```python
import torch

def _softmax(x, axis=-1):
    return torch.softmax(x, dim=axis)
def _gelu(x):
    return torch.nn.functional.gelu(x, approximate="tanh")
def _silu(x):
    return torch.nn.functional.silu(x)
def _sigmoid(x):
    return torch.sigmoid(x)
def _layernorm(x, axis=-1, eps=1e-5):
    m = x.mean(dim=axis, keepdim=True)
    v = x.var(dim=axis, keepdim=True, unbiased=False)
    return (x - m) / torch.sqrt(v + eps)
def _scatter_add(tgt, idx, src, axis=0):
    return tgt.clone().index_add_(axis, idx, src)
def _segment_sum(src, seg, n):
    out = torch.zeros((n,) + src.shape[1:], dtype=src.dtype)
    return out.index_add_(0, seg, src)
def _pad(x, pw):
    flat = tuple(v for pair in reversed(pw) for v in pair)
    return torch.nn.functional.pad(x, flat)

kernel_name = 'interleave_layers__gqa_block_cached__glu_gated_glu__decode'

def setup_inputs():

    _w = (lambda a: (lambda t: t.to(torch.bfloat16) if t.is_floating_point() else t)(torch.as_tensor(a)))
    def _A_setup():
        B, Sq, D = 8, 1, 512
        Hq, Hkv, Sk, Dh = 32, 32, 4096, 128
        assert Hq % Hkv == 0, (Hq, Hkv)
        return {
            "x": _w((lambda *s: torch.randn(*s, dtype=torch.bfloat16) * 0.05)(B, Sq, D)),
            "k_cache": _w((lambda *s: torch.randn(*s, dtype=torch.bfloat16) * 1.6)(B, Hkv, Sk, Dh)),
            "v_cache": _w((lambda *s: torch.randn(*s, dtype=torch.bfloat16) * 1.6)(B, Hkv, Sk, Dh)),
            "wq": _w((lambda *s: torch.randn(*s, dtype=torch.bfloat16) * 1.6)(D, Hq * Dh) * (D ** -0.5)),
            "wo": _w((lambda *s: torch.randn(*s, dtype=torch.bfloat16) * 1.6)(Hq * Dh, D) * ((Hq * Dh) ** -0.5)),
        }
    _A_in = _A_setup()

    def _B_setup():
        B, S, D, F = 8, 1, 512, 1376
        return {
            "x": _w((lambda *s: torch.randn(*s, dtype=torch.bfloat16) * 0.05)(B, S, D)),
            "w_gate": _w((lambda *s: torch.randn(*s, dtype=torch.bfloat16) * 0.05)(D, F)),
            "w_up": _w((lambda *s: torch.randn(*s, dtype=torch.bfloat16) * 0.05)(D, F)),
            "w_down": _w((lambda *s: torch.randn(*s, dtype=torch.bfloat16) * 0.05)(F, D)),
        }
    _B_in = _B_setup()

    return {
        "A_x": _A_in["x"],
        "A_k_cache": _A_in["k_cache"],
        "A_v_cache": _A_in["v_cache"],
        "A_wq": _A_in["wq"],
        "A_wo": _A_in["wo"],
        "B_x": _B_in["x"],
        "B_w_gate": _B_in["w_gate"],
        "B_w_up": _B_in["w_up"],
        "B_w_down": _B_in["w_down"],
    }

def reference(A_x, A_k_cache, A_v_cache, A_wq, A_wo, B_x, B_w_gate, B_w_up, B_w_down):
    def _A_ref(x, k_cache, v_cache, wq, wo):
        B, Sq, D = x.shape
        Hq, Dh = 32, 128
        Hkv = k_cache.shape[1]
        rep = Hq // Hkv
        q = (lambda x, *d: x.permute(*d))((x @ wq).reshape(B, Sq, Hq, Dh), 0, 2, 1, 3)
        k = (lambda x, n, axis: torch.repeat_interleave(x, n, dim=axis))(k_cache, rep, axis=1)
        v = (lambda x, n, axis: torch.repeat_interleave(x, n, dim=axis))(v_cache, rep, axis=1)
        scores = torch.einsum("bhqd,bhkd->bhqk", q, k) * (Dh ** -0.5)
        p = _softmax(scores, axis=-1)
        o = torch.einsum("bhqk,bhkd->bhqd", p, v)
        return (lambda x, *d: x.permute(*d))(o, 0, 2, 1, 3).reshape(B, Sq, Hq * Dh) @ wo

    def _B_ref(x, w_gate, w_up, w_down):
        g = torch.einsum("bsd,df->bsf", x, w_gate)
        u = torch.einsum("bsd,df->bsf", x, w_up)
        h = _sigmoid(g) * u
        return torch.einsum("bsf,fd->bsd", h, w_down)

    x = A_x
    x = x + _A_ref(_layernorm(x, axis=-1), A_k_cache, A_v_cache, A_wq, A_wo)
    x = x + _B_ref(_layernorm(x, axis=-1), B_w_gate, B_w_up, B_w_down)
    x = x + _A_ref(_layernorm(x, axis=-1), A_k_cache, A_v_cache, A_wq, A_wo)
    x = x + _B_ref(_layernorm(x, axis=-1), B_w_gate, B_w_up, B_w_down)
    return x
```

```asm
; @launch grid=(256,1,1) block=(256,1,1) lds=163840
.amdgcn_target "amdgcn-amd-amdhsa--gfx950"
.text
.globl interleave_layers__gqa_block_cached__glu_gated_glu__decode_kernel
.p2align 8
.type interleave_layers__gqa_block_cached__glu_gated_glu__decode_kernel,@function
interleave_layers__gqa_block_cached__glu_gated_glu__decode_kernel:
  s_cmp_ge_u32 s2, 256
  s_cbranch_scc1 Lend2
  s_load_dwordx4 s[64:67], s[0:1], 8
  s_load_dwordx4 s[68:71], s[0:1], 80
  s_lshr_b32 s91, s2, 3
  s_getpc_b64 s[86:87]
Lpc:
  s_lshl_b32 s88, s91, 11
  v_lshl_add_u32 v2, v0, 7, s88
  v_cmp_gt_u32 vcc, 16, v0
  v_min_u32 v2, Lend2-Lpc, v2
  s_and_saveexec_b64 s[88:89], vcc
  s_cbranch_execz Lcpf_1
  global_load_dword v255, v2, s[86:87]
Lcpf_1:
  s_mov_b64 exec, -1
  v_lshrrev_b32 v1, 6, v0
  v_and_b32 v0, 63, v0
  s_and_b32 s90, s2, 7
  v_readfirstlane_b32 s92, v1
  s_cmp_lt_u32 s91, 4
  s_cbranch_scc1 Lchain
  s_sub_u32 s57, s91, 4
  s_mul_i32 s58, s57, 37
  s_lshr_b32 s58, s58, 8
  s_mul_i32 s59, s58, 7
  s_sub_u32 s59, s57, s59
  s_lshl_b32 s60, s90, 2
  s_add_u32 s60, s60, s58
  s_lshl_b32 s61, s59, 2
  s_add_u32 s61, s61, s92
  s_lshl_b32 s28, s60, 20
  s_mul_i32 s3, s60, 5
  s_add_u32 s3, s3, s61
  s_mul_i32 s56, s3, 7282
  s_lshr_b32 s56, s56, 16
  s_mul_i32 s56, s56, 9
  s_sub_u32 s3, s3, s56
  s_mov_b32 s56, s61
  s_mul_i32 s31, s3, 28
  s_add_u32 s31, s31, s56
  s_lshl_b32 s31, s31, 12
  s_add_u32 s3, s3, 1
  s_cmp_eq_u32 s3, 9
  s_cselect_b32 s3, 0, s3
  s_mov_b32 s56, s61
  s_mul_i32 s39, s3, 28
  s_add_u32 s39, s39, s56
  s_lshl_b32 s39, s39, 12
  s_add_u32 s3, s3, 1
  s_cmp_eq_u32 s3, 9
  s_cselect_b32 s3, 0, s3
  s_mov_b32 s56, s61
  s_mul_i32 s50, s3, 28
  s_add_u32 s50, s50, s56
  s_lshl_b32 s50, s50, 12
  s_add_u32 s3, s3, 1
  s_cmp_eq_u32 s3, 9
  s_cselect_b32 s3, 0, s3
  s_mov_b32 s56, s61
  s_mul_i32 s51, s3, 28
  s_add_u32 s51, s51, s56
  s_lshl_b32 s51, s51, 12
  s_add_u32 s3, s3, 1
  s_cmp_eq_u32 s3, 9
  s_cselect_b32 s3, 0, s3
  v_lshlrev_b32 v2, 4, v0
  s_mul_i32 s38, s92, 36864
  s_load_dwordx4 s[76:79], s[0:1], 24
  s_load_dwordx4 s[80:83], s[0:1], 48
  s_load_dwordx2 s[84:85], s[0:1], 64
  s_lshl_b32 s72, s57, 2
  s_add_u32 s72, s72, s92
  s_mul_i32 s73, s72, 37
  v_add_u32 v16, s73, v0
  v_lshrrev_b32 v19, 3, v16
  v_lshlrev_b32 v19, 13, v19
  v_and_b32 v20, 7, v16
  v_lshl_add_u32 v19, v20, 7, v19
  s_lshl_b32 s73, s90, 10
  v_add_u32 v19, s73, v19
  s_waitcnt lgkmcnt(0)
  s_mov_b32 s12, s76
  s_mov_b32 s13, s77
  s_mov_b32 s14, 0x400000
  s_mov_b32 s15, 0x20000
  s_mov_b32 exec_hi, 31
  buffer_load_dword v24, v19, s[12:15], 0 offen
  s_mov_b64 exec, -1
  s_mov_b32 s8, s66
  s_mov_b32 s9, s67
  s_mov_b32 s10, 0x10000000
  s_mov_b32 s11, 0x20000
  s_add_u32 s29, s28, s31
  s_add_u32 m0, s38, 9216
  s_nop 0
  buffer_load_dwordx4 v2, s[8:11], s29 offen offset:0 nt lds
  s_add_u32 m0, s38, 8192
  s_nop 0
  buffer_load_dwordx4 v2, s[8:11], s29 offen offset:2048 nt lds
  s_add_u32 s29, s28, s39
  s_add_u32 m0, s38, 11264
  s_nop 0
  buffer_load_dwordx4 v2, s[8:11], s29 offen offset:0 nt lds
  s_add_u32 m0, s38, 10240
  s_nop 0
  buffer_load_dwordx4 v2, s[8:11], s29 offen offset:2048 nt lds
  s_add_u32 s29, s28, s50
  s_add_u32 m0, s38, 13312
  s_nop 0
  buffer_load_dwordx4 v2, s[8:11], s29 offen offset:0 nt lds
  s_add_u32 m0, s38, 12288
  s_nop 0
  buffer_load_dwordx4 v2, s[8:11], s29 offen offset:2048 nt lds
  s_add_u32 s29, s28, s51
  s_add_u32 m0, s38, 15360
  s_nop 0
  buffer_load_dwordx4 v2, s[8:11], s29 offen offset:0 nt lds
  s_add_u32 m0, s38, 14336
  s_nop 0
  buffer_load_dwordx4 v2, s[8:11], s29 offen offset:2048 nt lds
  s_mul_i32 s73, s72, 19
  v_add_u32 v17, s73, v0
  v_lshrrev_b32 v20, 2, v17
  v_mul_u32_u24 v20, 2752, v20
  v_and_b32 v17, 3, v17
  v_lshlrev_b32 v17, 7, v17
  v_min_u32 v17, 380, v17
  s_mul_i32 s73, s90, 384
  v_add3_u32 v17, v17, v20, s73
  s_lshl_b32 s73, s90, 19
  v_lshl_add_u32 v16, v16, 7, s73
  s_mul_i32 s73, s72, 14
  v_add_u32 v18, s73, v0
  s_mul_i32 s73, s90, 196608
  v_lshl_add_u32 v18, v18, 7, s73
  s_mov_b32 s72, s78
  s_mov_b32 s73, s79
  s_mov_b32 s74, 0x400000
  s_mov_b32 s75, 0x20000
  s_mov_b32 exec_hi, 31
  buffer_load_dword v24, v16, s[72:75], 0 offen
  s_mov_b64 exec, -1
  s_mov_b32 s72, s80
  s_mov_b32 s73, s81
  s_mov_b32 s74, 0x158000
  s_mov_b32 s75, 0x20000
  s_mov_b32 s76, s82
  s_mov_b32 s77, s83
  s_mov_b32 s78, 0x158000
  s_mov_b32 s79, 0x20000
  s_mov_b32 s80, s84
  s_mov_b32 s81, s85
  s_mov_b32 s82, 0x158000
  s_mov_b32 s83, 0x20000
  s_mov_b32 s20, s70
  s_mov_b32 s21, s71
  s_mov_b32 s22, 0x600000
  s_mov_b32 s23, 0x20000
  s_mov_b32 s24, s68
  s_mov_b32 s25, s69
  s_mov_b32 s26, 256
  s_mov_b32 s27, 0x20000
  s_lshl_b32 s53, s92, 9
  s_lshl_b32 s54, s92, 3
  s_lshl_b32 s57, s60, 12
  s_lshl_b32 s58, s59, 9
  s_add_u32 s36, s57, s58
  s_add_u32 s37, s36, 1048576
  s_lshl_b32 s55, s59, 3
  s_sub_u32 s55, s55, s58
  s_add_u32 s55, s55, 3584
  s_lshl_b32 s35, s60, 8
  s_add_u32 s35, s35, 2883584
  s_add_u32 s34, s35, 65536
  s_mov_b32 s30, 0
  s_mov_b32 s32, 0
  s_mov_b32 s52, 0
  v_mov_b32 v40, -1
  v_mov_b32 v41, -1
  v_lshrrev_b32 v5, 1, v2
  s_lshl_b32 s57, s92, 7
  s_add_u32 s57, s57, s36
  s_mov_b64 exec, 0xffff
  buffer_store_dwordx2 v[40:41], v5, s[20:23], s57 offen sc1
  s_add_u32 s57, s36, s55
  s_mov_b64 exec, 1
  buffer_store_dwordx2 v[40:41], off, s[20:23], s57 sc1
  s_mov_b64 exec, -1
  v_mov_b32 v42, -1
  v_mov_b32 v43, -1
  s_sub_u32 s57, s2, 32
  s_lshl_b32 s57, s57, 2
  s_add_u32 s57, s57, s92
  s_cmp_lt_u32 s57, 384
  s_cselect_b32 s58, 917504, 0
  s_lshl_b32 s57, s57, 10
  s_add_u32 s57, s57, 4194304
  s_add_u32 s58, s58, s57
  buffer_store_dwordx4 v[40:43], v2, s[20:23], s57 offen sc1
  s_cmp_eq_u32 s57, s58
  s_cselect_b64 exec, 1, -1
  buffer_store_dwordx4 v[40:43], v2, s[20:23], s58 offen sc1
  s_mov_b64 exec, 15
  v_lshlrev_b32 v5, 2, v0
  v_mov_b32 v44, 0
  ds_write_b32 v5, v44 offset:8320
  s_mov_b64 exec, -1
  s_cmp_lg_u32 s52, 0
  s_cselect_b64 vcc, -1, 0
  s_waitcnt vmcnt(12)
  s_add_u32 s29, s28, s31
  buffer_load_dwordx4 a[52:55], v2, s[8:11], s29 offen offset:1024 nt
  s_mul_i32 s62, s61, 9363
  s_add_u32 s63, s62, 9363
  s_lshr_b32 s62, s62, 8
  s_lshr_b32 s63, s63, 8
  s_sub_u32 s63, s63, s62
  s_mov_b32 s4, s64
  s_mov_b32 s5, s65
  s_mov_b32 s6, 0x10000000
  s_mov_b32 s7, 0x20000
  s_cmp_eq_u32 s63, 37
  s_cselect_b32 s57, 0x10000000, 0
  s_mov_b32 s12, s64
  s_mov_b32 s13, s65
  s_mov_b32 s14, s57
  s_mov_b32 s15, 0x20000
  s_mov_b32 s16, s66
  s_mov_b32 s17, s67
  s_mov_b32 s18, s57
  s_mov_b32 s19, 0x20000
  s_cselect_b32 s48, 0xfff0fff0, -1
  s_mov_b32 s49, s48
  s_waitcnt vmcnt(12)
  buffer_load_dwordx4 a[56:59], v2, s[8:11], s29 offen offset:3072 nt
  s_mov_b32 s56, s61
  s_mul_i32 s64, s3, 28
  s_add_u32 s64, s64, s56
  s_lshl_b32 s64, s64, 12
  s_add_u32 s3, s3, 1
  s_cmp_eq_u32 s3, 9
  s_cselect_b32 s3, 0, s3
  s_mov_b32 s56, s61
  s_mul_i32 s65, s3, 28
  s_add_u32 s65, s65, s56
  s_lshl_b32 s65, s65, 12
  s_add_u32 s3, s3, 1
  s_cmp_eq_u32 s3, 9
  s_cselect_b32 s3, 0, s3
  s_mov_b32 s56, s61
  s_mul_i32 s66, s3, 28
  s_add_u32 s66, s66, s56
  s_lshl_b32 s66, s66, 12
  s_add_u32 s3, s3, 1
  s_cmp_eq_u32 s3, 9
  s_cselect_b32 s3, 0, s3
  s_mov_b32 s56, s61
  s_mul_i32 s67, s3, 28
  s_add_u32 s67, s67, s56
  s_lshl_b32 s67, s67, 12
  s_add_u32 s3, s3, 1
  s_cmp_eq_u32 s3, 9
  s_cselect_b32 s3, 0, s3
  s_mov_b32 s56, s61
  s_mul_i32 s68, s3, 28
  s_add_u32 s68, s68, s56
  s_lshl_b32 s68, s68, 12
  s_add_u32 s3, s3, 1
  s_cmp_eq_u32 s3, 9
  s_cselect_b32 s3, 0, s3
  s_mul_i32 s69, s61, 36
  s_sub_u32 s69, s62, s69
  s_lshl_b32 s69, s69, 10
  s_add_u32 s69, s69, 1032192
  s_waitcnt vmcnt(12)
  s_add_u32 s29, s28, s39
  buffer_load_dwordx4 a[60:63], v2, s[8:11], s29 offen offset:1024 nt
  s_mov_b32 s33, 400000
  s_mov_b32 s94, 0x3db504f3
  s_mov_b32 s95, 0xffff0000
  s_getreg_b32 s56, hwreg(HW_REG_XCC_ID, 0, 4)
  s_and_b32 s56, s56, 7
  s_mul_i32 s93, s56, s56
  s_lshl_b32 s93, s93, 14
  s_lshl_b32 s56, s56, 6
  s_add_u32 s93, s93, s56
  s_add_u32 s93, s93, 1
  s_waitcnt vmcnt(12)
  buffer_load_dwordx4 a[64:67], v2, s[8:11], s29 offen offset:3072 nt
  v_and_b32 v3, 3, v0
  v_lshlrev_b32 v3, 4, v3
  v_lshrrev_b32 v5, 4, v0
  v_lshl_add_u32 v3, v5, 6, v3
  v_bfe_u32 v5, v0, 2, 2
  v_lshl_add_u32 v1, v5, 8, v3
  s_mov_b32 s40, 0xf000f
  s_mov_b32 s41, 0xf000f
  s_mov_b32 s42, 0xf000f0
  s_mov_b32 s43, 0xf000f0
  s_mov_b32 s44, 0xf000f00
  s_mov_b32 s45, 0xf000f00
  s_mov_b32 s46, 0xf000f000
  s_mov_b32 s47, 0xf000f000
  v_add_u32 v4, s38, v2
  v_add_u32 v4, 9216, v4
  v_and_b32 v5, 1, v0
  v_lshlrev_b32 v5, 4, v5
  v_mov_b32 v40, 0xffff
  v_lshlrev_b32 v5, v5, v40
  v_bfe_u32 v40, v0, 1, 2
  v_cmp_eq_u32 vcc, 0, v40
  s_nop 1
  v_cndmask_b32 v32, 0, v5, vcc
  v_cmp_eq_u32 vcc, 1, v40
  s_nop 1
  v_cndmask_b32 v33, 0, v5, vcc
  v_cmp_eq_u32 vcc, 2, v40
  s_nop 1
  v_cndmask_b32 v34, 0, v5, vcc
  v_cmp_eq_u32 vcc, 3, v40
  s_nop 1
  v_cndmask_b32 v35, 0, v5, vcc
  s_waitcnt vmcnt(12)
  s_add_u32 s29, s28, s50
  buffer_load_dwordx4 a[68:71], v2, s[8:11], s29 offen offset:1024 nt
  s_mov_b64 exec, 0x7ffff
  buffer_load_dword v24, v17, s[72:75], 0 offen
  s_mov_b64 exec, -1
  s_waitcnt vmcnt(13)
  buffer_load_dwordx4 a[72:75], v2, s[8:11], s29 offen offset:3072 nt
  s_waitcnt vmcnt(13)
  s_add_u32 s29, s28, s51
  buffer_load_dwordx4 a[76:79], v2, s[8:11], s29 offen offset:1024 nt
  s_waitcnt vmcnt(13)
  buffer_load_dwordx4 a[80:83], v2, s[8:11], s29 offen offset:3072 nt
  s_waitcnt vmcnt(8)
  s_add_u32 s29, s28, s64
  s_add_u32 m0, s38, 17408
  s_nop 0
  buffer_load_dwordx4 v2, s[8:11], s29 offen offset:0 nt lds
  s_mov_b64 exec, 0x7ffff
  buffer_load_dword v24, v17, s[76:79], 0 offen
  s_mov_b64 exec, -1
  s_waitcnt vmcnt(9)
  buffer_load_dwordx4 a[84:87], v2, s[8:11], s29 offen offset:1024 nt
  s_waitcnt lgkmcnt(0)
  s_barrier
  s_cmp_lg_u32 s92, 0
  s_cbranch_scc1 Lnoat_2
  s_lshl_b32 s57, s90, 4
  v_mov_b32 v5, s93
  s_mov_b64 exec, 1
  buffer_atomic_add v5, off, s[24:27], s57 sc1
  s_mov_b64 exec, -1
Lnoat_2:
  s_waitcnt vmcnt(9)
  s_add_u32 m0, s38, 16384
  s_nop 0
  buffer_load_dwordx4 v2, s[8:11], s29 offen offset:2048 nt lds
  s_waitcnt vmcnt(9)
  buffer_load_dwordx4 a[88:91], v2, s[8:11], s29 offen offset:3072 nt
  s_waitcnt vmcnt(9)
  s_add_u32 s29, s28, s65
  s_add_u32 m0, s38, 19456
  s_nop 0
  buffer_load_dwordx4 v2, s[8:11], s29 offen offset:0 nt lds
  s_mov_b64 exec, 0x3fff
  buffer_load_dword v24, v18, s[80:83], 0 offen
  s_mov_b64 exec, -1
  s_waitcnt vmcnt(9)
  buffer_load_dwordx4 a[92:95], v2, s[8:11], s29 offen offset:1024 nt
  s_waitcnt vmcnt(9)
  s_add_u32 m0, s38, 18432
  s_nop 0
  buffer_load_dwordx4 v2, s[8:11], s29 offen offset:2048 nt lds
  s_waitcnt vmcnt(9)
  buffer_load_dwordx4 a[96:99], v2, s[8:11], s29 offen offset:3072 nt
  s_waitcnt vmcnt(9)
  s_add_u32 s29, s28, s66
  s_add_u32 m0, s38, 21504
  s_nop 0
  buffer_load_dwordx4 v2, s[8:11], s29 offen offset:0 nt lds
  s_waitcnt vmcnt(8)
  buffer_load_dwordx4 a[100:103], v2, s[8:11], s29 offen offset:1024 nt
  s_waitcnt vmcnt(8)
  s_add_u32 m0, s38, 20480
  s_nop 0
  buffer_load_dwordx4 v2, s[8:11], s29 offen offset:2048 nt lds
  s_waitcnt vmcnt(8)
  buffer_load_dwordx4 a[104:107], v2, s[8:11], s29 offen offset:3072 nt
  s_waitcnt vmcnt(8)
  s_add_u32 s29, s28, s67
  s_add_u32 m0, s38, 23552
  s_nop 0
  buffer_load_dwordx4 v2, s[8:11], s29 offen offset:0 nt lds
  s_waitcnt vmcnt(7)
  buffer_load_dwordx4 a[108:111], v2, s[8:11], s29 offen offset:1024 nt
  s_waitcnt vmcnt(7)
  s_add_u32 m0, s38, 22528
  s_nop 0
  buffer_load_dwordx4 v2, s[8:11], s29 offen offset:2048 nt lds
  s_waitcnt vmcnt(7)
  buffer_load_dwordx4 a[112:115], v2, s[8:11], s29 offen offset:3072 nt
  s_waitcnt vmcnt(7)
  s_add_u32 s29, s28, s68
  s_add_u32 m0, s38, 25600
  s_nop 0
  buffer_load_dwordx4 v2, s[8:11], s29 offen offset:0 nt lds
  s_waitcnt vmcnt(7)
  buffer_load_dwordx4 a[116:119], v2, s[8:11], s29 offen offset:1024 nt
  s_waitcnt vmcnt(7)
  s_add_u32 m0, s38, 24576
  s_nop 0
  buffer_load_dwordx4 v2, s[8:11], s29 offen offset:2048 nt lds
  s_waitcnt vmcnt(7)
  buffer_load_dwordx4 a[120:123], v2, s[8:11], s29 offen offset:3072 nt
  s_waitcnt vmcnt(7)
  s_add_u32 s29, s28, s69
  buffer_load_dwordx4 a[124:127], v2, s[16:19], s29 offen offset:0 nt
  s_waitcnt vmcnt(7)
  buffer_load_dwordx4 a[48:51], v1, s[12:15], s29 offen offset:0 nt
  s_waitcnt vmcnt(7)
  s_add_u32 s29, s28, s31
  buffer_load_dwordx4 v[64:67], v1, s[4:7], s29 offen offset:0 nt
  s_waitcnt vmcnt(7)
  buffer_load_dwordx4 v[68:71], v1, s[4:7], s29 offen offset:1024 nt
  s_waitcnt vmcnt(7)
  buffer_load_dwordx4 v[72:75], v1, s[4:7], s29 offen offset:2048 nt
  s_waitcnt vmcnt(7)
  buffer_load_dwordx4 v[76:79], v1, s[4:7], s29 offen offset:3072 nt
  s_lshl_b32 s57, s90, 4
  buffer_load_dword v36, off, s[24:27], s57 sc1
  s_waitcnt vmcnt(8)
  s_add_u32 s29, s28, s39
  buffer_load_dwordx4 v[80:83], v1, s[4:7], s29 offen offset:0 nt
  s_waitcnt vmcnt(8)
  buffer_load_dwordx4 v[84:87], v1, s[4:7], s29 offen offset:1024 nt
  s_waitcnt vmcnt(8)
  buffer_load_dwordx4 v[88:91], v1, s[4:7], s29 offen offset:2048 nt
  s_waitcnt vmcnt(8)
  buffer_load_dwordx4 v[92:95], v1, s[4:7], s29 offen offset:3072 nt
  s_waitcnt vmcnt(8)
  s_add_u32 s29, s28, s50
  buffer_load_dwordx4 a[0:3], v1, s[4:7], s29 offen offset:0 nt
  s_waitcnt vmcnt(8)
  buffer_load_dwordx4 a[4:7], v1, s[4:7], s29 offen offset:1024 nt
  s_waitcnt vmcnt(8)
  buffer_load_dwordx4 a[8:11], v1, s[4:7], s29 offen offset:2048 nt
  s_waitcnt vmcnt(8)
  buffer_load_dwordx4 a[12:15], v1, s[4:7], s29 offen offset:3072 nt
  s_waitcnt vmcnt(8)
  s_branch Lflc_4
Lfl_3:
  s_sub_u32 s33, s33, 1
  s_cbranch_scc1 Lend
  s_sleep 4
  buffer_load_dword v36, off, s[24:27], s57 sc1
  s_waitcnt vmcnt(0)
Lflc_4:
  v_readfirstlane_b32 s58, v36
  s_and_b32 s59, s58, 63
  s_cmp_lg_u32 s59, 32
  s_cbranch_scc1 Lfl_3
  s_lshl_b32 s59, s93, 5
  s_cmp_eq_u32 s58, s59
  s_cselect_b32 s32, 1, 0
  v_mov_b32 v48, -1
  v_mov_b32 v49, -1
  v_bfe_u32 v50, v2, 1, 7
  s_lshr_b32 s56, s53, 2
  v_add_u32 v50, s56, v50
  s_mov_b32 exec_lo, 0
  v_mov_b32 v50, s55
  s_mov_b32 exec_lo, 0xffff0000
  s_mov_b32 exec_hi, 2
  v_add_u32 v50, 131072, v50
  s_mov_b32 exec_lo, -1
  s_mov_b32 exec_hi, 3
  s_add_u32 s56, s36, 0
  s_cmp_eq_u32 s32, 0
  s_cbranch_scc1 Lnl_5
  buffer_store_dwordx2 v[48:49], v50, s[20:23], s56 offen
  s_branch Ldn_6
Lnl_5:
  buffer_store_dwordx2 v[48:49], v50, s[20:23], s56 offen sc1
Ldn_6:
  s_mov_b64 exec, -1
  v_mov_b32 v48, -1
  v_mov_b32 v49, -1
  v_bfe_u32 v50, v2, 1, 7
  s_lshr_b32 s56, s53, 2
  v_add_u32 v50, s56, v50
  s_mov_b32 exec_lo, 0
  v_mov_b32 v50, s55
  s_mov_b32 exec_lo, 0xffff0000
  s_mov_b32 exec_hi, 2
  v_add_u32 v50, 917504, v50
  s_mov_b32 exec_lo, -1
  s_mov_b32 exec_hi, 3
  s_add_u32 s56, s36, 131072
  s_cmp_eq_u32 s32, 0
  s_cbranch_scc1 Lnl_7
  buffer_store_dwordx2 v[48:49], v50, s[20:23], s56 offen
  s_branch Ldn_8
Lnl_7:
  buffer_store_dwordx2 v[48:49], v50, s[20:23], s56 offen sc1
Ldn_8:
  s_mov_b64 exec, -1
  s_waitcnt vmcnt(9)
  s_add_u32 s29, s28, s51
  buffer_load_dwordx4 a[16:19], v1, s[4:7], s29 offen offset:0 nt
  s_waitcnt vmcnt(9)
  buffer_load_dwordx4 a[20:23], v1, s[4:7], s29 offen offset:1024 nt
  s_waitcnt vmcnt(9)
  buffer_load_dwordx4 a[24:27], v1, s[4:7], s29 offen offset:2048 nt
  s_waitcnt vmcnt(9)
  buffer_load_dwordx4 a[28:31], v1, s[4:7], s29 offen offset:3072 nt
  buffer_load_dwordx4 v[36:39], v3, s[20:23], s35 offen sc1
  s_waitcnt vmcnt(10)
  s_add_u32 s29, s28, s64
  buffer_load_dwordx4 a[32:35], v1, s[4:7], s29 offen offset:0 nt
  s_waitcnt vmcnt(10)
  buffer_load_dwordx4 a[36:39], v1, s[4:7], s29 offen offset:1024 nt
  s_waitcnt vmcnt(10)
  buffer_load_dwordx4 a[40:43], v1, s[4:7], s29 offen offset:2048 nt
  s_waitcnt vmcnt(10)
  buffer_load_dwordx4 a[44:47], v1, s[4:7], s29 offen offset:3072 nt
  s_waitcnt vmcnt(8)
  s_add_u32 s29, s28, s65
  buffer_load_dwordx4 v[96:99], v1, s[4:7], s29 offen offset:0 nt
  s_waitcnt vmcnt(8)
  buffer_load_dwordx4 v[100:103], v1, s[4:7], s29 offen offset:1024 nt
  s_waitcnt vmcnt(8)
  buffer_load_dwordx4 v[104:107], v1, s[4:7], s29 offen offset:2048 nt
  s_waitcnt vmcnt(8)
  buffer_load_dwordx4 v[108:111], v1, s[4:7], s29 offen offset:3072 nt
  s_waitcnt vmcnt(8)
  s_branch Lqchk_11
Lqw_9:
  s_sub_u32 s33, s33, 1
  s_cbranch_scc1 Lend
  buffer_load_dwordx4 v[36:39], v3, s[20:23], s35 offen sc1
  s_waitcnt vmcnt(0)
Lqchk_11:
  v_max3_u32 v0, v36, v37, v38
  v_max_u32 v0, v0, v39
  v_cmp_eq_u32 vcc, -1, v0
  s_cbranch_vccnz Lqw_9
  s_cmp_lg_u32 s52, 0
  s_cselect_b64 vcc, -1, 0
  v_cndmask_b32 v16, 0, v36, s[40:41]
  v_cndmask_b32 v17, 0, v37, s[40:41]
  v_cndmask_b32 v18, 0, v38, s[40:41]
  v_cndmask_b32 v19, 0, v39, s[40:41]
  v_cndmask_b32 v20, 0, v36, s[42:43]
  v_cndmask_b32 v21, 0, v37, s[42:43]
  v_cndmask_b32 v22, 0, v38, s[42:43]
  v_cndmask_b32 v23, 0, v39, s[42:43]
  v_cndmask_b32 v24, 0, v36, s[44:45]
  v_cndmask_b32 v25, 0, v37, s[44:45]
  v_cndmask_b32 v26, 0, v38, s[44:45]
  v_cndmask_b32 v27, 0, v39, s[44:45]
  v_cndmask_b32 v28, 0, v36, s[46:47]
  v_cndmask_b32 v29, 0, v37, s[46:47]
  v_cndmask_b32 v30, 0, v38, s[46:47]
  v_cndmask_b32 v31, 0, v39, s[46:47]
  s_waitcnt vmcnt(7)
  s_add_u32 s29, s28, s66
  buffer_load_dwordx4 v[112:115], v1, s[4:7], s29 offen offset:0 nt
  v_mfma_f32_16x16x32_bf16 v[40:43], a[48:51], v[16:19], 0
  v_mfma_f32_16x16x32_bf16 v[44:47], v[64:67], v[16:19], 0
  v_mfma_f32_16x16x32_bf16 v[44:47], v[68:71], v[24:27], v[44:47]
  v_mfma_f32_16x16x32_bf16 v[44:47], v[72:75], v[20:23], v[44:47]
  v_mfma_f32_16x16x32_bf16 v[44:47], v[76:79], v[28:31], v[44:47]
  s_nop 3
  v_mov_b32_dpp v6, v40 quad_perm:[0,0,0,0] row_mask:0xf bank_mask:0xf
  s_nop 2
  v_mov_b32_dpp v7, v44 quad_perm:[0,0,0,0] row_mask:0xf bank_mask:0xf
  v_add_f32_dpp v6, v41, v6 quad_perm:[1,1,1,1] row_mask:0xf bank_mask:0xf
  s_nop 0
  v_add_f32_dpp v7, v45, v7 quad_perm:[1,1,1,1] row_mask:0xf bank_mask:0xf
  v_add_f32_dpp v6, v42, v6 quad_perm:[2,2,2,2] row_mask:0xf bank_mask:0xf
  s_nop 0
  v_add_f32_dpp v7, v46, v7 quad_perm:[2,2,2,2] row_mask:0xf bank_mask:0xf
  v_add_f32_dpp v6, v43, v6 quad_perm:[3,3,3,3] row_mask:0xf bank_mask:0xf
  s_nop 0
  v_add_f32_dpp v7, v47, v7 quad_perm:[3,3,3,3] row_mask:0xf bank_mask:0xf
  s_mov_b64 exec, s[48:49]
  v_mov_b32 v6, 0xff800000
  s_mov_b64 exec, -1
  v_cvt_pk_bf16_f32 v0, v6, v7
  v_lshlrev_b32 v6, 16, v0
  v_and_b32 v7, s95, v0
  v_mul_f32 v6, s94, v6
  v_mul_f32 v7, s94, v7
  v_cvt_pk_bf16_f32 v0, v6, v7
  v_lshlrev_b32 v6, 16, v0
  v_and_b32 v7, s95, v0
  v_max_f32 v14, v6, v7
  s_nop 1
  v_max_f32_dpp v14, v14, v14 row_ror:4 row_mask:0xf bank_mask:0xf
  s_nop 1
  v_max_f32_dpp v14, v14, v14 row_ror:8 row_mask:0xf bank_mask:0xf
  s_nop 1
  v_max_f32_dpp v14, v14, v14 row_bcast:15 row_mask:0xa bank_mask:0xf
  s_nop 1
  v_max_f32_dpp v14, v14, v14 row_bcast:31 row_mask:0xc bank_mask:0xf
  v_mul_f32 v14, 0xbfb8aa3b, v14
  s_nop 0
  v_readlane_b32 s56, v14, 63
  s_nop 1
  v_mov_b32 v8, s56
  v_fmamk_f32 v6, v6, 0x3fb8aa3b, v8
  v_fmamk_f32 v7, v7, 0x3fb8aa3b, v8
  v_exp_f32 v6, v6
  v_exp_f32 v7, v7
  v_mov_b32 v9, v6
  v_cvt_pk_bf16_f32 v6, v6, v6
  v_add_f32 v9, v9, v7
  v_cvt_pk_bf16_f32 v7, v7, v7
  s_waitcnt vmcnt(7)
  buffer_load_dwordx4 v[116:119], v1, s[4:7], s29 offen offset:1024 nt
  ds_read_b128 v[40:43], v4 offset:0
  ds_read_b128 v[44:47], v4 offset:1024
  v_and_b32 v60, v6, v32
  v_and_b32 v61, v6, v33
  v_and_b32_dpp v62, v6, v34 row_half_mirror row_mask:0xf bank_mask:0xf
  v_and_b32_dpp v63, v6, v35 row_half_mirror row_mask:0xf bank_mask:0xf
  s_nop 1
  v_mfma_f32_16x16x32_bf16 v[52:55], a[124:127], v[60:63], 0
  v_and_b32 v60, v7, v32
  v_and_b32 v61, v7, v33
  v_and_b32_dpp v62, v7, v34 row_half_mirror row_mask:0xf bank_mask:0xf
  v_and_b32_dpp v63, v7, v35 row_half_mirror row_mask:0xf bank_mask:0xf
  s_waitcnt lgkmcnt(1)
  s_nop 0
  v_mfma_f32_16x16x32_bf16 v[52:55], v[40:43], v[60:63], v[52:55]
  v_mfma_f32_16x16x32_bf16 v[56:59], a[52:55], v[60:63], 0
  v_and_b32_dpp v60, v7, v32 row_half_mirror row_mask:0xf bank_mask:0xf
  v_and_b32_dpp v61, v7, v33 row_half_mirror row_mask:0xf bank_mask:0xf
  v_and_b32 v62, v7, v34
  v_and_b32 v63, v7, v35
  s_waitcnt lgkmcnt(0)
  s_nop 0
  v_mfma_f32_16x16x32_bf16 v[52:55], v[44:47], v[60:63], v[52:55]
  v_mfma_f32_16x16x32_bf16 v[56:59], a[56:59], v[60:63], v[56:59]
  s_waitcnt vmcnt(7)
  buffer_load_dwordx4 v[120:123], v1, s[4:7], s29 offen offset:2048 nt
  v_mfma_f32_16x16x32_bf16 v[40:43], v[80:83], v[16:19], 0
  v_mfma_f32_16x16x32_bf16 v[40:43], v[84:87], v[24:27], v[40:43]
  v_mfma_f32_16x16x32_bf16 v[40:43], v[88:91], v[20:23], v[40:43]
  v_mfma_f32_16x16x32_bf16 v[40:43], v[92:95], v[28:31], v[40:43]
  v_mfma_f32_16x16x32_bf16 v[44:47], a[0:3], v[16:19], 0
  v_mfma_f32_16x16x32_bf16 v[44:47], a[4:7], v[24:27], v[44:47]
  v_mfma_f32_16x16x32_bf16 v[44:47], a[8:11], v[20:23], v[44:47]
  v_mfma_f32_16x16x32_bf16 v[44:47], a[12:15], v[28:31], v[44:47]
  s_nop 3
  v_mov_b32_dpp v6, v40 quad_perm:[0,0,0,0] row_mask:0xf bank_mask:0xf
  s_nop 2
  v_mov_b32_dpp v7, v44 quad_perm:[0,0,0,0] row_mask:0xf bank_mask:0xf
  v_add_f32_dpp v6, v41, v6 quad_perm:[1,1,1,1] row_mask:0xf bank_mask:0xf
  s_nop 0
  v_add_f32_dpp v7, v45, v7 quad_perm:[1,1,1,1] row_mask:0xf bank_mask:0xf
  v_add_f32_dpp v6, v42, v6 quad_perm:[2,2,2,2] row_mask:0xf bank_mask:0xf
  s_nop 0
  v_add_f32_dpp v7, v46, v7 quad_perm:[2,2,2,2] row_mask:0xf bank_mask:0xf
  v_add_f32_dpp v6, v43, v6 quad_perm:[3,3,3,3] row_mask:0xf bank_mask:0xf
  s_nop 0
  v_add_f32_dpp v7, v47, v7 quad_perm:[3,3,3,3] row_mask:0xf bank_mask:0xf
  v_cvt_pk_bf16_f32 v0, v6, v7
  v_lshlrev_b32 v6, 16, v0
  v_and_b32 v7, s95, v0
  v_mul_f32 v6, s94, v6
  v_mul_f32 v7, s94, v7
  v_cvt_pk_bf16_f32 v0, v6, v7
  v_lshlrev_b32 v6, 16, v0
  v_and_b32 v7, s95, v0
  v_max_f32 v14, v6, v7
  s_nop 1
  v_max_f32_dpp v14, v14, v14 row_ror:4 row_mask:0xf bank_mask:0xf
  s_nop 1
  v_max_f32_dpp v14, v14, v14 row_ror:8 row_mask:0xf bank_mask:0xf
  s_nop 1
  v_max_f32_dpp v14, v14, v14 row_bcast:15 row_mask:0xa bank_mask:0xf
  s_nop 1
  v_max_f32_dpp v14, v14, v14 row_bcast:31 row_mask:0xc bank_mask:0xf
  v_mul_f32 v14, 0xbfb8aa3b, v14
  s_nop 0
  v_readlane_b32 s56, v14, 63
  s_nop 1
  v_min_f32 v15, s56, v8
  v_sub_f32 v14, v15, v8
  v_mov_b32 v8, v15
  v_fmamk_f32 v6, v6, 0x3fb8aa3b, v8
  v_fmamk_f32 v7, v7, 0x3fb8aa3b, v8
  v_exp_f32 v6, v6
  v_exp_f32 v7, v7
  v_exp_f32 v14, v14
  s_nop 0
  v_fma_f32 v9, v14, v9, v6
  v_cvt_pk_bf16_f32 v6, v6, v6
  v_add_f32 v9, v9, v7
  v_cvt_pk_bf16_f32 v7, v7, v7
  v_mul_f32 v52, v14, v52
  v_mul_f32 v53, v14, v53
  v_mul_f32 v54, v14, v54
  v_mul_f32 v55, v14, v55
  v_mul_f32 v56, v14, v56
  v_mul_f32 v57, v14, v57
  v_mul_f32 v58, v14, v58
  v_mul_f32 v59, v14, v59
  s_waitcnt vmcnt(7)
  buffer_load_dwordx4 v[124:127], v1, s[4:7], s29 offen offset:3072 nt
  ds_read_b128 v[40:43], v4 offset:2048
  ds_read_b128 v[44:47], v4 offset:3072
  ds_read_b128 v[48:51], v4 offset:4096
  v_and_b32 v60, v6, v32
  v_and_b32 v61, v6, v33
  v_and_b32_dpp v62, v6, v34 row_half_mirror row_mask:0xf bank_mask:0xf
  v_and_b32_dpp v63, v6, v35 row_half_mirror row_mask:0xf bank_mask:0xf
  s_waitcnt lgkmcnt(2)
  s_nop 0
  v_mfma_f32_16x16x32_bf16 v[52:55], v[40:43], v[60:63], v[52:55]
  ds_read_b128 v[40:43], v4 offset:5120
  v_mfma_f32_16x16x32_bf16 v[56:59], a[60:63], v[60:63], v[56:59]
  v_and_b32_dpp v60, v6, v32 row_half_mirror row_mask:0xf bank_mask:0xf
  v_and_b32_dpp v61, v6, v33 row_half_mirror row_mask:0xf bank_mask:0xf
  v_and_b32 v62, v6, v34
  v_and_b32 v63, v6, v35
  s_waitcnt lgkmcnt(2)
  s_nop 0
  v_mfma_f32_16x16x32_bf16 v[52:55], v[44:47], v[60:63], v[52:55]
  v_mfma_f32_16x16x32_bf16 v[56:59], a[64:67], v[60:63], v[56:59]
  v_and_b32 v60, v7, v32
  v_and_b32 v61, v7, v33
  v_and_b32_dpp v62, v7, v34 row_half_mirror row_mask:0xf bank_mask:0xf
  v_and_b32_dpp v63, v7, v35 row_half_mirror row_mask:0xf bank_mask:0xf
  s_waitcnt lgkmcnt(1)
  s_nop 0
  v_mfma_f32_16x16x32_bf16 v[52:55], v[48:51], v[60:63], v[52:55]
  v_mfma_f32_16x16x32_bf16 v[56:59], a[68:71], v[60:63], v[56:59]
  v_and_b32_dpp v60, v7, v32 row_half_mirror row_mask:0xf bank_mask:0xf
  v_and_b32_dpp v61, v7, v33 row_half_mirror row_mask:0xf bank_mask:0xf
  v_and_b32 v62, v7, v34
  v_and_b32 v63, v7, v35
  s_waitcnt lgkmcnt(0)
  s_nop 0
  v_mfma_f32_16x16x32_bf16 v[52:55], v[40:43], v[60:63], v[52:55]
  v_mfma_f32_16x16x32_bf16 v[56:59], a[72:75], v[60:63], v[56:59]
  s_waitcnt vmcnt(7)
  s_add_u32 s29, s28, s67
  buffer_load_dwordx4 v[128:131], v1, s[4:7], s29 offen offset:0 nt
  v_mfma_f32_16x16x32_bf16 v[40:43], a[16:19], v[16:19], 0
  v_mfma_f32_16x16x32_bf16 v[40:43], a[20:23], v[24:27], v[40:43]
  v_mfma_f32_16x16x32_bf16 v[40:43], a[24:27], v[20:23], v[40:43]
  v_mfma_f32_16x16x32_bf16 v[40:43], a[28:31], v[28:31], v[40:43]
  v_mfma_f32_16x16x32_bf16 v[44:47], a[32:35], v[16:19], 0
  v_mfma_f32_16x16x32_bf16 v[44:47], a[36:39], v[24:27], v[44:47]
  v_mfma_f32_16x16x32_bf16 v[44:47], a[40:43], v[20:23], v[44:47]
  v_mfma_f32_16x16x32_bf16 v[44:47], a[44:47], v[28:31], v[44:47]
  s_nop 3
  v_mov_b32_dpp v6, v40 quad_perm:[0,0,0,0] row_mask:0xf bank_mask:0xf
  s_nop 2
  v_mov_b32_dpp v7, v44 quad_perm:[0,0,0,0] row_mask:0xf bank_mask:0xf
  v_add_f32_dpp v6, v41, v6 quad_perm:[1,1,1,1] row_mask:0xf bank_mask:0xf
  s_nop 0
  v_add_f32_dpp v7, v45, v7 quad_perm:[1,1,1,1] row_mask:0xf bank_mask:0xf
  v_add_f32_dpp v6, v42, v6 quad_perm:[2,2,2,2] row_mask:0xf bank_mask:0xf
  s_nop 0
  v_add_f32_dpp v7, v46, v7 quad_perm:[2,2,2,2] row_mask:0xf bank_mask:0xf
  v_add_f32_dpp v6, v43, v6 quad_perm:[3,3,3,3] row_mask:0xf bank_mask:0xf
  s_nop 0
  v_add_f32_dpp v7, v47, v7 quad_perm:[3,3,3,3] row_mask:0xf bank_mask:0xf
  v_cvt_pk_bf16_f32 v0, v6, v7
  v_lshlrev_b32 v6, 16, v0
  v_and_b32 v7, s95, v0
  v_mul_f32 v6, s94, v6
  v_mul_f32 v7, s94, v7
  v_cvt_pk_bf16_f32 v0, v6, v7
  v_lshlrev_b32 v6, 16, v0
  v_and_b32 v7, s95, v0
  v_max_f32 v14, v6, v7
  s_nop 1
  v_max_f32_dpp v14, v14, v14 row_ror:4 row_mask:0xf bank_mask:0xf
  s_nop 1
  v_max_f32_dpp v14, v14, v14 row_ror:8 row_mask:0xf bank_mask:0xf
  s_nop 1
  v_max_f32_dpp v14, v14, v14 row_bcast:15 row_mask:0xa bank_mask:0xf
  s_nop 1
  v_max_f32_dpp v14, v14, v14 row_bcast:31 row_mask:0xc bank_mask:0xf
  v_mul_f32 v14, 0xbfb8aa3b, v14
  s_nop 0
  v_readlane_b32 s56, v14, 63
  s_nop 1
  v_min_f32 v15, s56, v8
  v_sub_f32 v14, v15, v8
  v_mov_b32 v8, v15
  v_fmamk_f32 v6, v6, 0x3fb8aa3b, v8
  v_fmamk_f32 v7, v7, 0x3fb8aa3b, v8
  v_exp_f32 v6, v6
  v_exp_f32 v7, v7
  v_exp_f32 v14, v14
  s_nop 0
  v_fma_f32 v9, v14, v9, v6
  v_cvt_pk_bf16_f32 v6, v6, v6
  v_add_f32 v9, v9, v7
  v_cvt_pk_bf16_f32 v7, v7, v7
  v_mul_f32 v52, v14, v52
  v_mul_f32 v53, v14, v53
  v_mul_f32 v54, v14, v54
  v_mul_f32 v55, v14, v55
  v_mul_f32 v56, v14, v56
  v_mul_f32 v57, v14, v57
  v_mul_f32 v58, v14, v58
  v_mul_f32 v59, v14, v59
  s_waitcnt vmcnt(7)
  buffer_load_dwordx4 v[132:135], v1, s[4:7], s29 offen offset:1024 nt
  ds_read_b128 v[40:43], v4 offset:6144
  ds_read_b128 v[44:47], v4 offset:7168
  ds_read_b128 v[48:51], v4 offset:8192
  v_and_b32 v60, v6, v32
  v_and_b32 v61, v6, v33
  v_and_b32_dpp v62, v6, v34 row_half_mirror row_mask:0xf bank_mask:0xf
  v_and_b32_dpp v63, v6, v35 row_half_mirror row_mask:0xf bank_mask:0xf
  s_waitcnt lgkmcnt(2)
  s_nop 0
  v_mfma_f32_16x16x32_bf16 v[52:55], v[40:43], v[60:63], v[52:55]
  ds_read_b128 v[40:43], v4 offset:9216
  v_mfma_f32_16x16x32_bf16 v[56:59], a[76:79], v[60:63], v[56:59]
  v_and_b32_dpp v60, v6, v32 row_half_mirror row_mask:0xf bank_mask:0xf
  v_and_b32_dpp v61, v6, v33 row_half_mirror row_mask:0xf bank_mask:0xf
  v_and_b32 v62, v6, v34
  v_and_b32 v63, v6, v35
  s_waitcnt lgkmcnt(2)
  s_nop 0
  v_mfma_f32_16x16x32_bf16 v[52:55], v[44:47], v[60:63], v[52:55]
  v_mfma_f32_16x16x32_bf16 v[56:59], a[80:83], v[60:63], v[56:59]
  v_and_b32 v60, v7, v32
  v_and_b32 v61, v7, v33
  v_and_b32_dpp v62, v7, v34 row_half_mirror row_mask:0xf bank_mask:0xf
  v_and_b32_dpp v63, v7, v35 row_half_mirror row_mask:0xf bank_mask:0xf
  s_waitcnt lgkmcnt(1)
  s_nop 0
  v_mfma_f32_16x16x32_bf16 v[52:55], v[48:51], v[60:63], v[52:55]
  v_mfma_f32_16x16x32_bf16 v[56:59], a[84:87], v[60:63], v[56:59]
  v_and_b32_dpp v60, v7, v32 row_half_mirror row_mask:0xf bank_mask:0xf
  v_and_b32_dpp v61, v7, v33 row_half_mirror row_mask:0xf bank_mask:0xf
  v_and_b32 v62, v7, v34
  v_and_b32 v63, v7, v35
  s_waitcnt lgkmcnt(0)
  s_nop 0
  v_mfma_f32_16x16x32_bf16 v[52:55], v[40:43], v[60:63], v[52:55]
  v_mfma_f32_16x16x32_bf16 v[56:59], a[88:91], v[60:63], v[56:59]
  s_waitcnt vmcnt(7)
  buffer_load_dwordx4 v[136:139], v1, s[4:7], s29 offen offset:2048 nt
  s_waitcnt vmcnt(7)
  buffer_load_dwordx4 v[140:143], v1, s[4:7], s29 offen offset:3072 nt
  s_waitcnt vmcnt(7)
  s_add_u32 s29, s28, s68
  buffer_load_dwordx4 v[144:147], v1, s[4:7], s29 offen offset:0 nt
  s_waitcnt vmcnt(7)
  buffer_load_dwordx4 v[148:151], v1, s[4:7], s29 offen offset:1024 nt
  s_waitcnt vmcnt(7)
  buffer_load_dwordx4 v[152:155], v1, s[4:7], s29 offen offset:2048 nt
  s_waitcnt vmcnt(7)
  buffer_load_dwordx4 v[156:159], v1, s[4:7], s29 offen offset:3072 nt
  v_mfma_f32_16x16x32_bf16 v[40:43], v[96:99], v[16:19], 0
  v_mfma_f32_16x16x32_bf16 v[40:43], v[100:103], v[24:27], v[40:43]
  v_mfma_f32_16x16x32_bf16 v[40:43], v[104:107], v[20:23], v[40:43]
  v_mfma_f32_16x16x32_bf16 v[40:43], v[108:111], v[28:31], v[40:43]
  v_mfma_f32_16x16x32_bf16 v[44:47], v[112:115], v[16:19], 0
  v_mfma_f32_16x16x32_bf16 v[44:47], v[116:119], v[24:27], v[44:47]
  v_mfma_f32_16x16x32_bf16 v[44:47], v[120:123], v[20:23], v[44:47]
  v_mfma_f32_16x16x32_bf16 v[44:47], v[124:127], v[28:31], v[44:47]
  s_nop 3
  v_mov_b32_dpp v6, v40 quad_perm:[0,0,0,0] row_mask:0xf bank_mask:0xf
  s_nop 2
  v_mov_b32_dpp v7, v44 quad_perm:[0,0,0,0] row_mask:0xf bank_mask:0xf
  v_add_f32_dpp v6, v41, v6 quad_perm:[1,1,1,1] row_mask:0xf bank_mask:0xf
  s_nop 0
  v_add_f32_dpp v7, v45, v7 quad_perm:[1,1,1,1] row_mask:0xf bank_mask:0xf
  v_add_f32_dpp v6, v42, v6 quad_perm:[2,2,2,2] row_mask:0xf bank_mask:0xf
  s_nop 0
  v_add_f32_dpp v7, v46, v7 quad_perm:[2,2,2,2] row_mask:0xf bank_mask:0xf
  v_add_f32_dpp v6, v43, v6 quad_perm:[3,3,3,3] row_mask:0xf bank_mask:0xf
  s_nop 0
  v_add_f32_dpp v7, v47, v7 quad_perm:[3,3,3,3] row_mask:0xf bank_mask:0xf
  v_cvt_pk_bf16_f32 v0, v6, v7
  v_lshlrev_b32 v6, 16, v0
  v_and_b32 v7, s95, v0
  v_mul_f32 v6, s94, v6
  v_mul_f32 v7, s94, v7
  v_cvt_pk_bf16_f32 v0, v6, v7
  v_lshlrev_b32 v6, 16, v0
  v_and_b32 v7, s95, v0
  v_max_f32 v14, v6, v7
  s_nop 1
  v_max_f32_dpp v14, v14, v14 row_ror:4 row_mask:0xf bank_mask:0xf
  s_nop 1
  v_max_f32_dpp v14, v14, v14 row_ror:8 row_mask:0xf bank_mask:0xf
  s_nop 1
  v_max_f32_dpp v14, v14, v14 row_bcast:15 row_mask:0xa bank_mask:0xf
  s_nop 1
  v_max_f32_dpp v14, v14, v14 row_bcast:31 row_mask:0xc bank_mask:0xf
  v_mul_f32 v14, 0xbfb8aa3b, v14
  s_nop 0
  v_readlane_b32 s56, v14, 63
  s_nop 1
  v_min_f32 v15, s56, v8
  v_sub_f32 v14, v15, v8
  v_mov_b32 v8, v15
  v_fmamk_f32 v6, v6, 0x3fb8aa3b, v8
  v_fmamk_f32 v7, v7, 0x3fb8aa3b, v8
  v_exp_f32 v6, v6
  v_exp_f32 v7, v7
  v_exp_f32 v14, v14
  s_nop 0
  v_fma_f32 v9, v14, v9, v6
  v_cvt_pk_bf16_f32 v6, v6, v6
  v_add_f32 v9, v9, v7
  v_cvt_pk_bf16_f32 v7, v7, v7
  v_mul_f32 v52, v14, v52
  v_mul_f32 v53, v14, v53
  v_mul_f32 v54, v14, v54
  v_mul_f32 v55, v14, v55
  v_mul_f32 v56, v14, v56
  v_mul_f32 v57, v14, v57
  v_mul_f32 v58, v14, v58
  v_mul_f32 v59, v14, v59
  ds_read_b128 v[40:43], v4 offset:10240
  ds_read_b128 v[44:47], v4 offset:11264
  ds_read_b128 v[48:51], v4 offset:12288
  v_and_b32 v60, v6, v32
  v_and_b32 v61, v6, v33
  v_and_b32_dpp v62, v6, v34 row_half_mirror row_mask:0xf bank_mask:0xf
  v_and_b32_dpp v63, v6, v35 row_half_mirror row_mask:0xf bank_mask:0xf
  s_waitcnt lgkmcnt(2)
  s_nop 0
  v_mfma_f32_16x16x32_bf16 v[52:55], v[40:43], v[60:63], v[52:55]
  ds_read_b128 v[40:43], v4 offset:13312
  v_mfma_f32_16x16x32_bf16 v[56:59], a[92:95], v[60:63], v[56:59]
  v_and_b32_dpp v60, v6, v32 row_half_mirror row_mask:0xf bank_mask:0xf
  v_and_b32_dpp v61, v6, v33 row_half_mirror row_mask:0xf bank_mask:0xf
  v_and_b32 v62, v6, v34
  v_and_b32 v63, v6, v35
  s_waitcnt lgkmcnt(2)
  s_nop 0
  v_mfma_f32_16x16x32_bf16 v[52:55], v[44:47], v[60:63], v[52:55]
  v_mfma_f32_16x16x32_bf16 v[56:59], a[96:99], v[60:63], v[56:59]
  v_and_b32 v60, v7, v32
  v_and_b32 v61, v7, v33
  v_and_b32_dpp v62, v7, v34 row_half_mirror row_mask:0xf bank_mask:0xf
  v_and_b32_dpp v63, v7, v35 row_half_mirror row_mask:0xf bank_mask:0xf
  s_waitcnt lgkmcnt(1)
  s_nop 0
  v_mfma_f32_16x16x32_bf16 v[52:55], v[48:51], v[60:63], v[52:55]
  v_mfma_f32_16x16x32_bf16 v[56:59], a[100:103], v[60:63], v[56:59]
  v_and_b32_dpp v60, v7, v32 row_half_mirror row_mask:0xf bank_mask:0xf
  v_and_b32_dpp v61, v7, v33 row_half_mirror row_mask:0xf bank_mask:0xf
  v_and_b32 v62, v7, v34
  v_and_b32 v63, v7, v35
  s_waitcnt lgkmcnt(0)
  s_nop 0
  v_mfma_f32_16x16x32_bf16 v[52:55], v[40:43], v[60:63], v[52:55]
  v_mfma_f32_16x16x32_bf16 v[56:59], a[104:107], v[60:63], v[56:59]
  s_add_u32 s28, s28, 0x2000000
  s_add_u32 s35, s35, 8192
  buffer_load_dwordx4 v[36:39], v3, s[20:23], s35 offen sc1
  s_waitcnt vmcnt(8)
  s_add_u32 s29, s28, s31
  buffer_load_dwordx4 v[160:163], v1, s[4:7], s29 offen offset:0 nt
  ds_read_b128 v[44:47], v4 offset:14336
  ds_read_b128 v[48:51], v4 offset:15360
  v_mfma_f32_16x16x32_bf16 v[40:43], v[128:131], v[16:19], 0
  s_waitcnt vmcnt(8)
  buffer_load_dwordx4 v[164:167], v1, s[4:7], s29 offen offset:1024 nt
  v_mfma_f32_16x16x32_bf16 v[40:43], v[132:135], v[24:27], v[40:43]
  s_waitcnt vmcnt(8)
  buffer_load_dwordx4 v[168:171], v1, s[4:7], s29 offen offset:2048 nt
  v_mfma_f32_16x16x32_bf16 v[40:43], v[136:139], v[20:23], v[40:43]
  s_waitcnt vmcnt(8)
  buffer_load_dwordx4 v[172:175], v1, s[4:7], s29 offen offset:3072 nt
  v_mfma_f32_16x16x32_bf16 v[40:43], v[140:143], v[28:31], v[40:43]
  s_nop 7
  v_mov_b32_dpp v6, v40 quad_perm:[0,0,0,0] row_mask:0xf bank_mask:0xf
  s_nop 1
  v_add_f32_dpp v6, v41, v6 quad_perm:[1,1,1,1] row_mask:0xf bank_mask:0xf
  s_nop 1
  v_add_f32_dpp v6, v42, v6 quad_perm:[2,2,2,2] row_mask:0xf bank_mask:0xf
  s_nop 1
  v_add_f32_dpp v6, v43, v6 quad_perm:[3,3,3,3] row_mask:0xf bank_mask:0xf
  v_cvt_pk_bf16_f32 v0, v6, v6
  v_and_b32 v6, s95, v0
  v_mul_f32 v6, s94, v6
  v_cvt_pk_bf16_f32 v0, v6, v6
  v_and_b32 v6, s95, v0
  s_nop 1
  v_max_f32_dpp v14, v6, v6 row_ror:4 row_mask:0xf bank_mask:0xf
  s_nop 1
  v_max_f32_dpp v14, v14, v14 row_ror:8 row_mask:0xf bank_mask:0xf
  s_nop 1
  v_max_f32_dpp v14, v14, v14 row_bcast:15 row_mask:0xa bank_mask:0xf
  s_nop 1
  v_max_f32_dpp v14, v14, v14 row_bcast:31 row_mask:0xc bank_mask:0xf
  v_mul_f32 v14, 0xbfb8aa3b, v14
  s_nop 0
  v_readlane_b32 s56, v14, 63
  s_nop 1
  v_min_f32 v15, s56, v8
  v_sub_f32 v14, v15, v8
  v_mov_b32 v8, v15
  v_fmamk_f32 v6, v6, 0x3fb8aa3b, v8
  v_exp_f32 v6, v6
  v_exp_f32 v14, v14
  s_nop 0
  v_fma_f32 v9, v14, v9, v6
  v_cvt_pk_bf16_f32 v6, v6, v6
  v_mul_f32 v52, v14, v52
  v_mul_f32 v53, v14, v53
  v_mul_f32 v54, v14, v54
  v_mul_f32 v55, v14, v55
  v_and_b32 v60, v6, v32
  v_and_b32 v61, v6, v33
  v_and_b32_dpp v62, v6, v34 row_half_mirror row_mask:0xf bank_mask:0xf
  v_and_b32_dpp v63, v6, v35 row_half_mirror row_mask:0xf bank_mask:0xf
  v_mul_f32 v56, v14, v56
  v_mul_f32 v57, v14, v57
  s_waitcnt lgkmcnt(0)
  v_mfma_f32_16x16x32_bf16 v[52:55], v[44:47], v[60:63], v[52:55]
  v_mul_f32 v58, v14, v58
  v_mul_f32 v59, v14, v59
  v_and_b32_dpp v40, v6, v32 row_half_mirror row_mask:0xf bank_mask:0xf
  v_and_b32_dpp v41, v6, v33 row_half_mirror row_mask:0xf bank_mask:0xf
  v_mfma_f32_16x16x32_bf16 v[56:59], a[108:111], v[60:63], v[56:59]
  v_and_b32 v42, v6, v34
  v_and_b32 v43, v6, v35
  v_mov_b32 v0, s54
  s_nop 0
  v_mfma_f32_16x16x32_bf16 v[52:55], v[48:51], v[40:43], v[52:55]
  v_mfma_f32_16x16x32_bf16 v[56:59], a[112:115], v[40:43], v[56:59]
  s_waitcnt vmcnt(8)
  s_add_u32 s29, s28, s39
  buffer_load_dwordx4 v[176:179], v1, s[4:7], s29 offen offset:0 nt
  ds_read_b128 v[44:47], v4 offset:16384
  ds_read_b128 v[48:51], v4 offset:17408
  v_mfma_f32_16x16x32_bf16 v[40:43], v[144:147], v[16:19], 0
  s_waitcnt vmcnt(8)
  buffer_load_dwordx4 v[180:183], v1, s[4:7], s29 offen offset:1024 nt
  v_mfma_f32_16x16x32_bf16 v[40:43], v[148:151], v[24:27], v[40:43]
  s_waitcnt vmcnt(8)
  buffer_load_dwordx4 v[184:187], v1, s[4:7], s29 offen offset:2048 nt
  v_mfma_f32_16x16x32_bf16 v[40:43], v[152:155], v[20:23], v[40:43]
  s_waitcnt vmcnt(8)
  buffer_load_dwordx4 v[188:191], v1, s[4:7], s29 offen offset:3072 nt
  v_mfma_f32_16x16x32_bf16 v[40:43], v[156:159], v[28:31], v[40:43]
  s_nop 7
  v_mov_b32_dpp v6, v40 quad_perm:[0,0,0,0] row_mask:0xf bank_mask:0xf
  s_nop 1
  v_add_f32_dpp v6, v41, v6 quad_perm:[1,1,1,1] row_mask:0xf bank_mask:0xf
  s_nop 1
  v_add_f32_dpp v6, v42, v6 quad_perm:[2,2,2,2] row_mask:0xf bank_mask:0xf
  s_nop 1
  v_add_f32_dpp v6, v43, v6 quad_perm:[3,3,3,3] row_mask:0xf bank_mask:0xf
  v_cvt_pk_bf16_f32 v0, v6, v6
  v_and_b32 v6, s95, v0
  v_mul_f32 v6, s94, v6
  v_cvt_pk_bf16_f32 v0, v6, v6
  v_and_b32 v6, s95, v0
  s_nop 1
  v_max_f32_dpp v14, v6, v6 row_ror:4 row_mask:0xf bank_mask:0xf
  s_nop 1
  v_max_f32_dpp v14, v14, v14 row_ror:8 row_mask:0xf bank_mask:0xf
  s_nop 1
  v_max_f32_dpp v14, v14, v14 row_bcast:15 row_mask:0xa bank_mask:0xf
  s_nop 1
  v_max_f32_dpp v14, v14, v14 row_bcast:31 row_mask:0xc bank_mask:0xf
  v_mul_f32 v14, 0xbfb8aa3b, v14
  s_nop 0
  v_readlane_b32 s56, v14, 63
  s_nop 1
  v_min_f32 v15, s56, v8
  v_sub_f32 v14, v15, v8
  v_mov_b32 v8, v15
  v_fmamk_f32 v6, v6, 0x3fb8aa3b, v8
  v_exp_f32 v6, v6
  v_exp_f32 v14, v14
  s_nop 0
  v_fma_f32 v9, v14, v9, v6
  v_cvt_pk_bf16_f32 v6, v6, v6
  v_mul_f32 v52, v14, v52
  v_mul_f32 v53, v14, v53
  v_mul_f32 v54, v14, v54
  v_mul_f32 v55, v14, v55
  v_and_b32 v60, v6, v32
  v_and_b32 v61, v6, v33
  v_and_b32_dpp v62, v6, v34 row_half_mirror row_mask:0xf bank_mask:0xf
  v_and_b32_dpp v63, v6, v35 row_half_mirror row_mask:0xf bank_mask:0xf
  v_mul_f32 v56, v14, v56
  v_mul_f32 v57, v14, v57
  s_waitcnt lgkmcnt(0)
  v_mfma_f32_16x16x32_bf16 v[52:55], v[44:47], v[60:63], v[52:55]
  v_mul_f32 v58, v14, v58
  v_mul_f32 v59, v14, v59
  v_add_f32_dpp v9, v9, v9 row_ror:4 row_mask:0xf bank_mask:0xf
  v_and_b32_dpp v40, v6, v32 row_half_mirror row_mask:0xf bank_mask:0xf
  v_and_b32_dpp v41, v6, v33 row_half_mirror row_mask:0xf bank_mask:0xf
  v_mfma_f32_16x16x32_bf16 v[56:59], a[116:119], v[60:63], v[56:59]
  v_and_b32 v42, v6, v34
  v_and_b32 v43, v6, v35
  v_add_f32_dpp v9, v9, v9 row_ror:8 row_mask:0xf bank_mask:0xf
  v_mov_b32 v0, s54
  v_mfma_f32_16x16x32_bf16 v[52:55], v[48:51], v[40:43], v[52:55]
  v_add_f32_dpp v9, v9, v9 row_bcast:15 row_mask:0xa bank_mask:0xf
  v_mfma_f32_16x16x32_bf16 v[56:59], a[120:123], v[40:43], v[56:59]
  s_nop 0
  v_add_f32_dpp v9, v9, v9 row_bcast:31 row_mask:0xc bank_mask:0xf
  s_mov_b32 exec_lo, 0
  s_mov_b32 exec_hi, 0x80000000
  ds_write_b64 v0, v[8:9] offset:8192
  s_mov_b64 exec, -1
  v_lshrrev_b32 v0, 1, v2
  v_add_u32 v5, s53, v0
  v_mov_b32 v42, 1
  v_mov_b32 v43, 0
  v_add_f32_dpp v40, v56, v52 row_ror:8 row_mask:0xf bank_mask:0x3
  v_add_f32_dpp v41, v57, v53 row_ror:8 row_mask:0xf bank_mask:0x3
  s_nop 0
  v_add_f32_dpp v40, v54, v58 row_ror:8 row_mask:0xf bank_mask:0xc
  v_add_f32_dpp v41, v55, v59 row_ror:8 row_mask:0xf bank_mask:0xc
  ds_write_b64 v5, v[40:41] offset:0
  s_mov_b64 exec, 1
  ds_add_rtn_u32 v42, v43, v42 offset:8320
  s_mov_b64 exec, -1
  ds_read_b128 v[16:19], v43 offset:8192
  ds_read_b128 v[20:23], v43 offset:8208
  ds_read_b64 v[24:25], v0 offset:0
  ds_read_b64 v[26:27], v0 offset:512
  ds_read_b64 v[28:29], v0 offset:1024
  ds_read_b64 v[30:31], v0 offset:1536
  s_waitcnt lgkmcnt(4)
  v_readfirstlane_b32 s56, v42
  v_min3_f32 v44, v16, v18, v20
  s_and_b32 s56, s56, 3
  s_cmp_lg_u32 s56, 3
  s_cbranch_scc1 Lpubnot_13
  v_min_f32 v44, v44, v22
  v_sub_f32 v16, v44, v16
  v_sub_f32 v18, v44, v18
  v_sub_f32 v20, v44, v20
  v_sub_f32 v22, v44, v22
  v_exp_f32 v16, v16
  v_exp_f32 v18, v18
  v_exp_f32 v20, v20
  v_exp_f32 v22, v22
  s_waitcnt lgkmcnt(0)
  v_mul_f32 v40, v16, v24
  v_mul_f32 v41, v16, v25
  v_mul_f32 v45, v16, v17
  v_fmac_f32 v40, v18, v26
  v_fmac_f32 v41, v18, v27
  v_fmac_f32 v45, v18, v19
  v_fmac_f32 v40, v20, v28
  v_fmac_f32 v41, v20, v29
  v_fmac_f32 v45, v20, v21
  v_fmac_f32 v40, v22, v30
  v_fmac_f32 v41, v22, v31
  v_fmac_f32 v45, v22, v23
  s_add_u32 s56, s36, s55
  s_cmp_eq_u32 s32, 0
  s_cbranch_scc1 Lpubnl_14
  buffer_store_dwordx2 v[40:41], v0, s[20:23], s36 offen
  s_mov_b64 exec, 1
  buffer_store_dwordx2 v[44:45], off, s[20:23], s56
  s_mov_b64 exec, -1
  s_branch Lpubdone_12
Lpubnl_14:
  buffer_store_dwordx2 v[40:41], v0, s[20:23], s36 offen sc1
  s_mov_b64 exec, 1
  buffer_store_dwordx2 v[44:45], off, s[20:23], s56 sc1
  s_mov_b64 exec, -1
  s_branch Lpubdone_12
Lpubnot_13:
  v_mov_b32 v0, 0x7ffffff0
  s_mov_b64 exec, 1
  buffer_store_dword v0, v0, s[20:23], 0 offen
  buffer_store_dword v0, v0, s[20:23], 0 offen
  s_mov_b64 exec, -1
  s_waitcnt lgkmcnt(0)
Lpubdone_12:
  s_add_u32 s36, s36, 131072
  s_mov_b32 s30, 1
  s_waitcnt vmcnt(9)
  s_add_u32 s29, s28, s50
  buffer_load_dwordx4 a[128:131], v1, s[4:7], s29 offen offset:0 nt
  s_waitcnt vmcnt(9)
  buffer_load_dwordx4 a[132:135], v1, s[4:7], s29 offen offset:1024 nt
  s_waitcnt vmcnt(9)
  buffer_load_dwordx4 a[136:139], v1, s[4:7], s29 offen offset:2048 nt
  s_waitcnt vmcnt(9)
  buffer_load_dwordx4 a[140:143], v1, s[4:7], s29 offen offset:3072 nt
  s_waitcnt vmcnt(9)
  s_add_u32 s29, s28, s51
  buffer_load_dwordx4 a[144:147], v1, s[4:7], s29 offen offset:0 nt
  s_waitcnt vmcnt(9)
  buffer_load_dwordx4 a[148:151], v1, s[4:7], s29 offen offset:1024 nt
  v_mov_b32 v0, 0x7ffffff0
  s_mov_b64 exec, 1
  buffer_store_dword v0, v0, s[20:23], 0 offen
  buffer_store_dword v0, v0, s[20:23], 0 offen
  s_mov_b64 exec, -1
  s_branch Lmainpost1
Lmain1:
  s_nop 7
  s_cmp_lg_u32 s52, 0
  s_cselect_b64 vcc, -1, 0
  v_max3_f32 v202, v192, v193, v194
  v_max3_f32 v205, v195, v196, v197
  v_max3_f32 v202, v202, v198, v199
  v_max3_f32 v205, v205, v200, v201
  v_max_f32 v202, v202, v205
  s_nop 1
  v_max_f32_dpp v202, v202, v202 row_ror:4 row_mask:0xf bank_mask:0xf
  s_nop 1
  v_max_f32_dpp v202, v202, v202 row_ror:8 row_mask:0xf bank_mask:0xf
  s_nop 1
  v_max_f32_dpp v202, v202, v202 row_bcast:15 row_mask:0xa bank_mask:0xf
  s_nop 1
  v_max_f32_dpp v202, v202, v202 row_bcast:31 row_mask:0xc bank_mask:0xf
  v_mul_f32 v202, 0xbe0293ee, v202
  s_nop 0
  v_readlane_b32 s56, v202, 63
  s_nop 1
  v_mov_b32 v202, s56
  v_fmamk_f32 v192, v192, 0x3e0293ee, v202
  v_exp_f32 v192, v192
  s_nop 0
  v_mov_b32 v203, v192
  v_cvt_pk_bf16_f32 v192, v192, v192
  v_and_b32 v216, v192, v32
  v_and_b32 v217, v192, v33
  v_and_b32_dpp v218, v192, v34 row_half_mirror row_mask:0xf bank_mask:0xf
  v_and_b32_dpp v219, v192, v35 row_half_mirror row_mask:0xf bank_mask:0xf
  v_fmamk_f32 v193, v193, 0x3e0293ee, v202
  v_exp_f32 v193, v193
  s_nop 0
  v_add_f32 v203, v203, v193
  v_cvt_pk_bf16_f32 v193, v193, v193
  s_waitcnt lgkmcnt(7)
  v_mfma_f32_16x16x32_bf16 v[208:211], v[224:227], v[216:219], 0
  v_and_b32_dpp v220, v192, v32 row_half_mirror row_mask:0xf bank_mask:0xf
  v_and_b32_dpp v221, v192, v33 row_half_mirror row_mask:0xf bank_mask:0xf
  v_mfma_f32_16x16x32_bf16 v[212:215], a[180:183], v[216:219], 0
  v_and_b32 v222, v192, v34
  v_and_b32 v223, v192, v35
  ds_read_b128 v[224:227], v4 offset:26624
  s_waitcnt vmcnt(9)
  s_add_u32 s29, s28, s50
  buffer_load_dwordx4 a[128:131], v1, s[4:7], s29 offen offset:0 nt
  s_waitcnt lgkmcnt(7)
  v_mfma_f32_16x16x32_bf16 v[208:211], v[228:231], v[220:223], v[208:211]
  v_and_b32 v216, v193, v32
  v_and_b32 v217, v193, v33
  v_mfma_f32_16x16x32_bf16 v[212:215], a[184:187], v[220:223], v[212:215]
  v_and_b32_dpp v218, v193, v34 row_half_mirror row_mask:0xf bank_mask:0xf
  v_and_b32_dpp v219, v193, v35 row_half_mirror row_mask:0xf bank_mask:0xf
  ds_read_b128 v[228:231], v4 offset:27648
  v_fmamk_f32 v194, v194, 0x3e0293ee, v202
  v_exp_f32 v194, v194
  s_nop 0
  v_add_f32 v203, v203, v194
  v_cvt_pk_bf16_f32 v194, v194, v194
  s_waitcnt lgkmcnt(7)
  v_mfma_f32_16x16x32_bf16 v[208:211], v[232:235], v[216:219], v[208:211]
  v_and_b32_dpp v220, v193, v32 row_half_mirror row_mask:0xf bank_mask:0xf
  v_and_b32_dpp v221, v193, v33 row_half_mirror row_mask:0xf bank_mask:0xf
  v_mfma_f32_16x16x32_bf16 v[212:215], a[188:191], v[216:219], v[212:215]
  v_and_b32 v222, v193, v34
  v_and_b32 v223, v193, v35
  ds_read_b128 v[232:235], v4 offset:28672
  s_waitcnt lgkmcnt(7)
  v_mfma_f32_16x16x32_bf16 v[208:211], v[236:239], v[220:223], v[208:211]
  v_and_b32 v216, v194, v32
  v_and_b32 v217, v194, v33
  v_mfma_f32_16x16x32_bf16 v[212:215], a[192:195], v[220:223], v[212:215]
  v_and_b32_dpp v218, v194, v34 row_half_mirror row_mask:0xf bank_mask:0xf
  v_and_b32_dpp v219, v194, v35 row_half_mirror row_mask:0xf bank_mask:0xf
  ds_read_b128 v[236:239], v4 offset:29696
  s_waitcnt vmcnt(9)
  buffer_load_dwordx4 a[132:135], v1, s[4:7], s29 offen offset:1024 nt
  v_fmamk_f32 v195, v195, 0x3e0293ee, v202
  v_exp_f32 v195, v195
  s_nop 0
  v_add_f32 v203, v203, v195
  v_cvt_pk_bf16_f32 v195, v195, v195
  s_waitcnt lgkmcnt(7)
  v_mfma_f32_16x16x32_bf16 v[208:211], v[240:243], v[216:219], v[208:211]
  v_and_b32_dpp v220, v194, v32 row_half_mirror row_mask:0xf bank_mask:0xf
  v_and_b32_dpp v221, v194, v33 row_half_mirror row_mask:0xf bank_mask:0xf
  v_mfma_f32_16x16x32_bf16 v[212:215], a[196:199], v[216:219], v[212:215]
  v_and_b32 v222, v194, v34
  v_and_b32 v223, v194, v35
  ds_read_b128 v[240:243], v4 offset:30720
  s_waitcnt lgkmcnt(7)
  v_mfma_f32_16x16x32_bf16 v[208:211], v[244:247], v[220:223], v[208:211]
  v_and_b32 v216, v195, v32
  v_and_b32 v217, v195, v33
  v_mfma_f32_16x16x32_bf16 v[212:215], a[200:203], v[220:223], v[212:215]
  v_and_b32_dpp v218, v195, v34 row_half_mirror row_mask:0xf bank_mask:0xf
  v_and_b32_dpp v219, v195, v35 row_half_mirror row_mask:0xf bank_mask:0xf
  ds_read_b128 v[244:247], v4 offset:31744
  v_fmamk_f32 v196, v196, 0x3e0293ee, v202
  v_exp_f32 v196, v196
  s_nop 0
  v_add_f32 v203, v203, v196
  v_cvt_pk_bf16_f32 v196, v196, v196
  s_waitcnt lgkmcnt(7)
  v_mfma_f32_16x16x32_bf16 v[208:211], v[248:251], v[216:219], v[208:211]
  v_and_b32_dpp v220, v195, v32 row_half_mirror row_mask:0xf bank_mask:0xf
  v_and_b32_dpp v221, v195, v33 row_half_mirror row_mask:0xf bank_mask:0xf
  v_mfma_f32_16x16x32_bf16 v[212:215], a[204:207], v[216:219], v[212:215]
  v_and_b32 v222, v195, v34
  v_and_b32 v223, v195, v35
  ds_read_b128 v[248:251], v4 offset:32768
  s_waitcnt lgkmcnt(7)
  v_mfma_f32_16x16x32_bf16 v[208:211], v[252:255], v[220:223], v[208:211]
  v_and_b32 v216, v196, v32
  v_and_b32 v217, v196, v33
  v_mfma_f32_16x16x32_bf16 v[212:215], a[208:211], v[220:223], v[212:215]
  v_and_b32_dpp v218, v196, v34 row_half_mirror row_mask:0xf bank_mask:0xf
  v_and_b32_dpp v219, v196, v35 row_half_mirror row_mask:0xf bank_mask:0xf
  ds_read_b128 v[252:255], v4 offset:33792
  s_waitcnt vmcnt(9)
  buffer_load_dwordx4 a[136:139], v1, s[4:7], s29 offen offset:2048 nt
  v_fmamk_f32 v197, v197, 0x3e0293ee, v202
  v_exp_f32 v197, v197
  s_nop 0
  v_add_f32 v203, v203, v197
  v_cvt_pk_bf16_f32 v197, v197, v197
  s_waitcnt lgkmcnt(7)
  v_mfma_f32_16x16x32_bf16 v[208:211], v[224:227], v[216:219], v[208:211]
  v_and_b32_dpp v220, v196, v32 row_half_mirror row_mask:0xf bank_mask:0xf
  v_and_b32_dpp v221, v196, v33 row_half_mirror row_mask:0xf bank_mask:0xf
  v_mfma_f32_16x16x32_bf16 v[212:215], a[212:215], v[216:219], v[212:215]
  v_and_b32 v222, v196, v34
  v_and_b32 v223, v196, v35
  ds_read_b128 v[224:227], v4 offset:34816
  s_waitcnt lgkmcnt(7)
  v_mfma_f32_16x16x32_bf16 v[208:211], v[228:231], v[220:223], v[208:211]
  v_and_b32 v216, v197, v32
  v_and_b32 v217, v197, v33
  v_mfma_f32_16x16x32_bf16 v[212:215], a[216:219], v[220:223], v[212:215]
  v_and_b32_dpp v218, v197, v34 row_half_mirror row_mask:0xf bank_mask:0xf
  v_and_b32_dpp v219, v197, v35 row_half_mirror row_mask:0xf bank_mask:0xf
  ds_read_b128 v[228:231], v4 offset:35840
  v_fmamk_f32 v198, v198, 0x3e0293ee, v202
  v_exp_f32 v198, v198
  s_nop 0
  v_add_f32 v203, v203, v198
  v_cvt_pk_bf16_f32 v198, v198, v198
  s_waitcnt lgkmcnt(7)
  v_mfma_f32_16x16x32_bf16 v[208:211], v[232:235], v[216:219], v[208:211]
  v_and_b32_dpp v220, v197, v32 row_half_mirror row_mask:0xf bank_mask:0xf
  v_and_b32_dpp v221, v197, v33 row_half_mirror row_mask:0xf bank_mask:0xf
  v_mfma_f32_16x16x32_bf16 v[212:215], a[220:223], v[216:219], v[212:215]
  v_and_b32 v222, v197, v34
  v_and_b32 v223, v197, v35
  s_waitcnt vmcnt(9)
  buffer_load_dwordx4 a[140:143], v1, s[4:7], s29 offen offset:3072 nt
  s_waitcnt lgkmcnt(6)
  v_mfma_f32_16x16x32_bf16 v[208:211], v[236:239], v[220:223], v[208:211]
  v_and_b32 v216, v198, v32
  v_and_b32 v217, v198, v33
  v_mfma_f32_16x16x32_bf16 v[212:215], a[224:227], v[220:223], v[212:215]
  v_and_b32_dpp v218, v198, v34 row_half_mirror row_mask:0xf bank_mask:0xf
  v_and_b32_dpp v219, v198, v35 row_half_mirror row_mask:0xf bank_mask:0xf
  v_fmamk_f32 v199, v199, 0x3e0293ee, v202
  v_exp_f32 v199, v199
  s_nop 0
  v_add_f32 v203, v203, v199
  v_cvt_pk_bf16_f32 v199, v199, v199
  s_waitcnt lgkmcnt(5)
  v_mfma_f32_16x16x32_bf16 v[208:211], v[240:243], v[216:219], v[208:211]
  v_and_b32_dpp v220, v198, v32 row_half_mirror row_mask:0xf bank_mask:0xf
  v_and_b32_dpp v221, v198, v33 row_half_mirror row_mask:0xf bank_mask:0xf
  v_mfma_f32_16x16x32_bf16 v[212:215], a[228:231], v[216:219], v[212:215]
  v_and_b32 v222, v198, v34
  v_and_b32 v223, v198, v35
  s_waitcnt lgkmcnt(4)
  s_nop 0
  v_mfma_f32_16x16x32_bf16 v[208:211], v[244:247], v[220:223], v[208:211]
  v_and_b32 v216, v199, v32
  v_and_b32 v217, v199, v33
  v_mfma_f32_16x16x32_bf16 v[212:215], a[232:235], v[220:223], v[212:215]
  v_and_b32_dpp v218, v199, v34 row_half_mirror row_mask:0xf bank_mask:0xf
  v_and_b32_dpp v219, v199, v35 row_half_mirror row_mask:0xf bank_mask:0xf
  v_fmamk_f32 v200, v200, 0x3e0293ee, v202
  v_exp_f32 v200, v200
  s_nop 0
  v_add_f32 v203, v203, v200
  v_cvt_pk_bf16_f32 v200, v200, v200
  s_waitcnt lgkmcnt(3)
  v_mfma_f32_16x16x32_bf16 v[208:211], v[248:251], v[216:219], v[208:211]
  v_and_b32_dpp v220, v199, v32 row_half_mirror row_mask:0xf bank_mask:0xf
  v_and_b32_dpp v221, v199, v33 row_half_mirror row_mask:0xf bank_mask:0xf
  v_mfma_f32_16x16x32_bf16 v[212:215], a[236:239], v[216:219], v[212:215]
  v_and_b32 v222, v199, v34
  v_and_b32 v223, v199, v35
  s_waitcnt vmcnt(9)
  s_add_u32 s29, s28, s51
  buffer_load_dwordx4 a[144:147], v1, s[4:7], s29 offen offset:0 nt
  s_waitcnt lgkmcnt(2)
  v_mfma_f32_16x16x32_bf16 v[208:211], v[252:255], v[220:223], v[208:211]
  v_and_b32 v216, v200, v32
  v_and_b32 v217, v200, v33
  v_mfma_f32_16x16x32_bf16 v[212:215], a[240:243], v[220:223], v[212:215]
  v_and_b32_dpp v218, v200, v34 row_half_mirror row_mask:0xf bank_mask:0xf
  v_and_b32_dpp v219, v200, v35 row_half_mirror row_mask:0xf bank_mask:0xf
  v_fmamk_f32 v201, v201, 0x3e0293ee, v202
  v_exp_f32 v201, v201
  s_nop 0
  v_add_f32 v203, v203, v201
  v_cvt_pk_bf16_f32 v201, v201, v201
  s_waitcnt lgkmcnt(1)
  v_mfma_f32_16x16x32_bf16 v[208:211], v[224:227], v[216:219], v[208:211]
  v_and_b32_dpp v220, v200, v32 row_half_mirror row_mask:0xf bank_mask:0xf
  v_and_b32_dpp v221, v200, v33 row_half_mirror row_mask:0xf bank_mask:0xf
  v_mfma_f32_16x16x32_bf16 v[212:215], a[244:247], v[216:219], v[212:215]
  v_and_b32 v222, v200, v34
  v_and_b32 v223, v200, v35
  s_waitcnt lgkmcnt(0)
  s_nop 0
  v_mfma_f32_16x16x32_bf16 v[208:211], v[228:231], v[220:223], v[208:211]
  v_and_b32 v216, v201, v32
  v_and_b32 v217, v201, v33
  v_mfma_f32_16x16x32_bf16 v[212:215], a[248:251], v[220:223], v[212:215]
  v_and_b32_dpp v218, v201, v34 row_half_mirror row_mask:0xf bank_mask:0xf
  v_and_b32_dpp v219, v201, v35 row_half_mirror row_mask:0xf bank_mask:0xf
  s_nop 1
  v_mfma_f32_16x16x32_bf16 v[208:211], a[252:255], v[216:219], v[208:211]
  v_add_f32_dpp v203, v203, v203 row_ror:4 row_mask:0xf bank_mask:0xf
  s_nop 1
  v_add_f32_dpp v203, v203, v203 row_ror:8 row_mask:0xf bank_mask:0xf
  s_nop 1
  v_add_f32_dpp v203, v203, v203 row_bcast:15 row_mask:0xa bank_mask:0xf
  s_nop 1
  v_add_f32_dpp v203, v203, v203 row_bcast:31 row_mask:0xc bank_mask:0xf
  v_mov_b32 v0, s54
  s_mov_b32 exec_lo, 0
  s_mov_b32 exec_hi, 0x80000000
  ds_write_b64 v0, v[202:203] offset:8288
  s_mov_b64 exec, -1
  s_waitcnt vmcnt(9)
  buffer_load_dwordx4 a[148:151], v1, s[4:7], s29 offen offset:1024 nt
  v_lshrrev_b32 v0, 1, v2
  v_add_u32 v5, s53, v0
  v_mov_b32 v42, 1
  v_mov_b32 v43, 0
  v_add_f32_dpp v40, v212, v208 row_ror:8 row_mask:0xf bank_mask:0x3
  v_add_f32_dpp v41, v213, v209 row_ror:8 row_mask:0xf bank_mask:0x3
  s_nop 0
  v_add_f32_dpp v40, v210, v214 row_ror:8 row_mask:0xf bank_mask:0xc
  v_add_f32_dpp v41, v211, v215 row_ror:8 row_mask:0xf bank_mask:0xc
  ds_write_b64 v5, v[40:41] offset:6144
  s_mov_b64 exec, 1
  ds_add_rtn_u32 v42, v43, v42 offset:8332
  s_mov_b64 exec, -1
  ds_read_b128 v[16:19], v43 offset:8288
  ds_read_b128 v[20:23], v43 offset:8304
  ds_read_b64 v[24:25], v0 offset:6144
  ds_read_b64 v[26:27], v0 offset:6656
  ds_read_b64 v[28:29], v0 offset:7168
  ds_read_b64 v[30:31], v0 offset:7680
  s_waitcnt lgkmcnt(4)
  v_readfirstlane_b32 s56, v42
  v_min3_f32 v44, v16, v18, v20
  s_and_b32 s56, s56, 3
  s_cmp_lg_u32 s56, 3
  s_cbranch_scc1 Lpubnot_16
  v_min_f32 v44, v44, v22
  v_sub_f32 v16, v44, v16
  v_sub_f32 v18, v44, v18
  v_sub_f32 v20, v44, v20
  v_sub_f32 v22, v44, v22
  v_exp_f32 v16, v16
  v_exp_f32 v18, v18
  v_exp_f32 v20, v20
  v_exp_f32 v22, v22
  s_waitcnt lgkmcnt(0)
  v_mul_f32 v40, v16, v24
  v_mul_f32 v41, v16, v25
  v_mul_f32 v45, v16, v17
  v_fmac_f32 v40, v18, v26
  v_fmac_f32 v41, v18, v27
  v_fmac_f32 v45, v18, v19
  v_fmac_f32 v40, v20, v28
  v_fmac_f32 v41, v20, v29
  v_fmac_f32 v45, v20, v21
  v_fmac_f32 v40, v22, v30
  v_fmac_f32 v41, v22, v31
  v_fmac_f32 v45, v22, v23
  s_add_u32 s56, s37, s55
  s_cmp_eq_u32 s32, 0
  s_cbranch_scc1 Lpubnl_17
  buffer_store_dwordx2 v[40:41], v0, s[20:23], s37 offen
  s_mov_b64 exec, 1
  buffer_store_dwordx2 v[44:45], off, s[20:23], s56
  s_mov_b64 exec, -1
  s_branch Lpubdone_15
Lpubnl_17:
  buffer_store_dwordx2 v[40:41], v0, s[20:23], s37 offen sc1
  s_mov_b64 exec, 1
  buffer_store_dwordx2 v[44:45], off, s[20:23], s56 sc1
  s_mov_b64 exec, -1
  s_branch Lpubdone_15
Lpubnot_16:
  v_mov_b32 v0, 0x7ffffff0
  s_mov_b64 exec, 1
  buffer_store_dword v0, v0, s[20:23], 0 offen
  buffer_store_dword v0, v0, s[20:23], 0 offen
  s_mov_b64 exec, -1
  s_waitcnt lgkmcnt(0)
Lpubdone_15:
  s_add_u32 s37, s37, 131072
Lmainpost1:
  s_nop 7
  s_branch Lqchk_20
Lqw_18:
  s_sub_u32 s33, s33, 1
  s_cbranch_scc1 Lend
  buffer_load_dwordx4 v[36:39], v3, s[20:23], s35 offen sc1
  s_waitcnt vmcnt(0)
Lqchk_20:
  v_max3_u32 v0, v36, v37, v38
  v_max_u32 v0, v0, v39
  v_cmp_eq_u32 vcc, -1, v0
  s_cbranch_vccnz Lqw_18
  s_cmp_lg_u32 s52, 0
  s_cselect_b64 vcc, -1, 0
  v_cndmask_b32 v16, 0, v36, s[40:41]
  v_cndmask_b32 v17, 0, v37, s[40:41]
  v_cndmask_b32 v18, 0, v38, s[40:41]
  v_cndmask_b32 v19, 0, v39, s[40:41]
  v_cndmask_b32 v20, 0, v36, s[42:43]
  v_cndmask_b32 v21, 0, v37, s[42:43]
  v_cndmask_b32 v22, 0, v38, s[42:43]
  v_cndmask_b32 v23, 0, v39, s[42:43]
  v_cndmask_b32 v24, 0, v36, s[44:45]
  v_cndmask_b32 v25, 0, v37, s[44:45]
  v_cndmask_b32 v26, 0, v38, s[44:45]
  v_cndmask_b32 v27, 0, v39, s[44:45]
  v_cndmask_b32 v28, 0, v36, s[46:47]
  v_cndmask_b32 v29, 0, v37, s[46:47]
  v_cndmask_b32 v30, 0, v38, s[46:47]
  v_cndmask_b32 v31, 0, v39, s[46:47]
  v_mov_b32 v48, -1
  v_mov_b32 v49, -1
  v_bfe_u32 v50, v2, 1, 7
  s_lshr_b32 s56, s53, 2
  v_add_u32 v50, s56, v50
  s_mov_b32 exec_lo, 0
  v_mov_b32 v50, s55
  s_mov_b32 exec_lo, 0xffff0000
  s_mov_b32 exec_hi, 2
  v_add_u32 v50, 917504, v50
  s_mov_b32 exec_lo, -1
  s_mov_b32 exec_hi, 3
  s_add_u32 s56, s36, 131072
  s_cmp_eq_u32 s32, 0
  s_cbranch_scc1 Lnl_21
  buffer_store_dwordx2 v[48:49], v50, s[20:23], s56 offen
  s_branch Ldn_22
Lnl_21:
  buffer_store_dwordx2 v[48:49], v50, s[20:23], s56 offen sc1
Ldn_22:
  s_mov_b64 exec, -1
  s_waitcnt vmcnt(12)
  s_add_u32 s29, s28, s51
  buffer_load_dwordx4 a[152:155], v1, s[4:7], s29 offen offset:2048 nt
  v_mfma_f32_16x16x32_bf16 v[40:43], v[160:163], v[16:19], 0
  v_mfma_f32_16x16x32_bf16 v[40:43], v[164:167], v[24:27], v[40:43]
  v_mfma_f32_16x16x32_bf16 v[40:43], v[168:171], v[20:23], v[40:43]
  s_waitcnt vmcnt(12)
  buffer_load_dwordx4 a[156:159], v1, s[4:7], s29 offen offset:3072 nt
  v_mfma_f32_16x16x32_bf16 v[40:43], v[172:175], v[28:31], v[40:43]
  s_nop 7
  v_mov_b32_dpp v6, v40 quad_perm:[0,0,0,0] row_mask:0xf bank_mask:0xf
  s_nop 1
  v_add_f32_dpp v6, v41, v6 quad_perm:[1,1,1,1] row_mask:0xf bank_mask:0xf
  s_nop 1
  v_add_f32_dpp v6, v42, v6 quad_perm:[2,2,2,2] row_mask:0xf bank_mask:0xf
  s_nop 1
  v_add_f32_dpp v6, v43, v6 quad_perm:[3,3,3,3] row_mask:0xf bank_mask:0xf
  v_mfma_f32_16x16x32_bf16 v[40:43], v[176:179], v[16:19], 0
  v_mfma_f32_16x16x32_bf16 v[40:43], v[180:183], v[24:27], v[40:43]
  s_waitcnt vmcnt(10)
  s_add_u32 s29, s28, s64
  buffer_load_dwordx4 a[160:163], v1, s[4:7], s29 offen offset:0 nt
  v_mfma_f32_16x16x32_bf16 v[40:43], v[184:187], v[20:23], v[40:43]
  v_mfma_f32_16x16x32_bf16 v[40:43], v[188:191], v[28:31], v[40:43]
  s_nop 7
  v_mov_b32_dpp v7, v40 quad_perm:[0,0,0,0] row_mask:0xf bank_mask:0xf
  s_nop 1
  v_add_f32_dpp v7, v41, v7 quad_perm:[1,1,1,1] row_mask:0xf bank_mask:0xf
  s_nop 1
  v_add_f32_dpp v7, v42, v7 quad_perm:[2,2,2,2] row_mask:0xf bank_mask:0xf
  s_nop 1
  v_add_f32_dpp v7, v43, v7 quad_perm:[3,3,3,3] row_mask:0xf bank_mask:0xf
  v_cvt_pk_bf16_f32 v0, v6, v7
  v_lshlrev_b32 v6, 16, v0
  v_and_b32 v7, s95, v0
  v_mul_f32 v6, s94, v6
  v_mul_f32 v7, s94, v7
  v_cvt_pk_bf16_f32 v0, v6, v7
  v_lshlrev_b32 v6, 16, v0
  v_and_b32 v7, s95, v0
  v_mfma_f32_16x16x32_bf16 v[40:43], a[128:131], v[16:19], 0
  s_waitcnt vmcnt(10)
  buffer_load_dwordx4 a[164:167], v1, s[4:7], s29 offen offset:1024 nt
  v_mfma_f32_16x16x32_bf16 v[40:43], a[132:135], v[24:27], v[40:43]
  s_waitcnt vmcnt(10)
  buffer_load_dwordx4 a[168:171], v1, s[4:7], s29 offen offset:2048 nt
  v_mfma_f32_16x16x32_bf16 v[40:43], a[136:139], v[20:23], v[40:43]
  s_waitcnt vmcnt(10)
  buffer_load_dwordx4 a[172:175], v1, s[4:7], s29 offen offset:3072 nt
  v_mfma_f32_16x16x32_bf16 v[40:43], a[140:143], v[28:31], v[40:43]
  s_nop 7
  v_mov_b32_dpp v8, v40 quad_perm:[0,0,0,0] row_mask:0xf bank_mask:0xf
  s_nop 1
  v_add_f32_dpp v8, v41, v8 quad_perm:[1,1,1,1] row_mask:0xf bank_mask:0xf
  s_nop 1
  v_add_f32_dpp v8, v42, v8 quad_perm:[2,2,2,2] row_mask:0xf bank_mask:0xf
  s_nop 1
  v_add_f32_dpp v8, v43, v8 quad_perm:[3,3,3,3] row_mask:0xf bank_mask:0xf
  s_waitcnt vmcnt(10)
  s_add_u32 s29, s28, s65
  buffer_load_dwordx4 v[192:195], v1, s[4:7], s29 offen offset:0 nt
  v_mfma_f32_16x16x32_bf16 v[40:43], a[144:147], v[16:19], 0
  s_waitcnt vmcnt(10)
  buffer_load_dwordx4 v[196:199], v1, s[4:7], s29 offen offset:1024 nt
  v_mfma_f32_16x16x32_bf16 v[40:43], a[148:151], v[24:27], v[40:43]
  s_waitcnt vmcnt(7)
  buffer_load_dwordx4 v[200:203], v1, s[4:7], s29 offen offset:2048 nt
  v_mfma_f32_16x16x32_bf16 v[40:43], a[152:155], v[20:23], v[40:43]
  s_waitcnt vmcnt(7)
  buffer_load_dwordx4 v[204:207], v1, s[4:7], s29 offen offset:3072 nt
  v_mfma_f32_16x16x32_bf16 v[40:43], a[156:159], v[28:31], v[40:43]
  s_nop 7
  v_mov_b32_dpp v9, v40 quad_perm:[0,0,0,0] row_mask:0xf bank_mask:0xf
  s_nop 1
  v_add_f32_dpp v9, v41, v9 quad_perm:[1,1,1,1] row_mask:0xf bank_mask:0xf
  s_nop 1
  v_add_f32_dpp v9, v42, v9 quad_perm:[2,2,2,2] row_mask:0xf bank_mask:0xf
  s_nop 1
  v_add_f32_dpp v9, v43, v9 quad_perm:[3,3,3,3] row_mask:0xf bank_mask:0xf
  v_cvt_pk_bf16_f32 v0, v8, v9
  v_lshlrev_b32 v8, 16, v0
  v_and_b32 v9, s95, v0
  v_mul_f32 v8, s94, v8
  v_mul_f32 v9, s94, v9
  v_cvt_pk_bf16_f32 v0, v8, v9
  v_lshlrev_b32 v8, 16, v0
  v_and_b32 v9, s95, v0
  s_waitcnt vmcnt(7)
  s_add_u32 s29, s28, s66
  buffer_load_dwordx4 v[208:211], v1, s[4:7], s29 offen offset:0 nt
  v_mfma_f32_16x16x32_bf16 v[40:43], a[160:163], v[16:19], 0
  s_waitcnt vmcnt(7)
  buffer_load_dwordx4 v[212:215], v1, s[4:7], s29 offen offset:1024 nt
  v_mfma_f32_16x16x32_bf16 v[40:43], a[164:167], v[24:27], v[40:43]
  s_waitcnt vmcnt(7)
  buffer_load_dwordx4 v[216:219], v1, s[4:7], s29 offen offset:2048 nt
  v_mfma_f32_16x16x32_bf16 v[40:43], a[168:171], v[20:23], v[40:43]
  s_waitcnt vmcnt(7)
  buffer_load_dwordx4 v[220:223], v1, s[4:7], s29 offen offset:3072 nt
  v_mfma_f32_16x16x32_bf16 v[40:43], a[172:175], v[28:31], v[40:43]
  s_nop 7
  v_mov_b32_dpp v10, v40 quad_perm:[0,0,0,0] row_mask:0xf bank_mask:0xf
  s_nop 1
  v_add_f32_dpp v10, v41, v10 quad_perm:[1,1,1,1] row_mask:0xf bank_mask:0xf
  s_nop 1
  v_add_f32_dpp v10, v42, v10 quad_perm:[2,2,2,2] row_mask:0xf bank_mask:0xf
  s_nop 1
  v_add_f32_dpp v10, v43, v10 quad_perm:[3,3,3,3] row_mask:0xf bank_mask:0xf
  s_waitcnt vmcnt(7)
  s_add_u32 s29, s28, s67
  buffer_load_dwordx4 v[224:227], v1, s[4:7], s29 offen offset:0 nt
  v_mfma_f32_16x16x32_bf16 v[40:43], v[192:195], v[16:19], 0
  s_waitcnt vmcnt(7)
  buffer_load_dwordx4 v[228:231], v1, s[4:7], s29 offen offset:1024 nt
  v_mfma_f32_16x16x32_bf16 v[40:43], v[196:199], v[24:27], v[40:43]
  s_waitcnt vmcnt(7)
  buffer_load_dwordx4 v[232:235], v1, s[4:7], s29 offen offset:2048 nt
  v_mfma_f32_16x16x32_bf16 v[40:43], v[200:203], v[20:23], v[40:43]
  s_waitcnt vmcnt(7)
  buffer_load_dwordx4 v[236:239], v1, s[4:7], s29 offen offset:3072 nt
  v_mfma_f32_16x16x32_bf16 v[40:43], v[204:207], v[28:31], v[40:43]
  s_nop 7
  v_mov_b32_dpp v11, v40 quad_perm:[0,0,0,0] row_mask:0xf bank_mask:0xf
  s_nop 1
  v_add_f32_dpp v11, v41, v11 quad_perm:[1,1,1,1] row_mask:0xf bank_mask:0xf
  s_nop 1
  v_add_f32_dpp v11, v42, v11 quad_perm:[2,2,2,2] row_mask:0xf bank_mask:0xf
  s_nop 1
  v_add_f32_dpp v11, v43, v11 quad_perm:[3,3,3,3] row_mask:0xf bank_mask:0xf
  v_cvt_pk_bf16_f32 v0, v10, v11
  v_lshlrev_b32 v10, 16, v0
  v_and_b32 v11, s95, v0
  v_mul_f32 v10, s94, v10
  v_mul_f32 v11, s94, v11
  v_cvt_pk_bf16_f32 v0, v10, v11
  v_lshlrev_b32 v10, 16, v0
  v_and_b32 v11, s95, v0
  s_waitcnt vmcnt(7)
  s_add_u32 s29, s28, s68
  buffer_load_dwordx4 v[240:243], v1, s[4:7], s29 offen offset:0 nt
  v_mfma_f32_16x16x32_bf16 v[40:43], v[208:211], v[16:19], 0
  s_waitcnt vmcnt(7)
  buffer_load_dwordx4 v[244:247], v1, s[4:7], s29 offen offset:1024 nt
  v_mfma_f32_16x16x32_bf16 v[40:43], v[212:215], v[24:27], v[40:43]
  s_waitcnt vmcnt(7)
  buffer_load_dwordx4 v[248:251], v1, s[4:7], s29 offen offset:2048 nt
  v_mfma_f32_16x16x32_bf16 v[40:43], v[216:219], v[20:23], v[40:43]
  s_waitcnt vmcnt(7)
  buffer_load_dwordx4 v[252:255], v1, s[4:7], s29 offen offset:3072 nt
  v_mfma_f32_16x16x32_bf16 v[40:43], v[220:223], v[28:31], v[40:43]
  s_nop 7
  v_mov_b32_dpp v12, v40 quad_perm:[0,0,0,0] row_mask:0xf bank_mask:0xf
  s_nop 1
  v_add_f32_dpp v12, v41, v12 quad_perm:[1,1,1,1] row_mask:0xf bank_mask:0xf
  s_nop 1
  v_add_f32_dpp v12, v42, v12 quad_perm:[2,2,2,2] row_mask:0xf bank_mask:0xf
  s_nop 1
  v_add_f32_dpp v12, v43, v12 quad_perm:[3,3,3,3] row_mask:0xf bank_mask:0xf
  s_waitcnt vmcnt(7)
  s_add_u32 s29, s28, s69
  buffer_load_dwordx4 a[176:179], v1, s[12:15], s29 offen offset:0 nt
  v_mfma_f32_16x16x32_bf16 v[40:43], v[224:227], v[16:19], 0
  s_waitcnt vmcnt(7)
  s_add_u32 s29, s28, s31
  s_add_u32 m0, s38, 27648
  s_nop 0
  buffer_load_dwordx4 v2, s[8:11], s29 offen offset:0 nt lds
  v_mfma_f32_16x16x32_bf16 v[40:43], v[228:231], v[24:27], v[40:43]
  s_waitcnt vmcnt(7)
  buffer_load_dwordx4 a[180:183], v2, s[8:11], s29 offen offset:1024 nt
  v_mfma_f32_16x16x32_bf16 v[40:43], v[232:235], v[20:23], v[40:43]
  s_waitcnt vmcnt(7)
  s_add_u32 m0, s38, 26624
  s_nop 0
  buffer_load_dwordx4 v2, s[8:11], s29 offen offset:2048 nt lds
  v_mfma_f32_16x16x32_bf16 v[40:43], v[236:239], v[28:31], v[40:43]
  s_nop 7
  v_mov_b32_dpp v13, v40 quad_perm:[0,0,0,0] row_mask:0xf bank_mask:0xf
  s_nop 1
  v_add_f32_dpp v13, v41, v13 quad_perm:[1,1,1,1] row_mask:0xf bank_mask:0xf
  s_nop 1
  v_add_f32_dpp v13, v42, v13 quad_perm:[2,2,2,2] row_mask:0xf bank_mask:0xf
  s_nop 1
  v_add_f32_dpp v13, v43, v13 quad_perm:[3,3,3,3] row_mask:0xf bank_mask:0xf
  v_cvt_pk_bf16_f32 v0, v12, v13
  v_lshlrev_b32 v12, 16, v0
  v_and_b32 v13, s95, v0
  v_mul_f32 v12, s94, v12
  v_mul_f32 v13, s94, v13
  v_cvt_pk_bf16_f32 v0, v12, v13
  v_lshlrev_b32 v12, 16, v0
  v_and_b32 v13, s95, v0
  s_waitcnt vmcnt(7)
  buffer_load_dwordx4 a[184:187], v2, s[8:11], s29 offen offset:3072 nt
  v_mfma_f32_16x16x32_bf16 v[40:43], v[240:243], v[16:19], 0
  s_waitcnt vmcnt(7)
  s_add_u32 s29, s28, s39
  s_add_u32 m0, s38, 29696
  s_nop 0
  buffer_load_dwordx4 v2, s[8:11], s29 offen offset:0 nt lds
  v_mfma_f32_16x16x32_bf16 v[40:43], v[244:247], v[24:27], v[40:43]
  s_waitcnt vmcnt(7)
  buffer_load_dwordx4 a[188:191], v2, s[8:11], s29 offen offset:1024 nt
  v_mfma_f32_16x16x32_bf16 v[40:43], v[248:251], v[20:23], v[40:43]
  s_waitcnt vmcnt(7)
  s_add_u32 m0, s38, 28672
  s_nop 0
  buffer_load_dwordx4 v2, s[8:11], s29 offen offset:2048 nt lds
  v_mfma_f32_16x16x32_bf16 v[40:43], v[252:255], v[28:31], v[40:43]
  s_nop 7
  v_mov_b32_dpp v14, v40 quad_perm:[0,0,0,0] row_mask:0xf bank_mask:0xf
  s_nop 1
  v_add_f32_dpp v14, v41, v14 quad_perm:[1,1,1,1] row_mask:0xf bank_mask:0xf
  s_nop 1
  v_add_f32_dpp v14, v42, v14 quad_perm:[2,2,2,2] row_mask:0xf bank_mask:0xf
  s_nop 1
  v_add_f32_dpp v14, v43, v14 quad_perm:[3,3,3,3] row_mask:0xf bank_mask:0xf
  s_waitcnt vmcnt(7)
  buffer_load_dwordx4 a[192:195], v2, s[8:11], s29 offen offset:3072 nt
  v_mfma_f32_16x16x32_bf16 v[40:43], a[176:179], v[16:19], 0
  s_nop 7
  v_mov_b32_dpp v15, v40 quad_perm:[0,0,0,0] row_mask:0xf bank_mask:0xf
  s_nop 1
  v_add_f32_dpp v15, v41, v15 quad_perm:[1,1,1,1] row_mask:0xf bank_mask:0xf
  s_nop 1
  v_add_f32_dpp v15, v42, v15 quad_perm:[2,2,2,2] row_mask:0xf bank_mask:0xf
  s_nop 1
  v_add_f32_dpp v15, v43, v15 quad_perm:[3,3,3,3] row_mask:0xf bank_mask:0xf
  s_mov_b64 exec, s[48:49]
  v_mov_b32 v15, 0xff800000
  s_mov_b64 exec, -1
  v_cvt_pk_bf16_f32 v0, v14, v15
  v_lshlrev_b32 v14, 16, v0
  v_and_b32 v15, s95, v0
  v_mul_f32 v14, s94, v14
  v_mul_f32 v15, s94, v15
  v_cvt_pk_bf16_f32 v0, v14, v15
  v_lshlrev_b32 v14, 16, v0
  v_and_b32 v15, s95, v0
  v_max3_f32 v44, v6, v7, v8
  v_max3_f32 v46, v9, v10, v11
  v_max3_f32 v44, v44, v12, v13
  v_max3_f32 v46, v46, v14, v15
  v_max_f32 v44, v44, v46
  s_nop 1
  v_max_f32_dpp v44, v44, v44 row_ror:4 row_mask:0xf bank_mask:0xf
  s_nop 1
  v_max_f32_dpp v44, v44, v44 row_ror:8 row_mask:0xf bank_mask:0xf
  s_nop 1
  v_max_f32_dpp v44, v44, v44 row_bcast:15 row_mask:0xa bank_mask:0xf
  s_nop 1
  v_max_f32_dpp v44, v44, v44 row_bcast:31 row_mask:0xc bank_mask:0xf
  v_mul_f32 v44, 0xbfb8aa3b, v44
  s_nop 0
  v_readlane_b32 s56, v44, 63
  s_nop 1
  v_mov_b32 v44, s56
  v_fmamk_f32 v6, v6, 0x3fb8aa3b, v44
  v_fmamk_f32 v7, v7, 0x3fb8aa3b, v44
  v_fmamk_f32 v8, v8, 0x3fb8aa3b, v44
  v_fmamk_f32 v9, v9, 0x3fb8aa3b, v44
  v_fmamk_f32 v10, v10, 0x3fb8aa3b, v44
  v_fmamk_f32 v11, v11, 0x3fb8aa3b, v44
  v_fmamk_f32 v12, v12, 0x3fb8aa3b, v44
  v_fmamk_f32 v13, v13, 0x3fb8aa3b, v44
  v_fmamk_f32 v14, v14, 0x3fb8aa3b, v44
  v_fmamk_f32 v15, v15, 0x3fb8aa3b, v44
  v_exp_f32 v6, v6
  v_exp_f32 v7, v7
  v_exp_f32 v8, v8
  v_exp_f32 v9, v9
  v_exp_f32 v10, v10
  v_exp_f32 v11, v11
  v_exp_f32 v12, v12
  v_exp_f32 v13, v13
  v_exp_f32 v14, v14
  v_exp_f32 v15, v15
  v_mov_b32 v45, v6
  v_add_f32 v45, v45, v7
  v_add_f32 v45, v45, v8
  v_add_f32 v45, v45, v9
  v_add_f32 v45, v45, v10
  v_add_f32 v45, v45, v11
  v_add_f32 v45, v45, v12
  v_add_f32 v45, v45, v13
  v_add_f32 v45, v45, v14
  v_add_f32 v45, v45, v15
  v_cvt_pk_bf16_f32 v6, v6, v6
  v_cvt_pk_bf16_f32 v7, v7, v7
  v_cvt_pk_bf16_f32 v8, v8, v8
  v_cvt_pk_bf16_f32 v9, v9, v9
  v_cvt_pk_bf16_f32 v10, v10, v10
  v_cvt_pk_bf16_f32 v11, v11, v11
  v_cvt_pk_bf16_f32 v12, v12, v12
  v_cvt_pk_bf16_f32 v13, v13, v13
  v_cvt_pk_bf16_f32 v14, v14, v14
  v_cvt_pk_bf16_f32 v15, v15, v15
  v_add_f32_dpp v45, v45, v45 row_ror:4 row_mask:0xf bank_mask:0xf
  s_nop 1
  v_add_f32_dpp v45, v45, v45 row_ror:8 row_mask:0xf bank_mask:0xf
  s_nop 1
  v_add_f32_dpp v45, v45, v45 row_bcast:15 row_mask:0xa bank_mask:0xf
  s_nop 1
  v_add_f32_dpp v45, v45, v45 row_bcast:31 row_mask:0xc bank_mask:0xf
  v_mov_b32 v0, s54
  s_mov_b32 exec_lo, 0
  s_mov_b32 exec_hi, 0x80000000
  ds_write_b64 v0, v[44:45] offset:8224
  s_mov_b64 exec, -1
  s_waitcnt vmcnt(7)
  s_add_u32 s29, s28, s50
  s_add_u32 m0, s38, 31744
  s_nop 0
  buffer_load_dwordx4 v2, s[8:11], s29 offen offset:0 nt lds
  ds_read_b128 v[16:19], v4 offset:18432
  v_and_b32 v60, v6, v32
  v_and_b32 v61, v6, v33
  v_and_b32_dpp v62, v6, v34 row_half_mirror row_mask:0xf bank_mask:0xf
  v_and_b32_dpp v63, v6, v35 row_half_mirror row_mask:0xf bank_mask:0xf
  s_waitcnt lgkmcnt(0)
  s_nop 0
  v_mfma_f32_16x16x32_bf16 v[52:55], v[16:19], v[60:63], 0
  s_waitcnt vmcnt(7)
  buffer_load_dwordx4 a[196:199], v2, s[8:11], s29 offen offset:1024 nt
  v_mfma_f32_16x16x32_bf16 v[56:59], a[180:183], v[60:63], 0
  s_waitcnt vmcnt(7)
  s_add_u32 m0, s38, 30720
  s_nop 0
  buffer_load_dwordx4 v2, s[8:11], s29 offen offset:2048 nt lds
  ds_read_b128 v[16:19], v4 offset:19456
  v_and_b32_dpp v60, v6, v32 row_half_mirror row_mask:0xf bank_mask:0xf
  v_and_b32_dpp v61, v6, v33 row_half_mirror row_mask:0xf bank_mask:0xf
  v_and_b32 v62, v6, v34
  v_and_b32 v63, v6, v35
  s_waitcnt lgkmcnt(0)
  s_nop 0
  v_mfma_f32_16x16x32_bf16 v[52:55], v[16:19], v[60:63], v[52:55]
  s_waitcnt vmcnt(7)
  buffer_load_dwordx4 a[200:203], v2, s[8:11], s29 offen offset:3072 nt
  v_mfma_f32_16x16x32_bf16 v[56:59], a[184:187], v[60:63], v[56:59]
  s_waitcnt vmcnt(7)
  s_add_u32 s29, s28, s51
  s_add_u32 m0, s38, 33792
  s_nop 0
  buffer_load_dwordx4 v2, s[8:11], s29 offen offset:0 nt lds
  ds_read_b128 v[16:19], v4 offset:20480
  v_and_b32 v60, v7, v32
  v_and_b32 v61, v7, v33
  v_and_b32_dpp v62, v7, v34 row_half_mirror row_mask:0xf bank_mask:0xf
  v_and_b32_dpp v63, v7, v35 row_half_mirror row_mask:0xf bank_mask:0xf
  s_waitcnt lgkmcnt(0)
  s_nop 0
  v_mfma_f32_16x16x32_bf16 v[52:55], v[16:19], v[60:63], v[52:55]
  s_waitcnt vmcnt(7)
  buffer_load_dwordx4 a[204:207], v2, s[8:11], s29 offen offset:1024 nt
  v_mfma_f32_16x16x32_bf16 v[56:59], a[188:191], v[60:63], v[56:59]
  s_waitcnt vmcnt(7)
  s_add_u32 m0, s38, 32768
  s_nop 0
  buffer_load_dwordx4 v2, s[8:11], s29 offen offset:2048 nt lds
  ds_read_b128 v[16:19], v4 offset:21504
  v_and_b32_dpp v60, v7, v32 row_half_mirror row_mask:0xf bank_mask:0xf
  v_and_b32_dpp v61, v7, v33 row_half_mirror row_mask:0xf bank_mask:0xf
  v_and_b32 v62, v7, v34
  v_and_b32 v63, v7, v35
  s_waitcnt lgkmcnt(0)
  s_nop 0
  v_mfma_f32_16x16x32_bf16 v[52:55], v[16:19], v[60:63], v[52:55]
  s_waitcnt vmcnt(7)
  buffer_load_dwordx4 a[208:211], v2, s[8:11], s29 offen offset:3072 nt
  v_mfma_f32_16x16x32_bf16 v[56:59], a[192:195], v[60:63], v[56:59]
  s_waitcnt vmcnt(7)
  s_add_u32 s29, s28, s64
  s_add_u32 m0, s38, 35840
  s_nop 0
  buffer_load_dwordx4 v2, s[8:11], s29 offen offset:0 nt lds
  ds_read_b128 v[16:19], v4 offset:22528
  v_and_b32 v60, v8, v32
  v_and_b32 v61, v8, v33
  v_and_b32_dpp v62, v8, v34 row_half_mirror row_mask:0xf bank_mask:0xf
  v_and_b32_dpp v63, v8, v35 row_half_mirror row_mask:0xf bank_mask:0xf
  s_waitcnt lgkmcnt(0)
  s_nop 0
  v_mfma_f32_16x16x32_bf16 v[52:55], v[16:19], v[60:63], v[52:55]
  s_waitcnt vmcnt(7)
  buffer_load_dwordx4 a[212:215], v2, s[8:11], s29 offen offset:1024 nt
  v_mfma_f32_16x16x32_bf16 v[56:59], a[196:199], v[60:63], v[56:59]
  s_waitcnt vmcnt(7)
  s_add_u32 m0, s38, 34816
  s_nop 0
  buffer_load_dwordx4 v2, s[8:11], s29 offen offset:2048 nt lds
  ds_read_b128 v[16:19], v4 offset:23552
  v_and_b32_dpp v60, v8, v32 row_half_mirror row_mask:0xf bank_mask:0xf
  v_and_b32_dpp v61, v8, v33 row_half_mirror row_mask:0xf bank_mask:0xf
  v_and_b32 v62, v8, v34
  v_and_b32 v63, v8, v35
  s_waitcnt lgkmcnt(0)
  s_nop 0
  v_mfma_f32_16x16x32_bf16 v[52:55], v[16:19], v[60:63], v[52:55]
  s_waitcnt vmcnt(7)
  buffer_load_dwordx4 a[216:219], v2, s[8:11], s29 offen offset:3072 nt
  v_mfma_f32_16x16x32_bf16 v[56:59], a[200:203], v[60:63], v[56:59]
  s_waitcnt vmcnt(7)
  s_add_u32 s29, s28, s65
  s_add_u32 m0, s38, 37888
  s_nop 0
  buffer_load_dwordx4 v2, s[8:11], s29 offen offset:0 nt lds
  ds_read_b128 v[16:19], v4 offset:24576
  v_and_b32 v60, v9, v32
  v_and_b32 v61, v9, v33
  v_and_b32_dpp v62, v9, v34 row_half_mirror row_mask:0xf bank_mask:0xf
  v_and_b32_dpp v63, v9, v35 row_half_mirror row_mask:0xf bank_mask:0xf
  s_waitcnt lgkmcnt(0)
  s_nop 0
  v_mfma_f32_16x16x32_bf16 v[52:55], v[16:19], v[60:63], v[52:55]
  s_waitcnt vmcnt(7)
  buffer_load_dwordx4 a[220:223], v2, s[8:11], s29 offen offset:1024 nt
  v_mfma_f32_16x16x32_bf16 v[56:59], a[204:207], v[60:63], v[56:59]
  s_waitcnt vmcnt(7)
  s_add_u32 m0, s38, 36864
  s_nop 0
  buffer_load_dwordx4 v2, s[8:11], s29 offen offset:2048 nt lds
  ds_read_b128 v[16:19], v4 offset:25600
  v_and_b32_dpp v60, v9, v32 row_half_mirror row_mask:0xf bank_mask:0xf
  v_and_b32_dpp v61, v9, v33 row_half_mirror row_mask:0xf bank_mask:0xf
  v_and_b32 v62, v9, v34
  v_and_b32 v63, v9, v35
  s_waitcnt lgkmcnt(0)
  s_nop 0
  v_mfma_f32_16x16x32_bf16 v[52:55], v[16:19], v[60:63], v[52:55]
  s_waitcnt vmcnt(7)
  buffer_load_dwordx4 a[224:227], v2, s[8:11], s29 offen offset:3072 nt
  v_mfma_f32_16x16x32_bf16 v[56:59], a[208:211], v[60:63], v[56:59]
  s_waitcnt vmcnt(7)
  s_add_u32 s29, s28, s66
  s_add_u32 m0, s38, 39936
  s_nop 0
  buffer_load_dwordx4 v2, s[8:11], s29 offen offset:0 nt lds
  ds_read_b128 v[16:19], v4 offset:26624
  v_and_b32 v60, v10, v32
  v_and_b32 v61, v10, v33
  v_and_b32_dpp v62, v10, v34 row_half_mirror row_mask:0xf bank_mask:0xf
  v_and_b32_dpp v63, v10, v35 row_half_mirror row_mask:0xf bank_mask:0xf
  s_waitcnt lgkmcnt(0)
  s_nop 0
  v_mfma_f32_16x16x32_bf16 v[52:55], v[16:19], v[60:63], v[52:55]
  s_waitcnt vmcnt(7)
  buffer_load_dwordx4 a[228:231], v2, s[8:11], s29 offen offset:1024 nt
  v_mfma_f32_16x16x32_bf16 v[56:59], a[212:215], v[60:63], v[56:59]
  s_waitcnt vmcnt(7)
  s_add_u32 m0, s38, 38912
  s_nop 0
  buffer_load_dwordx4 v2, s[8:11], s29 offen offset:2048 nt lds
  ds_read_b128 v[16:19], v4 offset:27648
  v_and_b32_dpp v60, v10, v32 row_half_mirror row_mask:0xf bank_mask:0xf
  v_and_b32_dpp v61, v10, v33 row_half_mirror row_mask:0xf bank_mask:0xf
  v_and_b32 v62, v10, v34
  v_and_b32 v63, v10, v35
  s_waitcnt lgkmcnt(0)
  s_nop 0
  v_mfma_f32_16x16x32_bf16 v[52:55], v[16:19], v[60:63], v[52:55]
  s_waitcnt vmcnt(7)
  buffer_load_dwordx4 a[232:235], v2, s[8:11], s29 offen offset:3072 nt
  v_mfma_f32_16x16x32_bf16 v[56:59], a[216:219], v[60:63], v[56:59]
  s_waitcnt vmcnt(7)
  s_add_u32 s29, s28, s67
  s_add_u32 m0, s38, 41984
  s_nop 0
  buffer_load_dwordx4 v2, s[8:11], s29 offen offset:0 nt lds
  ds_read_b128 v[16:19], v4 offset:28672
  v_and_b32 v60, v11, v32
  v_and_b32 v61, v11, v33
  v_and_b32_dpp v62, v11, v34 row_half_mirror row_mask:0xf bank_mask:0xf
  v_and_b32_dpp v63, v11, v35 row_half_mirror row_mask:0xf bank_mask:0xf
  s_waitcnt lgkmcnt(0)
  s_nop 0
  v_mfma_f32_16x16x32_bf16 v[52:55], v[16:19], v[60:63], v[52:55]
  s_waitcnt vmcnt(7)
  buffer_load_dwordx4 v[36:39], v3, s[20:23], s34 offen sc1
  buffer_load_dwordx4 a[236:239], v2, s[8:11], s29 offen offset:1024 nt
  v_mfma_f32_16x16x32_bf16 v[56:59], a[220:223], v[60:63], v[56:59]
  s_waitcnt vmcnt(8)
  s_add_u32 m0, s38, 40960
  s_nop 0
  buffer_load_dwordx4 v2, s[8:11], s29 offen offset:2048 nt lds
  ds_read_b128 v[16:19], v4 offset:29696
  v_and_b32_dpp v60, v11, v32 row_half_mirror row_mask:0xf bank_mask:0xf
  v_and_b32_dpp v61, v11, v33 row_half_mirror row_mask:0xf bank_mask:0xf
  v_and_b32 v62, v11, v34
  v_and_b32 v63, v11, v35
  s_waitcnt lgkmcnt(0)
  s_nop 0
  v_mfma_f32_16x16x32_bf16 v[52:55], v[16:19], v[60:63], v[52:55]
  s_waitcnt vmcnt(8)
  buffer_load_dwordx4 a[240:243], v2, s[8:11], s29 offen offset:3072 nt
  v_mfma_f32_16x16x32_bf16 v[56:59], a[224:227], v[60:63], v[56:59]
  s_waitcnt vmcnt(8)
  s_add_u32 s29, s28, s68
  s_add_u32 m0, s38, 44032
  s_nop 0
  buffer_load_dwordx4 v2, s[8:11], s29 offen offset:0 nt lds
  ds_read_b128 v[16:19], v4 offset:30720
  v_and_b32 v60, v12, v32
  v_and_b32 v61, v12, v33
  v_and_b32_dpp v62, v12, v34 row_half_mirror row_mask:0xf bank_mask:0xf
  v_and_b32_dpp v63, v12, v35 row_half_mirror row_mask:0xf bank_mask:0xf
  s_waitcnt lgkmcnt(0)
  s_nop 0
  v_mfma_f32_16x16x32_bf16 v[52:55], v[16:19], v[60:63], v[52:55]
  s_waitcnt vmcnt(8)
  buffer_load_dwordx4 a[244:247], v2, s[8:11], s29 offen offset:1024 nt
  v_mfma_f32_16x16x32_bf16 v[56:59], a[228:231], v[60:63], v[56:59]
  s_waitcnt vmcnt(8)
  s_add_u32 m0, s38, 43008
  s_nop 0
  buffer_load_dwordx4 v2, s[8:11], s29 offen offset:2048 nt lds
  ds_read_b128 v[16:19], v4 offset:31744
  v_and_b32_dpp v60, v12, v32 row_half_mirror row_mask:0xf bank_mask:0xf
  v_and_b32_dpp v61, v12, v33 row_half_mirror row_mask:0xf bank_mask:0xf
  v_and_b32 v62, v12, v34
  v_and_b32 v63, v12, v35
  s_waitcnt lgkmcnt(0)
  s_nop 0
  v_mfma_f32_16x16x32_bf16 v[52:55], v[16:19], v[60:63], v[52:55]
  s_waitcnt vmcnt(8)
  buffer_load_dwordx4 a[248:251], v2, s[8:11], s29 offen offset:3072 nt
  v_mfma_f32_16x16x32_bf16 v[56:59], a[232:235], v[60:63], v[56:59]
  s_waitcnt vmcnt(8)
  s_add_u32 s29, s28, s69
  buffer_load_dwordx4 a[252:255], v2, s[16:19], s29 offen offset:0 nt
  ds_read_b128 v[16:19], v4 offset:32768
  v_and_b32 v60, v13, v32
  v_and_b32 v61, v13, v33
  v_and_b32_dpp v62, v13, v34 row_half_mirror row_mask:0xf bank_mask:0xf
  v_and_b32_dpp v63, v13, v35 row_half_mirror row_mask:0xf bank_mask:0xf
  s_waitcnt lgkmcnt(0)
  s_nop 0
  v_mfma_f32_16x16x32_bf16 v[52:55], v[16:19], v[60:63], v[52:55]
  s_add_u32 s28, s28, 0x2000000
  s_add_u32 s35, s35, 8192
  s_cmp_eq_u32 s30, 7
  s_cbranch_scc1 Lnoq2_23
  s_waitcnt vmcnt(8)
  v_max3_u32 v0, v36, v37, v38
  v_max_u32 v0, v0, v39
  v_cmp_eq_u32 vcc, -1, v0
  s_cbranch_vccnz Lnoq2_23
  s_mov_b32 s52, 1
  v_cndmask_b32 v16, 0, v36, s[40:41]
  v_cndmask_b32 v17, 0, v37, s[40:41]
  v_cndmask_b32 v18, 0, v38, s[40:41]
  v_cndmask_b32 v19, 0, v39, s[40:41]
  v_cndmask_b32 v20, 0, v36, s[42:43]
  v_cndmask_b32 v21, 0, v37, s[42:43]
  v_cndmask_b32 v22, 0, v38, s[42:43]
  v_cndmask_b32 v23, 0, v39, s[42:43]
  v_cndmask_b32 v24, 0, v36, s[44:45]
  v_cndmask_b32 v25, 0, v37, s[44:45]
  v_cndmask_b32 v26, 0, v38, s[44:45]
  v_cndmask_b32 v27, 0, v39, s[44:45]
  v_cndmask_b32 v28, 0, v36, s[46:47]
  v_cndmask_b32 v29, 0, v37, s[46:47]
  v_cndmask_b32 v30, 0, v38, s[46:47]
  v_cndmask_b32 v31, 0, v39, s[46:47]
  v_mfma_f32_16x16x32_bf16 v[40:43], v[128:131], v[16:19], 0
  v_mfma_f32_16x16x32_bf16 v[40:43], v[132:135], v[24:27], v[40:43]
  v_mfma_f32_16x16x32_bf16 v[40:43], v[136:139], v[20:23], v[40:43]
  v_mfma_f32_16x16x32_bf16 v[40:43], v[140:143], v[28:31], v[40:43]
  ds_read_b128 v[128:131], v4 offset:0
  ds_read_b128 v[132:135], v4 offset:1024
  ds_read_b128 v[136:139], v4 offset:2048
  ds_read_b128 v[140:143], v4 offset:3072
  v_mfma_f32_16x16x32_bf16 v[44:47], v[96:99], v[16:19], 0
  v_mfma_f32_16x16x32_bf16 v[44:47], v[100:103], v[24:27], v[44:47]
  v_mfma_f32_16x16x32_bf16 v[44:47], v[104:107], v[20:23], v[44:47]
  v_mfma_f32_16x16x32_bf16 v[44:47], v[108:111], v[28:31], v[44:47]
  v_mfma_f32_16x16x32_bf16 v[48:51], v[144:147], v[16:19], 0
  v_mov_b32_dpp v103, v40 quad_perm:[0,0,0,0] row_mask:0xf bank_mask:0xf
  v_mov_b32_dpp v108, v42 quad_perm:[2,2,2,2] row_mask:0xf bank_mask:0xf
  v_mfma_f32_16x16x32_bf16 v[48:51], v[148:151], v[24:27], v[48:51]
  v_add_f32_dpp v103, v41, v103 quad_perm:[1,1,1,1] row_mask:0xf bank_mask:0xf
  v_add_f32_dpp v108, v43, v108 quad_perm:[3,3,3,3] row_mask:0xf bank_mask:0xf
  v_mfma_f32_16x16x32_bf16 v[48:51], v[152:155], v[20:23], v[48:51]
  v_add_f32 v103, v103, v108
  v_mfma_f32_16x16x32_bf16 v[48:51], v[156:159], v[28:31], v[48:51]
  s_waitcnt lgkmcnt(0)
  buffer_load_dwordx4 v[36:39], v3, s[20:23], s35 offen sc1
  s_waitcnt vmcnt(8)
  s_add_u32 s29, s28, s31
  s_add_u32 m0, s38, 9216
  s_nop 0
  buffer_load_dwordx4 v2, s[8:11], s29 offen offset:0 nt lds
  ds_read_b128 v[144:147], v4 offset:4096
  ds_read_b128 v[148:151], v4 offset:5120
  ds_read_b128 v[152:155], v4 offset:6144
  ds_read_b128 v[156:159], v4 offset:7168
  v_mfma_f32_16x16x32_bf16 v[40:43], v[64:67], v[16:19], 0
  v_mov_b32_dpp v101, v44 quad_perm:[0,0,0,0] row_mask:0xf bank_mask:0xf
  v_mov_b32_dpp v108, v46 quad_perm:[2,2,2,2] row_mask:0xf bank_mask:0xf
  v_mfma_f32_16x16x32_bf16 v[40:43], v[68:71], v[24:27], v[40:43]
  v_add_f32_dpp v101, v45, v101 quad_perm:[1,1,1,1] row_mask:0xf bank_mask:0xf
  v_add_f32_dpp v108, v47, v108 quad_perm:[3,3,3,3] row_mask:0xf bank_mask:0xf
  v_mfma_f32_16x16x32_bf16 v[40:43], v[72:75], v[20:23], v[40:43]
  v_add_f32 v101, v101, v108
  v_mfma_f32_16x16x32_bf16 v[40:43], v[76:79], v[28:31], v[40:43]
  v_mfma_f32_16x16x32_bf16 v[44:47], v[80:83], v[16:19], 0
  v_mov_b32_dpp v104, v48 quad_perm:[0,0,0,0] row_mask:0xf bank_mask:0xf
  v_mov_b32_dpp v108, v50 quad_perm:[2,2,2,2] row_mask:0xf bank_mask:0xf
  v_mfma_f32_16x16x32_bf16 v[44:47], v[84:87], v[24:27], v[44:47]
  v_add_f32_dpp v104, v49, v104 quad_perm:[1,1,1,1] row_mask:0xf bank_mask:0xf
  v_add_f32_dpp v108, v51, v108 quad_perm:[3,3,3,3] row_mask:0xf bank_mask:0xf
  v_mfma_f32_16x16x32_bf16 v[44:47], v[88:91], v[20:23], v[44:47]
  v_add_f32 v104, v104, v108
  v_mfma_f32_16x16x32_bf16 v[44:47], v[92:95], v[28:31], v[44:47]
  s_waitcnt lgkmcnt(0)
  v_mfma_f32_16x16x32_bf16 v[48:51], a[0:3], v[16:19], 0
  v_mov_b32_dpp v96, v40 quad_perm:[0,0,0,0] row_mask:0xf bank_mask:0xf
  v_mov_b32_dpp v108, v42 quad_perm:[2,2,2,2] row_mask:0xf bank_mask:0xf
  v_mfma_f32_16x16x32_bf16 v[48:51], a[4:7], v[24:27], v[48:51]
  v_add_f32_dpp v96, v41, v96 quad_perm:[1,1,1,1] row_mask:0xf bank_mask:0xf
  v_add_f32_dpp v108, v43, v108 quad_perm:[3,3,3,3] row_mask:0xf bank_mask:0xf
  v_mfma_f32_16x16x32_bf16 v[48:51], a[8:11], v[20:23], v[48:51]
  v_add_f32 v96, v96, v108
  v_mfma_f32_16x16x32_bf16 v[48:51], a[12:15], v[28:31], v[48:51]
  v_mfma_f32_16x16x32_bf16 v[40:43], v[112:115], v[16:19], 0
  v_mov_b32_dpp v97, v44 quad_perm:[0,0,0,0] row_mask:0xf bank_mask:0xf
  v_mov_b32_dpp v108, v46 quad_perm:[2,2,2,2] row_mask:0xf bank_mask:0xf
  v_mfma_f32_16x16x32_bf16 v[40:43], v[116:119], v[24:27], v[40:43]
  v_add_f32_dpp v97, v45, v97 quad_perm:[1,1,1,1] row_mask:0xf bank_mask:0xf
  v_add_f32_dpp v108, v47, v108 quad_perm:[3,3,3,3] row_mask:0xf bank_mask:0xf
  v_mfma_f32_16x16x32_bf16 v[40:43], v[120:123], v[20:23], v[40:43]
  v_add_f32 v97, v97, v108
  v_mfma_f32_16x16x32_bf16 v[40:43], v[124:127], v[28:31], v[40:43]
  s_waitcnt vmcnt(8)
  s_add_u32 m0, s38, 8192
  s_nop 0
  buffer_load_dwordx4 v2, s[8:11], s29 offen offset:2048 nt lds
  v_mfma_f32_16x16x32_bf16 v[44:47], a[16:19], v[16:19], 0
  v_mov_b32_dpp v98, v48 quad_perm:[0,0,0,0] row_mask:0xf bank_mask:0xf
  v_mov_b32_dpp v108, v50 quad_perm:[2,2,2,2] row_mask:0xf bank_mask:0xf
  v_mfma_f32_16x16x32_bf16 v[44:47], a[20:23], v[24:27], v[44:47]
  v_add_f32_dpp v98, v49, v98 quad_perm:[1,1,1,1] row_mask:0xf bank_mask:0xf
  v_add_f32_dpp v108, v51, v108 quad_perm:[3,3,3,3] row_mask:0xf bank_mask:0xf
  v_mfma_f32_16x16x32_bf16 v[44:47], a[24:27], v[20:23], v[44:47]
  v_add_f32 v98, v98, v108
  v_mfma_f32_16x16x32_bf16 v[44:47], a[28:31], v[28:31], v[44:47]
  v_mfma_f32_16x16x32_bf16 v[48:51], a[32:35], v[16:19], 0
  v_mov_b32_dpp v102, v40 quad_perm:[0,0,0,0] row_mask:0xf bank_mask:0xf
  v_mov_b32_dpp v108, v42 quad_perm:[2,2,2,2] row_mask:0xf bank_mask:0xf
  v_mfma_f32_16x16x32_bf16 v[48:51], a[36:39], v[24:27], v[48:51]
  v_add_f32_dpp v102, v41, v102 quad_perm:[1,1,1,1] row_mask:0xf bank_mask:0xf
  v_add_f32_dpp v108, v43, v108 quad_perm:[3,3,3,3] row_mask:0xf bank_mask:0xf
  v_mfma_f32_16x16x32_bf16 v[48:51], a[40:43], v[20:23], v[48:51]
  v_add_f32 v102, v102, v108
  v_mfma_f32_16x16x32_bf16 v[48:51], a[44:47], v[28:31], v[48:51]
  v_mfma_f32_16x16x32_bf16 v[40:43], a[48:51], v[16:19], 0
  v_mov_b32_dpp v99, v44 quad_perm:[0,0,0,0] row_mask:0xf bank_mask:0xf
  v_mov_b32_dpp v108, v46 quad_perm:[2,2,2,2] row_mask:0xf bank_mask:0xf
  s_nop 0
  v_add_f32_dpp v99, v45, v99 quad_perm:[1,1,1,1] row_mask:0xf bank_mask:0xf
  v_add_f32_dpp v108, v47, v108 quad_perm:[3,3,3,3] row_mask:0xf bank_mask:0xf
  v_add_f32 v99, v99, v108
  s_nop 0
  v_mov_b32_dpp v100, v48 quad_perm:[0,0,0,0] row_mask:0xf bank_mask:0xf
  v_mov_b32_dpp v108, v50 quad_perm:[2,2,2,2] row_mask:0xf bank_mask:0xf
  s_nop 0
  v_add_f32_dpp v100, v49, v100 quad_perm:[1,1,1,1] row_mask:0xf bank_mask:0xf
  v_add_f32_dpp v108, v51, v108 quad_perm:[3,3,3,3] row_mask:0xf bank_mask:0xf
  v_add_f32 v100, v100, v108
  s_waitcnt vmcnt(8)
  s_add_u32 s29, s28, s39
  s_add_u32 m0, s38, 11264
  s_nop 0
  buffer_load_dwordx4 v2, s[8:11], s29 offen offset:0 nt lds
  v_mov_b32_dpp v105, v40 quad_perm:[0,0,0,0] row_mask:0xf bank_mask:0xf
  v_mov_b32_dpp v108, v42 quad_perm:[2,2,2,2] row_mask:0xf bank_mask:0xf
  s_nop 0
  v_add_f32_dpp v105, v41, v105 quad_perm:[1,1,1,1] row_mask:0xf bank_mask:0xf
  v_add_f32_dpp v108, v43, v108 quad_perm:[3,3,3,3] row_mask:0xf bank_mask:0xf
  v_add_f32 v105, v105, v108
  s_mov_b64 exec, s[48:49]
  v_mov_b32 v105, 0xff800000
  s_mov_b64 exec, -1
  s_add_u32 s34, s34, 8192
  v_mfma_f32_16x16x32_bf16 v[56:59], a[236:239], v[60:63], v[56:59]
  ds_read_b128 v[16:19], v4 offset:33792
  v_and_b32_dpp v60, v13, v32 row_half_mirror row_mask:0xf bank_mask:0xf
  v_and_b32_dpp v61, v13, v33 row_half_mirror row_mask:0xf bank_mask:0xf
  v_and_b32 v62, v13, v34
  v_and_b32 v63, v13, v35
  s_waitcnt lgkmcnt(0)
  s_nop 0
  v_mfma_f32_16x16x32_bf16 v[52:55], v[16:19], v[60:63], v[52:55]
  v_mfma_f32_16x16x32_bf16 v[56:59], a[240:243], v[60:63], v[56:59]
  s_waitcnt vmcnt(8)
  s_add_u32 m0, s38, 10240
  s_nop 0
  buffer_load_dwordx4 v2, s[8:11], s29 offen offset:2048 nt lds
  ds_read_b128 v[16:19], v4 offset:34816
  v_and_b32 v60, v14, v32
  v_and_b32 v61, v14, v33
  v_and_b32_dpp v62, v14, v34 row_half_mirror row_mask:0xf bank_mask:0xf
  v_and_b32_dpp v63, v14, v35 row_half_mirror row_mask:0xf bank_mask:0xf
  s_waitcnt lgkmcnt(0)
  s_nop 0
  v_mfma_f32_16x16x32_bf16 v[52:55], v[16:19], v[60:63], v[52:55]
  s_waitcnt vmcnt(8)
  s_add_u32 s29, s28, s50
  s_add_u32 m0, s38, 13312
  s_nop 0
  buffer_load_dwordx4 v2, s[8:11], s29 offen offset:0 nt lds
  v_mfma_f32_16x16x32_bf16 v[56:59], a[244:247], v[60:63], v[56:59]
  s_waitcnt vmcnt(8)
  s_add_u32 m0, s38, 12288
  s_nop 0
  buffer_load_dwordx4 v2, s[8:11], s29 offen offset:2048 nt lds
  ds_read_b128 v[16:19], v4 offset:35840
  v_and_b32_dpp v60, v14, v32 row_half_mirror row_mask:0xf bank_mask:0xf
  v_and_b32_dpp v61, v14, v33 row_half_mirror row_mask:0xf bank_mask:0xf
  v_and_b32 v62, v14, v34
  v_and_b32 v63, v14, v35
  s_waitcnt lgkmcnt(0)
  s_nop 0
  v_mfma_f32_16x16x32_bf16 v[52:55], v[16:19], v[60:63], v[52:55]
  s_waitcnt vmcnt(8)
  s_add_u32 s29, s28, s51
  s_add_u32 m0, s38, 15360
  s_nop 0
  buffer_load_dwordx4 v2, s[8:11], s29 offen offset:0 nt lds
  v_mfma_f32_16x16x32_bf16 v[56:59], a[248:251], v[60:63], v[56:59]
  s_waitcnt vmcnt(8)
  s_add_u32 m0, s38, 14336
  s_nop 0
  buffer_load_dwordx4 v2, s[8:11], s29 offen offset:2048 nt lds
  v_and_b32 v60, v15, v32
  v_and_b32 v61, v15, v33
  v_and_b32_dpp v62, v15, v34 row_half_mirror row_mask:0xf bank_mask:0xf
  v_and_b32_dpp v63, v15, v35 row_half_mirror row_mask:0xf bank_mask:0xf
  s_nop 1
  v_mfma_f32_16x16x32_bf16 v[52:55], a[252:255], v[60:63], v[52:55]
  v_lshrrev_b32 v0, 1, v2
  v_add_u32 v5, s53, v0
  v_mov_b32 v42, 1
  v_mov_b32 v43, 0
  s_nop 3
  v_add_f32_dpp v40, v56, v52 row_ror:8 row_mask:0xf bank_mask:0x3
  v_add_f32_dpp v41, v57, v53 row_ror:8 row_mask:0xf bank_mask:0x3
  s_nop 0
  v_add_f32_dpp v40, v54, v58 row_ror:8 row_mask:0xf bank_mask:0xc
  v_add_f32_dpp v41, v55, v59 row_ror:8 row_mask:0xf bank_mask:0xc
  ds_write_b64 v5, v[40:41] offset:2048
  s_mov_b64 exec, 1
  ds_add_rtn_u32 v42, v43, v42 offset:8324
  s_mov_b64 exec, -1
  ds_read_b128 v[16:19], v43 offset:8224
  ds_read_b128 v[20:23], v43 offset:8240
  ds_read_b64 v[24:25], v0 offset:2048
  ds_read_b64 v[26:27], v0 offset:2560
  ds_read_b64 v[28:29], v0 offset:3072
  ds_read_b64 v[30:31], v0 offset:3584
  s_waitcnt lgkmcnt(4)
  v_readfirstlane_b32 s56, v42
  v_min3_f32 v44, v16, v18, v20
  s_and_b32 s56, s56, 3
  s_cmp_lg_u32 s56, 3
  s_cbranch_scc1 Lpubnot_25
  v_min_f32 v44, v44, v22
  v_sub_f32 v16, v44, v16
  v_sub_f32 v18, v44, v18
  v_sub_f32 v20, v44, v20
  v_sub_f32 v22, v44, v22
  v_exp_f32 v16, v16
  v_exp_f32 v18, v18
  v_exp_f32 v20, v20
  v_exp_f32 v22, v22
  s_waitcnt lgkmcnt(0)
  v_mul_f32 v40, v16, v24
  v_mul_f32 v41, v16, v25
  v_mul_f32 v45, v16, v17
  v_fmac_f32 v40, v18, v26
  v_fmac_f32 v41, v18, v27
  v_fmac_f32 v45, v18, v19
  v_fmac_f32 v40, v20, v28
  v_fmac_f32 v41, v20, v29
  v_fmac_f32 v45, v20, v21
  v_fmac_f32 v40, v22, v30
  v_fmac_f32 v41, v22, v31
  v_fmac_f32 v45, v22, v23
  s_add_u32 s56, s36, s55
  s_cmp_eq_u32 s32, 0
  s_cbranch_scc1 Lpubnl_26
  buffer_store_dwordx2 v[40:41], v0, s[20:23], s36 offen
  s_mov_b64 exec, 1
  buffer_store_dwordx2 v[44:45], off, s[20:23], s56
  s_mov_b64 exec, -1
  s_branch Lpubdone_24
Lpubnl_26:
  buffer_store_dwordx2 v[40:41], v0, s[20:23], s36 offen sc1
  s_mov_b64 exec, 1
  buffer_store_dwordx2 v[44:45], off, s[20:23], s56 sc1
  s_mov_b64 exec, -1
  s_branch Lpubdone_24
Lpubnot_25:
  v_mov_b32 v0, 0x7ffffff0
  s_mov_b64 exec, 1
  buffer_store_dword v0, v0, s[20:23], 0 offen
  buffer_store_dword v0, v0, s[20:23], 0 offen
  s_mov_b64 exec, -1
  s_waitcnt lgkmcnt(0)
Lpubdone_24:
  s_add_u32 s36, s36, 131072
  s_add_u32 s30, s30, 1
  s_branch Lmain0
Lnoq2_23:
  s_nop 7
  s_waitcnt vmcnt(7)
  v_mfma_f32_16x16x32_bf16 v[56:59], a[236:239], v[60:63], v[56:59]
  s_waitcnt vmcnt(6)
  ds_read_b128 v[16:19], v4 offset:33792
  v_and_b32_dpp v60, v13, v32 row_half_mirror row_mask:0xf bank_mask:0xf
  v_and_b32_dpp v61, v13, v33 row_half_mirror row_mask:0xf bank_mask:0xf
  v_and_b32 v62, v13, v34
  v_and_b32 v63, v13, v35
  s_waitcnt lgkmcnt(0)
  s_nop 0
  v_mfma_f32_16x16x32_bf16 v[52:55], v[16:19], v[60:63], v[52:55]
  s_waitcnt vmcnt(5)
  v_mfma_f32_16x16x32_bf16 v[56:59], a[240:243], v[60:63], v[56:59]
  s_waitcnt vmcnt(4)
  ds_read_b128 v[16:19], v4 offset:34816
  v_and_b32 v60, v14, v32
  v_and_b32 v61, v14, v33
  v_and_b32_dpp v62, v14, v34 row_half_mirror row_mask:0xf bank_mask:0xf
  v_and_b32_dpp v63, v14, v35 row_half_mirror row_mask:0xf bank_mask:0xf
  s_waitcnt lgkmcnt(0)
  s_nop 0
  v_mfma_f32_16x16x32_bf16 v[52:55], v[16:19], v[60:63], v[52:55]
  s_waitcnt vmcnt(3)
  v_mfma_f32_16x16x32_bf16 v[56:59], a[244:247], v[60:63], v[56:59]
  s_waitcnt vmcnt(2)
  ds_read_b128 v[16:19], v4 offset:35840
  v_and_b32_dpp v60, v14, v32 row_half_mirror row_mask:0xf bank_mask:0xf
  v_and_b32_dpp v61, v14, v33 row_half_mirror row_mask:0xf bank_mask:0xf
  v_and_b32 v62, v14, v34
  v_and_b32 v63, v14, v35
  s_waitcnt lgkmcnt(0)
  s_nop 0
  v_mfma_f32_16x16x32_bf16 v[52:55], v[16:19], v[60:63], v[52:55]
  buffer_load_dwordx4 v[36:39], v3, s[20:23], s34 offen sc1
  s_waitcnt vmcnt(2)
  v_mfma_f32_16x16x32_bf16 v[56:59], a[248:251], v[60:63], v[56:59]
  s_waitcnt vmcnt(1)
  v_and_b32 v60, v15, v32
  v_and_b32 v61, v15, v33
  v_and_b32_dpp v62, v15, v34 row_half_mirror row_mask:0xf bank_mask:0xf
  v_and_b32_dpp v63, v15, v35 row_half_mirror row_mask:0xf bank_mask:0xf
  s_nop 1
  v_mfma_f32_16x16x32_bf16 v[52:55], a[252:255], v[60:63], v[52:55]
  v_lshrrev_b32 v0, 1, v2
  v_add_u32 v5, s53, v0
  v_mov_b32 v42, 1
  v_mov_b32 v43, 0
  s_nop 3
  v_add_f32_dpp v40, v56, v52 row_ror:8 row_mask:0xf bank_mask:0x3
  v_add_f32_dpp v41, v57, v53 row_ror:8 row_mask:0xf bank_mask:0x3
  s_nop 0
  v_add_f32_dpp v40, v54, v58 row_ror:8 row_mask:0xf bank_mask:0xc
  v_add_f32_dpp v41, v55, v59 row_ror:8 row_mask:0xf bank_mask:0xc
  ds_write_b64 v5, v[40:41] offset:2048
  s_mov_b64 exec, 1
  ds_add_rtn_u32 v42, v43, v42 offset:8324
  s_mov_b64 exec, -1
  ds_read_b128 v[16:19], v43 offset:8224
  ds_read_b128 v[20:23], v43 offset:8240
  ds_read_b64 v[24:25], v0 offset:2048
  ds_read_b64 v[26:27], v0 offset:2560
  ds_read_b64 v[28:29], v0 offset:3072
  ds_read_b64 v[30:31], v0 offset:3584
  s_waitcnt lgkmcnt(4)
  v_readfirstlane_b32 s56, v42
  v_min3_f32 v44, v16, v18, v20
  s_and_b32 s56, s56, 3
  s_cmp_lg_u32 s56, 3
  s_cbranch_scc1 Lpubnot_28
  v_min_f32 v44, v44, v22
  v_sub_f32 v16, v44, v16
  v_sub_f32 v18, v44, v18
  v_sub_f32 v20, v44, v20
  v_sub_f32 v22, v44, v22
  v_exp_f32 v16, v16
  v_exp_f32 v18, v18
  v_exp_f32 v20, v20
  v_exp_f32 v22, v22
  s_waitcnt lgkmcnt(0)
  v_mul_f32 v40, v16, v24
  v_mul_f32 v41, v16, v25
  v_mul_f32 v45, v16, v17
  v_fmac_f32 v40, v18, v26
  v_fmac_f32 v41, v18, v27
  v_fmac_f32 v45, v18, v19
  v_fmac_f32 v40, v20, v28
  v_fmac_f32 v41, v20, v29
  v_fmac_f32 v45, v20, v21
  v_fmac_f32 v40, v22, v30
  v_fmac_f32 v41, v22, v31
  v_fmac_f32 v45, v22, v23
  s_add_u32 s56, s36, s55
  s_cmp_eq_u32 s32, 0
  s_cbranch_scc1 Lpubnl_29
  buffer_store_dwordx2 v[40:41], v0, s[20:23], s36 offen
  s_mov_b64 exec, 1
  buffer_store_dwordx2 v[44:45], off, s[20:23], s56
  s_mov_b64 exec, -1
  s_branch Lpubdone_27
Lpubnl_29:
  buffer_store_dwordx2 v[40:41], v0, s[20:23], s36 offen sc1
  s_mov_b64 exec, 1
  buffer_store_dwordx2 v[44:45], off, s[20:23], s56 sc1
  s_mov_b64 exec, -1
  s_branch Lpubdone_27
Lpubnot_28:
  v_mov_b32 v0, 0x7ffffff0
  s_mov_b64 exec, 1
  buffer_store_dword v0, v0, s[20:23], 0 offen
  buffer_store_dword v0, v0, s[20:23], 0 offen
  s_mov_b64 exec, -1
  s_waitcnt lgkmcnt(0)
Lpubdone_27:
  s_add_u32 s36, s36, 131072
  s_add_u32 s30, s30, 1
  s_waitcnt vmcnt(2)
  s_branch Lqchk_32
Lqw_30:
  s_sub_u32 s33, s33, 1
  s_cbranch_scc1 Lend
  buffer_load_dwordx4 v[36:39], v3, s[20:23], s34 offen sc1
  s_waitcnt vmcnt(0)
Lqchk_32:
  v_max3_u32 v0, v36, v37, v38
  v_max_u32 v0, v0, v39
  v_cmp_eq_u32 vcc, -1, v0
  s_cbranch_vccnz Lqw_30
  s_cmp_eq_u32 s30, 8
  s_cbranch_scc1 Lfin
  s_mov_b32 s52, 0
  v_cndmask_b32 v16, 0, v36, s[40:41]
  v_cndmask_b32 v17, 0, v37, s[40:41]
  v_cndmask_b32 v18, 0, v38, s[40:41]
  v_cndmask_b32 v19, 0, v39, s[40:41]
  v_cndmask_b32 v20, 0, v36, s[42:43]
  v_cndmask_b32 v21, 0, v37, s[42:43]
  v_cndmask_b32 v22, 0, v38, s[42:43]
  v_cndmask_b32 v23, 0, v39, s[42:43]
  v_cndmask_b32 v24, 0, v36, s[44:45]
  v_cndmask_b32 v25, 0, v37, s[44:45]
  v_cndmask_b32 v26, 0, v38, s[44:45]
  v_cndmask_b32 v27, 0, v39, s[44:45]
  v_cndmask_b32 v28, 0, v36, s[46:47]
  v_cndmask_b32 v29, 0, v37, s[46:47]
  v_cndmask_b32 v30, 0, v38, s[46:47]
  v_cndmask_b32 v31, 0, v39, s[46:47]
  v_mfma_f32_16x16x32_bf16 v[40:43], v[128:131], v[16:19], 0
  v_mfma_f32_16x16x32_bf16 v[40:43], v[132:135], v[24:27], v[40:43]
  v_mfma_f32_16x16x32_bf16 v[40:43], v[136:139], v[20:23], v[40:43]
  v_mfma_f32_16x16x32_bf16 v[40:43], v[140:143], v[28:31], v[40:43]
  ds_read_b128 v[128:131], v4 offset:0
  ds_read_b128 v[132:135], v4 offset:1024
  ds_read_b128 v[136:139], v4 offset:2048
  ds_read_b128 v[140:143], v4 offset:3072
  v_mfma_f32_16x16x32_bf16 v[44:47], v[96:99], v[16:19], 0
  v_mfma_f32_16x16x32_bf16 v[44:47], v[100:103], v[24:27], v[44:47]
  v_mfma_f32_16x16x32_bf16 v[44:47], v[104:107], v[20:23], v[44:47]
  v_mfma_f32_16x16x32_bf16 v[44:47], v[108:111], v[28:31], v[44:47]
  v_mfma_f32_16x16x32_bf16 v[48:51], v[144:147], v[16:19], 0
  v_mov_b32_dpp v103, v40 quad_perm:[0,0,0,0] row_mask:0xf bank_mask:0xf
  v_mov_b32_dpp v108, v42 quad_perm:[2,2,2,2] row_mask:0xf bank_mask:0xf
  v_mfma_f32_16x16x32_bf16 v[48:51], v[148:151], v[24:27], v[48:51]
  v_add_f32_dpp v103, v41, v103 quad_perm:[1,1,1,1] row_mask:0xf bank_mask:0xf
  v_add_f32_dpp v108, v43, v108 quad_perm:[3,3,3,3] row_mask:0xf bank_mask:0xf
  v_mfma_f32_16x16x32_bf16 v[48:51], v[152:155], v[20:23], v[48:51]
  v_add_f32 v103, v103, v108
  v_mfma_f32_16x16x32_bf16 v[48:51], v[156:159], v[28:31], v[48:51]
  s_waitcnt lgkmcnt(0)
  buffer_load_dwordx4 v[36:39], v3, s[20:23], s35 offen sc1
  s_add_u32 s29, s28, s31
  s_add_u32 m0, s38, 9216
  s_nop 0
  buffer_load_dwordx4 v2, s[8:11], s29 offen offset:0 nt lds
  s_add_u32 m0, s38, 8192
  s_nop 0
  buffer_load_dwordx4 v2, s[8:11], s29 offen offset:2048 nt lds
  s_add_u32 s29, s28, s39
  s_add_u32 m0, s38, 11264
  s_nop 0
  buffer_load_dwordx4 v2, s[8:11], s29 offen offset:0 nt lds
  s_add_u32 m0, s38, 10240
  s_nop 0
  buffer_load_dwordx4 v2, s[8:11], s29 offen offset:2048 nt lds
  ds_read_b128 v[144:147], v4 offset:4096
  ds_read_b128 v[148:151], v4 offset:5120
  ds_read_b128 v[152:155], v4 offset:6144
  ds_read_b128 v[156:159], v4 offset:7168
  v_mfma_f32_16x16x32_bf16 v[40:43], v[64:67], v[16:19], 0
  v_mov_b32_dpp v101, v44 quad_perm:[0,0,0,0] row_mask:0xf bank_mask:0xf
  v_mov_b32_dpp v108, v46 quad_perm:[2,2,2,2] row_mask:0xf bank_mask:0xf
  v_mfma_f32_16x16x32_bf16 v[40:43], v[68:71], v[24:27], v[40:43]
  v_add_f32_dpp v101, v45, v101 quad_perm:[1,1,1,1] row_mask:0xf bank_mask:0xf
  v_add_f32_dpp v108, v47, v108 quad_perm:[3,3,3,3] row_mask:0xf bank_mask:0xf
  v_mfma_f32_16x16x32_bf16 v[40:43], v[72:75], v[20:23], v[40:43]
  v_add_f32 v101, v101, v108
  v_mfma_f32_16x16x32_bf16 v[40:43], v[76:79], v[28:31], v[40:43]
  v_mfma_f32_16x16x32_bf16 v[44:47], v[80:83], v[16:19], 0
  v_mov_b32_dpp v104, v48 quad_perm:[0,0,0,0] row_mask:0xf bank_mask:0xf
  v_mov_b32_dpp v108, v50 quad_perm:[2,2,2,2] row_mask:0xf bank_mask:0xf
  v_mfma_f32_16x16x32_bf16 v[44:47], v[84:87], v[24:27], v[44:47]
  v_add_f32_dpp v104, v49, v104 quad_perm:[1,1,1,1] row_mask:0xf bank_mask:0xf
  v_add_f32_dpp v108, v51, v108 quad_perm:[3,3,3,3] row_mask:0xf bank_mask:0xf
  v_mfma_f32_16x16x32_bf16 v[44:47], v[88:91], v[20:23], v[44:47]
  v_add_f32 v104, v104, v108
  v_mfma_f32_16x16x32_bf16 v[44:47], v[92:95], v[28:31], v[44:47]
  s_waitcnt lgkmcnt(0)
  s_add_u32 s29, s28, s50
  s_add_u32 m0, s38, 13312
  s_nop 0
  buffer_load_dwordx4 v2, s[8:11], s29 offen offset:0 nt lds
  s_add_u32 m0, s38, 12288
  s_nop 0
  buffer_load_dwordx4 v2, s[8:11], s29 offen offset:2048 nt lds
  s_add_u32 s29, s28, s51
  s_add_u32 m0, s38, 15360
  s_nop 0
  buffer_load_dwordx4 v2, s[8:11], s29 offen offset:0 nt lds
  s_add_u32 m0, s38, 14336
  s_nop 0
  buffer_load_dwordx4 v2, s[8:11], s29 offen offset:2048 nt lds
  v_mfma_f32_16x16x32_bf16 v[48:51], a[0:3], v[16:19], 0
  v_mov_b32_dpp v96, v40 quad_perm:[0,0,0,0] row_mask:0xf bank_mask:0xf
  v_mov_b32_dpp v108, v42 quad_perm:[2,2,2,2] row_mask:0xf bank_mask:0xf
  v_mfma_f32_16x16x32_bf16 v[48:51], a[4:7], v[24:27], v[48:51]
  v_add_f32_dpp v96, v41, v96 quad_perm:[1,1,1,1] row_mask:0xf bank_mask:0xf
  v_add_f32_dpp v108, v43, v108 quad_perm:[3,3,3,3] row_mask:0xf bank_mask:0xf
  v_mfma_f32_16x16x32_bf16 v[48:51], a[8:11], v[20:23], v[48:51]
  v_add_f32 v96, v96, v108
  v_mfma_f32_16x16x32_bf16 v[48:51], a[12:15], v[28:31], v[48:51]
  v_mfma_f32_16x16x32_bf16 v[40:43], v[112:115], v[16:19], 0
  v_mov_b32_dpp v97, v44 quad_perm:[0,0,0,0] row_mask:0xf bank_mask:0xf
  v_mov_b32_dpp v108, v46 quad_perm:[2,2,2,2] row_mask:0xf bank_mask:0xf
  v_mfma_f32_16x16x32_bf16 v[40:43], v[116:119], v[24:27], v[40:43]
  v_add_f32_dpp v97, v45, v97 quad_perm:[1,1,1,1] row_mask:0xf bank_mask:0xf
  v_add_f32_dpp v108, v47, v108 quad_perm:[3,3,3,3] row_mask:0xf bank_mask:0xf
  v_mfma_f32_16x16x32_bf16 v[40:43], v[120:123], v[20:23], v[40:43]
  v_add_f32 v97, v97, v108
  v_mfma_f32_16x16x32_bf16 v[40:43], v[124:127], v[28:31], v[40:43]
  v_mfma_f32_16x16x32_bf16 v[44:47], a[16:19], v[16:19], 0
  v_mov_b32_dpp v98, v48 quad_perm:[0,0,0,0] row_mask:0xf bank_mask:0xf
  v_mov_b32_dpp v108, v50 quad_perm:[2,2,2,2] row_mask:0xf bank_mask:0xf
  v_mfma_f32_16x16x32_bf16 v[44:47], a[20:23], v[24:27], v[44:47]
  v_add_f32_dpp v98, v49, v98 quad_perm:[1,1,1,1] row_mask:0xf bank_mask:0xf
  v_add_f32_dpp v108, v51, v108 quad_perm:[3,3,3,3] row_mask:0xf bank_mask:0xf
  v_mfma_f32_16x16x32_bf16 v[44:47], a[24:27], v[20:23], v[44:47]
  v_add_f32 v98, v98, v108
  v_mfma_f32_16x16x32_bf16 v[44:47], a[28:31], v[28:31], v[44:47]
  v_mfma_f32_16x16x32_bf16 v[48:51], a[32:35], v[16:19], 0
  v_mov_b32_dpp v102, v40 quad_perm:[0,0,0,0] row_mask:0xf bank_mask:0xf
  v_mov_b32_dpp v108, v42 quad_perm:[2,2,2,2] row_mask:0xf bank_mask:0xf
  v_mfma_f32_16x16x32_bf16 v[48:51], a[36:39], v[24:27], v[48:51]
  v_add_f32_dpp v102, v41, v102 quad_perm:[1,1,1,1] row_mask:0xf bank_mask:0xf
  v_add_f32_dpp v108, v43, v108 quad_perm:[3,3,3,3] row_mask:0xf bank_mask:0xf
  v_mfma_f32_16x16x32_bf16 v[48:51], a[40:43], v[20:23], v[48:51]
  v_add_f32 v102, v102, v108
  v_mfma_f32_16x16x32_bf16 v[48:51], a[44:47], v[28:31], v[48:51]
  v_mfma_f32_16x16x32_bf16 v[40:43], a[48:51], v[16:19], 0
  v_mov_b32_dpp v99, v44 quad_perm:[0,0,0,0] row_mask:0xf bank_mask:0xf
  v_mov_b32_dpp v108, v46 quad_perm:[2,2,2,2] row_mask:0xf bank_mask:0xf
  s_nop 0
  v_add_f32_dpp v99, v45, v99 quad_perm:[1,1,1,1] row_mask:0xf bank_mask:0xf
  v_add_f32_dpp v108, v47, v108 quad_perm:[3,3,3,3] row_mask:0xf bank_mask:0xf
  v_add_f32 v99, v99, v108
  s_nop 0
  v_mov_b32_dpp v100, v48 quad_perm:[0,0,0,0] row_mask:0xf bank_mask:0xf
  v_mov_b32_dpp v108, v50 quad_perm:[2,2,2,2] row_mask:0xf bank_mask:0xf
  s_nop 0
  v_add_f32_dpp v100, v49, v100 quad_perm:[1,1,1,1] row_mask:0xf bank_mask:0xf
  v_add_f32_dpp v108, v51, v108 quad_perm:[3,3,3,3] row_mask:0xf bank_mask:0xf
  v_add_f32 v100, v100, v108
  v_mov_b32_dpp v105, v40 quad_perm:[0,0,0,0] row_mask:0xf bank_mask:0xf
  v_mov_b32_dpp v108, v42 quad_perm:[2,2,2,2] row_mask:0xf bank_mask:0xf
  s_nop 0
  v_add_f32_dpp v105, v41, v105 quad_perm:[1,1,1,1] row_mask:0xf bank_mask:0xf
  v_add_f32_dpp v108, v43, v108 quad_perm:[3,3,3,3] row_mask:0xf bank_mask:0xf
  v_add_f32 v105, v105, v108
  s_mov_b64 exec, s[48:49]
  v_mov_b32 v105, 0xff800000
  s_mov_b64 exec, -1
  s_add_u32 s34, s34, 8192
  v_mov_b32 v0, 0x7ffffff0
  s_mov_b64 exec, 1
  buffer_store_dword v0, v0, s[20:23], 0 offen
  buffer_store_dword v0, v0, s[20:23], 0 offen
  s_mov_b64 exec, -1
  s_branch Lmain0
Lmain0:
  s_nop 7
  s_cmp_lg_u32 s52, 0
  s_cselect_b64 vcc, -1, 0
  v_max3_f32 v106, v96, v97, v98
  v_max3_f32 v109, v99, v100, v101
  v_max3_f32 v106, v106, v102, v103
  v_max3_f32 v109, v109, v104, v105
  v_max_f32 v106, v106, v109
  s_nop 1
  v_max_f32_dpp v106, v106, v106 row_ror:4 row_mask:0xf bank_mask:0xf
  s_nop 1
  v_max_f32_dpp v106, v106, v106 row_ror:8 row_mask:0xf bank_mask:0xf
  s_nop 1
  v_max_f32_dpp v106, v106, v106 row_bcast:15 row_mask:0xa bank_mask:0xf
  s_nop 1
  v_max_f32_dpp v106, v106, v106 row_bcast:31 row_mask:0xc bank_mask:0xf
  v_mul_f32 v106, 0xbe0293ee, v106
  s_nop 0
  v_readlane_b32 s56, v106, 63
  s_nop 1
  v_mov_b32 v106, s56
  v_fmamk_f32 v96, v96, 0x3e0293ee, v106
  v_exp_f32 v96, v96
  s_nop 0
  v_mov_b32 v107, v96
  v_cvt_pk_bf16_f32 v96, v96, v96
  v_and_b32 v120, v96, v32
  v_and_b32 v121, v96, v33
  v_and_b32_dpp v122, v96, v34 row_half_mirror row_mask:0xf bank_mask:0xf
  v_and_b32_dpp v123, v96, v35 row_half_mirror row_mask:0xf bank_mask:0xf
  v_fmamk_f32 v97, v97, 0x3e0293ee, v106
  v_exp_f32 v97, v97
  s_nop 0
  v_add_f32 v107, v107, v97
  v_cvt_pk_bf16_f32 v97, v97, v97
  s_waitcnt lgkmcnt(7)
  v_mfma_f32_16x16x32_bf16 v[112:115], v[128:131], v[120:123], 0
  v_and_b32_dpp v124, v96, v32 row_half_mirror row_mask:0xf bank_mask:0xf
  v_and_b32_dpp v125, v96, v33 row_half_mirror row_mask:0xf bank_mask:0xf
  v_mfma_f32_16x16x32_bf16 v[116:119], a[52:55], v[120:123], 0
  v_and_b32 v126, v96, v34
  v_and_b32 v127, v96, v35
  ds_read_b128 v[128:131], v4 offset:8192
  s_waitcnt vmcnt(9)
  s_add_u32 s29, s28, s31
  buffer_load_dwordx4 a[52:55], v2, s[8:11], s29 offen offset:1024 nt
  s_waitcnt lgkmcnt(7)
  v_mfma_f32_16x16x32_bf16 v[112:115], v[132:135], v[124:127], v[112:115]
  v_and_b32 v120, v97, v32
  v_and_b32 v121, v97, v33
  v_mfma_f32_16x16x32_bf16 v[116:119], a[56:59], v[124:127], v[116:119]
  v_and_b32_dpp v122, v97, v34 row_half_mirror row_mask:0xf bank_mask:0xf
  v_and_b32_dpp v123, v97, v35 row_half_mirror row_mask:0xf bank_mask:0xf
  ds_read_b128 v[132:135], v4 offset:9216
  v_fmamk_f32 v98, v98, 0x3e0293ee, v106
  v_exp_f32 v98, v98
  s_nop 0
  v_add_f32 v107, v107, v98
  v_cvt_pk_bf16_f32 v98, v98, v98
  s_waitcnt lgkmcnt(7)
  v_mfma_f32_16x16x32_bf16 v[112:115], v[136:139], v[120:123], v[112:115]
  v_and_b32_dpp v124, v97, v32 row_half_mirror row_mask:0xf bank_mask:0xf
  v_and_b32_dpp v125, v97, v33 row_half_mirror row_mask:0xf bank_mask:0xf
  v_mfma_f32_16x16x32_bf16 v[116:119], a[60:63], v[120:123], v[116:119]
  v_and_b32 v126, v97, v34
  v_and_b32 v127, v97, v35
  ds_read_b128 v[136:139], v4 offset:10240
  s_waitcnt lgkmcnt(7)
  v_mfma_f32_16x16x32_bf16 v[112:115], v[140:143], v[124:127], v[112:115]
  v_and_b32 v120, v98, v32
  v_and_b32 v121, v98, v33
  v_mfma_f32_16x16x32_bf16 v[116:119], a[64:67], v[124:127], v[116:119]
  v_and_b32_dpp v122, v98, v34 row_half_mirror row_mask:0xf bank_mask:0xf
  v_and_b32_dpp v123, v98, v35 row_half_mirror row_mask:0xf bank_mask:0xf
  ds_read_b128 v[140:143], v4 offset:11264
  s_waitcnt vmcnt(9)
  buffer_load_dwordx4 a[56:59], v2, s[8:11], s29 offen offset:3072 nt
  v_fmamk_f32 v99, v99, 0x3e0293ee, v106
  v_exp_f32 v99, v99
  s_nop 0
  v_add_f32 v107, v107, v99
  v_cvt_pk_bf16_f32 v99, v99, v99
  s_waitcnt lgkmcnt(7)
  v_mfma_f32_16x16x32_bf16 v[112:115], v[144:147], v[120:123], v[112:115]
  v_and_b32_dpp v124, v98, v32 row_half_mirror row_mask:0xf bank_mask:0xf
  v_and_b32_dpp v125, v98, v33 row_half_mirror row_mask:0xf bank_mask:0xf
  v_mfma_f32_16x16x32_bf16 v[116:119], a[68:71], v[120:123], v[116:119]
  v_and_b32 v126, v98, v34
  v_and_b32 v127, v98, v35
  ds_read_b128 v[144:147], v4 offset:12288
  s_waitcnt lgkmcnt(7)
  v_mfma_f32_16x16x32_bf16 v[112:115], v[148:151], v[124:127], v[112:115]
  v_and_b32 v120, v99, v32
  v_and_b32 v121, v99, v33
  v_mfma_f32_16x16x32_bf16 v[116:119], a[72:75], v[124:127], v[116:119]
  v_and_b32_dpp v122, v99, v34 row_half_mirror row_mask:0xf bank_mask:0xf
  v_and_b32_dpp v123, v99, v35 row_half_mirror row_mask:0xf bank_mask:0xf
  ds_read_b128 v[148:151], v4 offset:13312
  v_fmamk_f32 v100, v100, 0x3e0293ee, v106
  v_exp_f32 v100, v100
  s_nop 0
  v_add_f32 v107, v107, v100
  v_cvt_pk_bf16_f32 v100, v100, v100
  s_waitcnt lgkmcnt(7)
  v_mfma_f32_16x16x32_bf16 v[112:115], v[152:155], v[120:123], v[112:115]
  v_and_b32_dpp v124, v99, v32 row_half_mirror row_mask:0xf bank_mask:0xf
  v_and_b32_dpp v125, v99, v33 row_half_mirror row_mask:0xf bank_mask:0xf
  v_mfma_f32_16x16x32_bf16 v[116:119], a[76:79], v[120:123], v[116:119]
  v_and_b32 v126, v99, v34
  v_and_b32 v127, v99, v35
  ds_read_b128 v[152:155], v4 offset:14336
  s_waitcnt lgkmcnt(7)
  v_mfma_f32_16x16x32_bf16 v[112:115], v[156:159], v[124:127], v[112:115]
  v_and_b32 v120, v100, v32
  v_and_b32 v121, v100, v33
  v_mfma_f32_16x16x32_bf16 v[116:119], a[80:83], v[124:127], v[116:119]
  v_and_b32_dpp v122, v100, v34 row_half_mirror row_mask:0xf bank_mask:0xf
  v_and_b32_dpp v123, v100, v35 row_half_mirror row_mask:0xf bank_mask:0xf
  ds_read_b128 v[156:159], v4 offset:15360
  s_waitcnt vmcnt(9)
  s_add_u32 s29, s28, s39
  buffer_load_dwordx4 a[60:63], v2, s[8:11], s29 offen offset:1024 nt
  v_fmamk_f32 v101, v101, 0x3e0293ee, v106
  v_exp_f32 v101, v101
  s_nop 0
  v_add_f32 v107, v107, v101
  v_cvt_pk_bf16_f32 v101, v101, v101
  s_waitcnt lgkmcnt(7)
  v_mfma_f32_16x16x32_bf16 v[112:115], v[128:131], v[120:123], v[112:115]
  v_and_b32_dpp v124, v100, v32 row_half_mirror row_mask:0xf bank_mask:0xf
  v_and_b32_dpp v125, v100, v33 row_half_mirror row_mask:0xf bank_mask:0xf
  v_mfma_f32_16x16x32_bf16 v[116:119], a[84:87], v[120:123], v[116:119]
  v_and_b32 v126, v100, v34
  v_and_b32 v127, v100, v35
  ds_read_b128 v[128:131], v4 offset:16384
  s_waitcnt lgkmcnt(7)
  v_mfma_f32_16x16x32_bf16 v[112:115], v[132:135], v[124:127], v[112:115]
  v_and_b32 v120, v101, v32
  v_and_b32 v121, v101, v33
  v_mfma_f32_16x16x32_bf16 v[116:119], a[88:91], v[124:127], v[116:119]
  v_and_b32_dpp v122, v101, v34 row_half_mirror row_mask:0xf bank_mask:0xf
  v_and_b32_dpp v123, v101, v35 row_half_mirror row_mask:0xf bank_mask:0xf
  ds_read_b128 v[132:135], v4 offset:17408
  v_fmamk_f32 v102, v102, 0x3e0293ee, v106
  v_exp_f32 v102, v102
  s_nop 0
  v_add_f32 v107, v107, v102
  v_cvt_pk_bf16_f32 v102, v102, v102
  s_waitcnt lgkmcnt(7)
  v_mfma_f32_16x16x32_bf16 v[112:115], v[136:139], v[120:123], v[112:115]
  v_and_b32_dpp v124, v101, v32 row_half_mirror row_mask:0xf bank_mask:0xf
  v_and_b32_dpp v125, v101, v33 row_half_mirror row_mask:0xf bank_mask:0xf
  v_mfma_f32_16x16x32_bf16 v[116:119], a[92:95], v[120:123], v[116:119]
  v_and_b32 v126, v101, v34
  v_and_b32 v127, v101, v35
  s_waitcnt vmcnt(9)
  buffer_load_dwordx4 a[64:67], v2, s[8:11], s29 offen offset:3072 nt
  s_waitcnt lgkmcnt(6)
  v_mfma_f32_16x16x32_bf16 v[112:115], v[140:143], v[124:127], v[112:115]
  v_and_b32 v120, v102, v32
  v_and_b32 v121, v102, v33
  v_mfma_f32_16x16x32_bf16 v[116:119], a[96:99], v[124:127], v[116:119]
  v_and_b32_dpp v122, v102, v34 row_half_mirror row_mask:0xf bank_mask:0xf
  v_and_b32_dpp v123, v102, v35 row_half_mirror row_mask:0xf bank_mask:0xf
  v_fmamk_f32 v103, v103, 0x3e0293ee, v106
  v_exp_f32 v103, v103
  s_nop 0
  v_add_f32 v107, v107, v103
  v_cvt_pk_bf16_f32 v103, v103, v103
  s_waitcnt lgkmcnt(5)
  v_mfma_f32_16x16x32_bf16 v[112:115], v[144:147], v[120:123], v[112:115]
  v_and_b32_dpp v124, v102, v32 row_half_mirror row_mask:0xf bank_mask:0xf
  v_and_b32_dpp v125, v102, v33 row_half_mirror row_mask:0xf bank_mask:0xf
  v_mfma_f32_16x16x32_bf16 v[116:119], a[100:103], v[120:123], v[116:119]
  v_and_b32 v126, v102, v34
  v_and_b32 v127, v102, v35
  s_waitcnt lgkmcnt(4)
  s_nop 0
  v_mfma_f32_16x16x32_bf16 v[112:115], v[148:151], v[124:127], v[112:115]
  v_and_b32 v120, v103, v32
  v_and_b32 v121, v103, v33
  v_mfma_f32_16x16x32_bf16 v[116:119], a[104:107], v[124:127], v[116:119]
  v_and_b32_dpp v122, v103, v34 row_half_mirror row_mask:0xf bank_mask:0xf
  v_and_b32_dpp v123, v103, v35 row_half_mirror row_mask:0xf bank_mask:0xf
  v_fmamk_f32 v104, v104, 0x3e0293ee, v106
  v_exp_f32 v104, v104
  s_nop 0
  v_add_f32 v107, v107, v104
  v_cvt_pk_bf16_f32 v104, v104, v104
  s_waitcnt lgkmcnt(3)
  v_mfma_f32_16x16x32_bf16 v[112:115], v[152:155], v[120:123], v[112:115]
  v_and_b32_dpp v124, v103, v32 row_half_mirror row_mask:0xf bank_mask:0xf
  v_and_b32_dpp v125, v103, v33 row_half_mirror row_mask:0xf bank_mask:0xf
  v_mfma_f32_16x16x32_bf16 v[116:119], a[108:111], v[120:123], v[116:119]
  v_and_b32 v126, v103, v34
  v_and_b32 v127, v103, v35
  s_waitcnt vmcnt(9)
  s_add_u32 s29, s28, s50
  buffer_load_dwordx4 a[68:71], v2, s[8:11], s29 offen offset:1024 nt
  s_waitcnt lgkmcnt(2)
  v_mfma_f32_16x16x32_bf16 v[112:115], v[156:159], v[124:127], v[112:115]
  v_and_b32 v120, v104, v32
  v_and_b32 v121, v104, v33
  v_mfma_f32_16x16x32_bf16 v[116:119], a[112:115], v[124:127], v[116:119]
  v_and_b32_dpp v122, v104, v34 row_half_mirror row_mask:0xf bank_mask:0xf
  v_and_b32_dpp v123, v104, v35 row_half_mirror row_mask:0xf bank_mask:0xf
  v_fmamk_f32 v105, v105, 0x3e0293ee, v106
  v_exp_f32 v105, v105
  s_nop 0
  v_add_f32 v107, v107, v105
  v_cvt_pk_bf16_f32 v105, v105, v105
  s_waitcnt lgkmcnt(1)
  v_mfma_f32_16x16x32_bf16 v[112:115], v[128:131], v[120:123], v[112:115]
  v_and_b32_dpp v124, v104, v32 row_half_mirror row_mask:0xf bank_mask:0xf
  v_and_b32_dpp v125, v104, v33 row_half_mirror row_mask:0xf bank_mask:0xf
  v_mfma_f32_16x16x32_bf16 v[116:119], a[116:119], v[120:123], v[116:119]
  v_and_b32 v126, v104, v34
  v_and_b32 v127, v104, v35
  s_waitcnt lgkmcnt(0)
  s_nop 0
  v_mfma_f32_16x16x32_bf16 v[112:115], v[132:135], v[124:127], v[112:115]
  v_and_b32 v120, v105, v32
  v_and_b32 v121, v105, v33
  v_mfma_f32_16x16x32_bf16 v[116:119], a[120:123], v[124:127], v[116:119]
  v_and_b32_dpp v122, v105, v34 row_half_mirror row_mask:0xf bank_mask:0xf
  v_and_b32_dpp v123, v105, v35 row_half_mirror row_mask:0xf bank_mask:0xf
  s_nop 1
  v_mfma_f32_16x16x32_bf16 v[112:115], a[124:127], v[120:123], v[112:115]
  v_add_f32_dpp v107, v107, v107 row_ror:4 row_mask:0xf bank_mask:0xf
  s_nop 1
  v_add_f32_dpp v107, v107, v107 row_ror:8 row_mask:0xf bank_mask:0xf
  s_nop 1
  v_add_f32_dpp v107, v107, v107 row_bcast:15 row_mask:0xa bank_mask:0xf
  s_nop 1
  v_add_f32_dpp v107, v107, v107 row_bcast:31 row_mask:0xc bank_mask:0xf
  v_mov_b32 v0, s54
  s_mov_b32 exec_lo, 0
  s_mov_b32 exec_hi, 0x80000000
  ds_write_b64 v0, v[106:107] offset:8256
  s_mov_b64 exec, -1
  s_waitcnt vmcnt(9)
  buffer_load_dwordx4 a[72:75], v2, s[8:11], s29 offen offset:3072 nt
  v_lshrrev_b32 v0, 1, v2
  v_add_u32 v5, s53, v0
  v_mov_b32 v42, 1
  v_mov_b32 v43, 0
  v_add_f32_dpp v40, v116, v112 row_ror:8 row_mask:0xf bank_mask:0x3
  v_add_f32_dpp v41, v117, v113 row_ror:8 row_mask:0xf bank_mask:0x3
  s_nop 0
  v_add_f32_dpp v40, v114, v118 row_ror:8 row_mask:0xf bank_mask:0xc
  v_add_f32_dpp v41, v115, v119 row_ror:8 row_mask:0xf bank_mask:0xc
  ds_write_b64 v5, v[40:41] offset:4096
  s_mov_b64 exec, 1
  ds_add_rtn_u32 v42, v43, v42 offset:8328
  s_mov_b64 exec, -1
  ds_read_b128 v[16:19], v43 offset:8256
  ds_read_b128 v[20:23], v43 offset:8272
  ds_read_b64 v[24:25], v0 offset:4096
  ds_read_b64 v[26:27], v0 offset:4608
  ds_read_b64 v[28:29], v0 offset:5120
  ds_read_b64 v[30:31], v0 offset:5632
  s_waitcnt lgkmcnt(4)
  v_readfirstlane_b32 s56, v42
  v_min3_f32 v44, v16, v18, v20
  s_and_b32 s56, s56, 3
  s_cmp_lg_u32 s56, 3
  s_cbranch_scc1 Lpubnot_34
  v_min_f32 v44, v44, v22
  v_sub_f32 v16, v44, v16
  v_sub_f32 v18, v44, v18
  v_sub_f32 v20, v44, v20
  v_sub_f32 v22, v44, v22
  v_exp_f32 v16, v16
  v_exp_f32 v18, v18
  v_exp_f32 v20, v20
  v_exp_f32 v22, v22
  s_waitcnt lgkmcnt(0)
  v_mul_f32 v40, v16, v24
  v_mul_f32 v41, v16, v25
  v_mul_f32 v45, v16, v17
  v_fmac_f32 v40, v18, v26
  v_fmac_f32 v41, v18, v27
  v_fmac_f32 v45, v18, v19
  v_fmac_f32 v40, v20, v28
  v_fmac_f32 v41, v20, v29
  v_fmac_f32 v45, v20, v21
  v_fmac_f32 v40, v22, v30
  v_fmac_f32 v41, v22, v31
  v_fmac_f32 v45, v22, v23
  s_add_u32 s56, s37, s55
  s_cmp_eq_u32 s32, 0
  s_cbranch_scc1 Lpubnl_35
  buffer_store_dwordx2 v[40:41], v0, s[20:23], s37 offen
  s_mov_b64 exec, 1
  buffer_store_dwordx2 v[44:45], off, s[20:23], s56
  s_mov_b64 exec, -1
  s_branch Lpubdone_33
Lpubnl_35:
  buffer_store_dwordx2 v[40:41], v0, s[20:23], s37 offen sc1
  s_mov_b64 exec, 1
  buffer_store_dwordx2 v[44:45], off, s[20:23], s56 sc1
  s_mov_b64 exec, -1
  s_branch Lpubdone_33
Lpubnot_34:
  v_mov_b32 v0, 0x7ffffff0
  s_mov_b64 exec, 1
  buffer_store_dword v0, v0, s[20:23], 0 offen
  buffer_store_dword v0, v0, s[20:23], 0 offen
  s_mov_b64 exec, -1
  s_waitcnt lgkmcnt(0)
Lpubdone_33:
  s_add_u32 s37, s37, 131072
Lmainpost0:
  s_nop 7
  s_branch Lqchk_38
Lqw_36:
  s_sub_u32 s33, s33, 1
  s_cbranch_scc1 Lend
  buffer_load_dwordx4 v[36:39], v3, s[20:23], s35 offen sc1
  s_waitcnt vmcnt(0)
Lqchk_38:
  v_max3_u32 v0, v36, v37, v38
  v_max_u32 v0, v0, v39
  v_cmp_eq_u32 vcc, -1, v0
  s_cbranch_vccnz Lqw_36
  s_cmp_lg_u32 s52, 0
  s_cselect_b64 vcc, -1, 0
  v_cndmask_b32 v16, 0, v36, s[40:41]
  v_cndmask_b32 v17, 0, v37, s[40:41]
  v_cndmask_b32 v18, 0, v38, s[40:41]
  v_cndmask_b32 v19, 0, v39, s[40:41]
  v_cndmask_b32 v20, 0, v36, s[42:43]
  v_cndmask_b32 v21, 0, v37, s[42:43]
  v_cndmask_b32 v22, 0, v38, s[42:43]
  v_cndmask_b32 v23, 0, v39, s[42:43]
  v_cndmask_b32 v24, 0, v36, s[44:45]
  v_cndmask_b32 v25, 0, v37, s[44:45]
  v_cndmask_b32 v26, 0, v38, s[44:45]
  v_cndmask_b32 v27, 0, v39, s[44:45]
  v_cndmask_b32 v28, 0, v36, s[46:47]
  v_cndmask_b32 v29, 0, v37, s[46:47]
  v_cndmask_b32 v30, 0, v38, s[46:47]
  v_cndmask_b32 v31, 0, v39, s[46:47]
  v_mov_b32 v10, v36
  v_mov_b32 v11, v37
  v_mov_b32 v12, v38
  v_mov_b32 v13, v39
  v_mov_b32 v48, -1
  v_mov_b32 v49, -1
  v_bfe_u32 v50, v2, 1, 7
  s_lshr_b32 s56, s53, 2
  v_add_u32 v50, s56, v50
  s_mov_b32 exec_lo, 0
  v_mov_b32 v50, s55
  s_mov_b32 exec_lo, 0xffff0000
  s_mov_b32 exec_hi, 2
  v_add_u32 v50, 917504, v50
  s_mov_b32 exec_lo, -1
  s_mov_b32 exec_hi, 3
  s_add_u32 s56, s36, 131072
  s_cmp_eq_u32 s32, 0
  s_cbranch_scc1 Lnl_39
  buffer_store_dwordx2 v[48:49], v50, s[20:23], s56 offen
  s_branch Ldn_40
Lnl_39:
  buffer_store_dwordx2 v[48:49], v50, s[20:23], s56 offen sc1
Ldn_40:
  s_mov_b64 exec, -1
  s_waitcnt vmcnt(12)
  s_add_u32 s29, s28, s51
  buffer_load_dwordx4 a[76:79], v2, s[8:11], s29 offen offset:1024 nt
  s_waitcnt vmcnt(12)
  buffer_load_dwordx4 a[80:83], v2, s[8:11], s29 offen offset:3072 nt
  s_waitcnt vmcnt(10)
  s_add_u32 s29, s28, s64
  s_add_u32 m0, s38, 17408
  s_nop 0
  buffer_load_dwordx4 v2, s[8:11], s29 offen offset:0 nt lds
  s_waitcnt vmcnt(10)
  buffer_load_dwordx4 a[84:87], v2, s[8:11], s29 offen offset:1024 nt
  s_waitcnt vmcnt(10)
  s_add_u32 m0, s38, 16384
  s_nop 0
  buffer_load_dwordx4 v2, s[8:11], s29 offen offset:2048 nt lds
  s_waitcnt vmcnt(10)
  buffer_load_dwordx4 a[88:91], v2, s[8:11], s29 offen offset:3072 nt
  s_waitcnt vmcnt(10)
  s_add_u32 s29, s28, s65
  s_add_u32 m0, s38, 19456
  s_nop 0
  buffer_load_dwordx4 v2, s[8:11], s29 offen offset:0 nt lds
  s_waitcnt vmcnt(10)
  buffer_load_dwordx4 a[92:95], v2, s[8:11], s29 offen offset:1024 nt
  s_waitcnt vmcnt(7)
  s_add_u32 m0, s38, 18432
  s_nop 0
  buffer_load_dwordx4 v2, s[8:11], s29 offen offset:2048 nt lds
  s_waitcnt vmcnt(7)
  buffer_load_dwordx4 a[96:99], v2, s[8:11], s29 offen offset:3072 nt
  s_waitcnt vmcnt(7)
  s_add_u32 s29, s28, s66
  s_add_u32 m0, s38, 21504
  s_nop 0
  buffer_load_dwordx4 v2, s[8:11], s29 offen offset:0 nt lds
  s_waitcnt vmcnt(7)
  buffer_load_dwordx4 a[100:103], v2, s[8:11], s29 offen offset:1024 nt
  s_waitcnt vmcnt(7)
  s_add_u32 m0, s38, 20480
  s_nop 0
  buffer_load_dwordx4 v2, s[8:11], s29 offen offset:2048 nt lds
  s_waitcnt vmcnt(7)
  buffer_load_dwordx4 a[104:107], v2, s[8:11], s29 offen offset:3072 nt
  s_waitcnt vmcnt(7)
  s_add_u32 s29, s28, s67
  s_add_u32 m0, s38, 23552
  s_nop 0
  buffer_load_dwordx4 v2, s[8:11], s29 offen offset:0 nt lds
  s_waitcnt vmcnt(7)
  buffer_load_dwordx4 a[108:111], v2, s[8:11], s29 offen offset:1024 nt
  s_waitcnt vmcnt(7)
  s_add_u32 m0, s38, 22528
  s_nop 0
  buffer_load_dwordx4 v2, s[8:11], s29 offen offset:2048 nt lds
  s_waitcnt vmcnt(7)
  buffer_load_dwordx4 a[112:115], v2, s[8:11], s29 offen offset:3072 nt
  s_waitcnt vmcnt(7)
  s_add_u32 s29, s28, s68
  s_add_u32 m0, s38, 25600
  s_nop 0
  buffer_load_dwordx4 v2, s[8:11], s29 offen offset:0 nt lds
  s_waitcnt vmcnt(7)
  buffer_load_dwordx4 a[116:119], v2, s[8:11], s29 offen offset:1024 nt
  s_waitcnt vmcnt(7)
  s_add_u32 m0, s38, 24576
  s_nop 0
  buffer_load_dwordx4 v2, s[8:11], s29 offen offset:2048 nt lds
  s_waitcnt vmcnt(7)
  buffer_load_dwordx4 a[120:123], v2, s[8:11], s29 offen offset:3072 nt
  s_waitcnt vmcnt(7)
  s_add_u32 s29, s28, s69
  buffer_load_dwordx4 a[124:127], v2, s[16:19], s29 offen offset:0 nt
  s_waitcnt vmcnt(7)
  buffer_load_dwordx4 a[48:51], v1, s[12:15], s29 offen offset:0 nt
  s_waitcnt vmcnt(7)
  s_add_u32 s29, s28, s31
  buffer_load_dwordx4 v[64:67], v1, s[4:7], s29 offen offset:0 nt
  s_waitcnt vmcnt(7)
  buffer_load_dwordx4 v[68:71], v1, s[4:7], s29 offen offset:1024 nt
  s_waitcnt vmcnt(7)
  buffer_load_dwordx4 v[72:75], v1, s[4:7], s29 offen offset:2048 nt
  s_waitcnt vmcnt(7)
  buffer_load_dwordx4 v[76:79], v1, s[4:7], s29 offen offset:3072 nt
  s_waitcnt vmcnt(7)
  s_add_u32 s29, s28, s39
  buffer_load_dwordx4 v[80:83], v1, s[4:7], s29 offen offset:0 nt
  s_waitcnt vmcnt(7)
  buffer_load_dwordx4 v[84:87], v1, s[4:7], s29 offen offset:1024 nt
  s_waitcnt vmcnt(7)
  buffer_load_dwordx4 v[88:91], v1, s[4:7], s29 offen offset:2048 nt
  s_waitcnt vmcnt(7)
  buffer_load_dwordx4 v[92:95], v1, s[4:7], s29 offen offset:3072 nt
  s_waitcnt vmcnt(7)
  s_add_u32 s29, s28, s50
  buffer_load_dwordx4 a[0:3], v1, s[4:7], s29 offen offset:0 nt
  s_waitcnt vmcnt(7)
  buffer_load_dwordx4 a[4:7], v1, s[4:7], s29 offen offset:1024 nt
  s_waitcnt vmcnt(7)
  buffer_load_dwordx4 a[8:11], v1, s[4:7], s29 offen offset:2048 nt
  s_waitcnt vmcnt(7)
  buffer_load_dwordx4 a[12:15], v1, s[4:7], s29 offen offset:3072 nt
  v_mfma_f32_16x16x32_bf16 v[40:43], a[48:51], v[16:19], 0
  v_mfma_f32_16x16x32_bf16 v[44:47], v[64:67], v[16:19], 0
  v_mfma_f32_16x16x32_bf16 v[44:47], v[68:71], v[24:27], v[44:47]
  v_mfma_f32_16x16x32_bf16 v[44:47], v[72:75], v[20:23], v[44:47]
  v_mfma_f32_16x16x32_bf16 v[44:47], v[76:79], v[28:31], v[44:47]
  s_nop 3
  v_mov_b32_dpp v6, v40 quad_perm:[0,0,0,0] row_mask:0xf bank_mask:0xf
  s_nop 2
  v_mov_b32_dpp v7, v44 quad_perm:[0,0,0,0] row_mask:0xf bank_mask:0xf
  v_add_f32_dpp v6, v41, v6 quad_perm:[1,1,1,1] row_mask:0xf bank_mask:0xf
  s_nop 0
  v_add_f32_dpp v7, v45, v7 quad_perm:[1,1,1,1] row_mask:0xf bank_mask:0xf
  v_add_f32_dpp v6, v42, v6 quad_perm:[2,2,2,2] row_mask:0xf bank_mask:0xf
  s_nop 0
  v_add_f32_dpp v7, v46, v7 quad_perm:[2,2,2,2] row_mask:0xf bank_mask:0xf
  v_add_f32_dpp v6, v43, v6 quad_perm:[3,3,3,3] row_mask:0xf bank_mask:0xf
  s_nop 0
  v_add_f32_dpp v7, v47, v7 quad_perm:[3,3,3,3] row_mask:0xf bank_mask:0xf
  s_mov_b64 exec, s[48:49]
  v_mov_b32 v6, 0xff800000
  s_mov_b64 exec, -1
  v_cvt_pk_bf16_f32 v0, v6, v7
  v_lshlrev_b32 v6, 16, v0
  v_and_b32 v7, s95, v0
  v_mul_f32 v6, s94, v6
  v_mul_f32 v7, s94, v7
  v_cvt_pk_bf16_f32 v0, v6, v7
  v_lshlrev_b32 v6, 16, v0
  v_and_b32 v7, s95, v0
  v_max_f32 v14, v6, v7
  s_nop 1
  v_max_f32_dpp v14, v14, v14 row_ror:4 row_mask:0xf bank_mask:0xf
  s_nop 1
  v_max_f32_dpp v14, v14, v14 row_ror:8 row_mask:0xf bank_mask:0xf
  s_nop 1
  v_max_f32_dpp v14, v14, v14 row_bcast:15 row_mask:0xa bank_mask:0xf
  s_nop 1
  v_max_f32_dpp v14, v14, v14 row_bcast:31 row_mask:0xc bank_mask:0xf
  v_mul_f32 v14, 0xbfb8aa3b, v14
  s_nop 0
  v_readlane_b32 s56, v14, 63
  s_nop 1
  v_mov_b32 v8, s56
  v_fmamk_f32 v6, v6, 0x3fb8aa3b, v8
  v_fmamk_f32 v7, v7, 0x3fb8aa3b, v8
  v_exp_f32 v6, v6
  v_exp_f32 v7, v7
  v_mov_b32 v9, v6
  v_cvt_pk_bf16_f32 v6, v6, v6
  v_add_f32 v9, v9, v7
  v_cvt_pk_bf16_f32 v7, v7, v7
  s_waitcnt vmcnt(7)
  s_add_u32 s29, s28, s51
  buffer_load_dwordx4 a[16:19], v1, s[4:7], s29 offen offset:0 nt
  ds_read_b128 v[40:43], v4 offset:0
  ds_read_b128 v[44:47], v4 offset:1024
  v_and_b32 v60, v6, v32
  v_and_b32 v61, v6, v33
  v_and_b32_dpp v62, v6, v34 row_half_mirror row_mask:0xf bank_mask:0xf
  v_and_b32_dpp v63, v6, v35 row_half_mirror row_mask:0xf bank_mask:0xf
  s_nop 1
  v_mfma_f32_16x16x32_bf16 v[52:55], a[124:127], v[60:63], 0
  v_and_b32 v60, v7, v32
  v_and_b32 v61, v7, v33
  v_and_b32_dpp v62, v7, v34 row_half_mirror row_mask:0xf bank_mask:0xf
  v_and_b32_dpp v63, v7, v35 row_half_mirror row_mask:0xf bank_mask:0xf
  s_waitcnt lgkmcnt(1)
  s_nop 0
  v_mfma_f32_16x16x32_bf16 v[52:55], v[40:43], v[60:63], v[52:55]
  v_mfma_f32_16x16x32_bf16 v[56:59], a[52:55], v[60:63], 0
  v_and_b32_dpp v60, v7, v32 row_half_mirror row_mask:0xf bank_mask:0xf
  v_and_b32_dpp v61, v7, v33 row_half_mirror row_mask:0xf bank_mask:0xf
  v_and_b32 v62, v7, v34
  v_and_b32 v63, v7, v35
  s_waitcnt lgkmcnt(0)
  s_nop 0
  v_mfma_f32_16x16x32_bf16 v[52:55], v[44:47], v[60:63], v[52:55]
  v_mfma_f32_16x16x32_bf16 v[56:59], a[56:59], v[60:63], v[56:59]
  s_waitcnt vmcnt(7)
  buffer_load_dwordx4 a[20:23], v1, s[4:7], s29 offen offset:1024 nt
  s_waitcnt vmcnt(7)
  buffer_load_dwordx4 a[24:27], v1, s[4:7], s29 offen offset:2048 nt
  s_waitcnt vmcnt(7)
  buffer_load_dwordx4 a[28:31], v1, s[4:7], s29 offen offset:3072 nt
  s_waitcnt vmcnt(7)
  s_add_u32 s29, s28, s64
  buffer_load_dwordx4 a[32:35], v1, s[4:7], s29 offen offset:0 nt
  s_waitcnt vmcnt(7)
  buffer_load_dwordx4 a[36:39], v1, s[4:7], s29 offen offset:1024 nt
  s_waitcnt vmcnt(7)
  buffer_load_dwordx4 a[40:43], v1, s[4:7], s29 offen offset:2048 nt
  s_waitcnt vmcnt(7)
  buffer_load_dwordx4 a[44:47], v1, s[4:7], s29 offen offset:3072 nt
  v_mfma_f32_16x16x32_bf16 v[40:43], v[80:83], v[16:19], 0
  v_mfma_f32_16x16x32_bf16 v[40:43], v[84:87], v[24:27], v[40:43]
  v_mfma_f32_16x16x32_bf16 v[40:43], v[88:91], v[20:23], v[40:43]
  v_mfma_f32_16x16x32_bf16 v[40:43], v[92:95], v[28:31], v[40:43]
  v_mfma_f32_16x16x32_bf16 v[44:47], a[0:3], v[16:19], 0
  v_mfma_f32_16x16x32_bf16 v[44:47], a[4:7], v[24:27], v[44:47]
  v_mfma_f32_16x16x32_bf16 v[44:47], a[8:11], v[20:23], v[44:47]
  v_mfma_f32_16x16x32_bf16 v[44:47], a[12:15], v[28:31], v[44:47]
  s_nop 3
  v_mov_b32_dpp v6, v40 quad_perm:[0,0,0,0] row_mask:0xf bank_mask:0xf
  s_nop 2
  v_mov_b32_dpp v7, v44 quad_perm:[0,0,0,0] row_mask:0xf bank_mask:0xf
  v_add_f32_dpp v6, v41, v6 quad_perm:[1,1,1,1] row_mask:0xf bank_mask:0xf
  s_nop 0
  v_add_f32_dpp v7, v45, v7 quad_perm:[1,1,1,1] row_mask:0xf bank_mask:0xf
  v_add_f32_dpp v6, v42, v6 quad_perm:[2,2,2,2] row_mask:0xf bank_mask:0xf
  s_nop 0
  v_add_f32_dpp v7, v46, v7 quad_perm:[2,2,2,2] row_mask:0xf bank_mask:0xf
  v_add_f32_dpp v6, v43, v6 quad_perm:[3,3,3,3] row_mask:0xf bank_mask:0xf
  s_nop 0
  v_add_f32_dpp v7, v47, v7 quad_perm:[3,3,3,3] row_mask:0xf bank_mask:0xf
  v_cvt_pk_bf16_f32 v0, v6, v7
  v_lshlrev_b32 v6, 16, v0
  v_and_b32 v7, s95, v0
  v_mul_f32 v6, s94, v6
  v_mul_f32 v7, s94, v7
  v_cvt_pk_bf16_f32 v0, v6, v7
  v_lshlrev_b32 v6, 16, v0
  v_and_b32 v7, s95, v0
  v_max_f32 v14, v6, v7
  s_nop 1
  v_max_f32_dpp v14, v14, v14 row_ror:4 row_mask:0xf bank_mask:0xf
  s_nop 1
  v_max_f32_dpp v14, v14, v14 row_ror:8 row_mask:0xf bank_mask:0xf
  s_nop 1
  v_max_f32_dpp v14, v14, v14 row_bcast:15 row_mask:0xa bank_mask:0xf
  s_nop 1
  v_max_f32_dpp v14, v14, v14 row_bcast:31 row_mask:0xc bank_mask:0xf
  v_mul_f32 v14, 0xbfb8aa3b, v14
  s_nop 0
  v_readlane_b32 s56, v14, 63
  s_nop 1
  v_min_f32 v15, s56, v8
  v_sub_f32 v14, v15, v8
  v_mov_b32 v8, v15
  v_fmamk_f32 v6, v6, 0x3fb8aa3b, v8
  v_fmamk_f32 v7, v7, 0x3fb8aa3b, v8
  v_exp_f32 v6, v6
  v_exp_f32 v7, v7
  v_exp_f32 v14, v14
  s_nop 0
  v_fma_f32 v9, v14, v9, v6
  v_cvt_pk_bf16_f32 v6, v6, v6
  v_add_f32 v9, v9, v7
  v_cvt_pk_bf16_f32 v7, v7, v7
  v_mul_f32 v52, v14, v52
  v_mul_f32 v53, v14, v53
  v_mul_f32 v54, v14, v54
  v_mul_f32 v55, v14, v55
  v_mul_f32 v56, v14, v56
  v_mul_f32 v57, v14, v57
  v_mul_f32 v58, v14, v58
  v_mul_f32 v59, v14, v59
  s_waitcnt vmcnt(7)
  s_add_u32 s29, s28, s65
  buffer_load_dwordx4 v[96:99], v1, s[4:7], s29 offen offset:0 nt
  ds_read_b128 v[40:43], v4 offset:2048
  ds_read_b128 v[44:47], v4 offset:3072
  ds_read_b128 v[48:51], v4 offset:4096
  v_and_b32 v60, v6, v32
  v_and_b32 v61, v6, v33
  v_and_b32_dpp v62, v6, v34 row_half_mirror row_mask:0xf bank_mask:0xf
  v_and_b32_dpp v63, v6, v35 row_half_mirror row_mask:0xf bank_mask:0xf
  s_waitcnt lgkmcnt(2)
  s_nop 0
  v_mfma_f32_16x16x32_bf16 v[52:55], v[40:43], v[60:63], v[52:55]
  ds_read_b128 v[40:43], v4 offset:5120
  v_mfma_f32_16x16x32_bf16 v[56:59], a[60:63], v[60:63], v[56:59]
  v_and_b32_dpp v60, v6, v32 row_half_mirror row_mask:0xf bank_mask:0xf
  v_and_b32_dpp v61, v6, v33 row_half_mirror row_mask:0xf bank_mask:0xf
  v_and_b32 v62, v6, v34
  v_and_b32 v63, v6, v35
  s_waitcnt lgkmcnt(2)
  s_nop 0
  v_mfma_f32_16x16x32_bf16 v[52:55], v[44:47], v[60:63], v[52:55]
  v_mfma_f32_16x16x32_bf16 v[56:59], a[64:67], v[60:63], v[56:59]
  v_and_b32 v60, v7, v32
  v_and_b32 v61, v7, v33
  v_and_b32_dpp v62, v7, v34 row_half_mirror row_mask:0xf bank_mask:0xf
  v_and_b32_dpp v63, v7, v35 row_half_mirror row_mask:0xf bank_mask:0xf
  s_waitcnt lgkmcnt(1)
  s_nop 0
  v_mfma_f32_16x16x32_bf16 v[52:55], v[48:51], v[60:63], v[52:55]
  v_mfma_f32_16x16x32_bf16 v[56:59], a[68:71], v[60:63], v[56:59]
  v_and_b32_dpp v60, v7, v32 row_half_mirror row_mask:0xf bank_mask:0xf
  v_and_b32_dpp v61, v7, v33 row_half_mirror row_mask:0xf bank_mask:0xf
  v_and_b32 v62, v7, v34
  v_and_b32 v63, v7, v35
  s_waitcnt lgkmcnt(0)
  s_nop 0
  v_mfma_f32_16x16x32_bf16 v[52:55], v[40:43], v[60:63], v[52:55]
  v_mfma_f32_16x16x32_bf16 v[56:59], a[72:75], v[60:63], v[56:59]
  s_waitcnt vmcnt(7)
  buffer_load_dwordx4 v[100:103], v1, s[4:7], s29 offen offset:1024 nt
  s_waitcnt vmcnt(7)
  buffer_load_dwordx4 v[104:107], v1, s[4:7], s29 offen offset:2048 nt
  s_waitcnt vmcnt(7)
  buffer_load_dwordx4 v[108:111], v1, s[4:7], s29 offen offset:3072 nt
  s_waitcnt vmcnt(7)
  s_add_u32 s29, s28, s66
  buffer_load_dwordx4 v[112:115], v1, s[4:7], s29 offen offset:0 nt
  s_waitcnt vmcnt(7)
  buffer_load_dwordx4 v[116:119], v1, s[4:7], s29 offen offset:1024 nt
  s_waitcnt vmcnt(7)
  buffer_load_dwordx4 v[120:123], v1, s[4:7], s29 offen offset:2048 nt
  s_waitcnt vmcnt(7)
  buffer_load_dwordx4 v[124:127], v1, s[4:7], s29 offen offset:3072 nt
  v_mfma_f32_16x16x32_bf16 v[40:43], a[16:19], v[16:19], 0
  v_mfma_f32_16x16x32_bf16 v[40:43], a[20:23], v[24:27], v[40:43]
  v_mfma_f32_16x16x32_bf16 v[40:43], a[24:27], v[20:23], v[40:43]
  v_mfma_f32_16x16x32_bf16 v[40:43], a[28:31], v[28:31], v[40:43]
  v_mfma_f32_16x16x32_bf16 v[44:47], a[32:35], v[16:19], 0
  v_mfma_f32_16x16x32_bf16 v[44:47], a[36:39], v[24:27], v[44:47]
  v_mfma_f32_16x16x32_bf16 v[44:47], a[40:43], v[20:23], v[44:47]
  v_mfma_f32_16x16x32_bf16 v[44:47], a[44:47], v[28:31], v[44:47]
  s_nop 3
  v_mov_b32_dpp v6, v40 quad_perm:[0,0,0,0] row_mask:0xf bank_mask:0xf
  s_nop 2
  v_mov_b32_dpp v7, v44 quad_perm:[0,0,0,0] row_mask:0xf bank_mask:0xf
  v_add_f32_dpp v6, v41, v6 quad_perm:[1,1,1,1] row_mask:0xf bank_mask:0xf
  s_nop 0
  v_add_f32_dpp v7, v45, v7 quad_perm:[1,1,1,1] row_mask:0xf bank_mask:0xf
  v_add_f32_dpp v6, v42, v6 quad_perm:[2,2,2,2] row_mask:0xf bank_mask:0xf
  s_nop 0
  v_add_f32_dpp v7, v46, v7 quad_perm:[2,2,2,2] row_mask:0xf bank_mask:0xf
  v_add_f32_dpp v6, v43, v6 quad_perm:[3,3,3,3] row_mask:0xf bank_mask:0xf
  s_nop 0
  v_add_f32_dpp v7, v47, v7 quad_perm:[3,3,3,3] row_mask:0xf bank_mask:0xf
  v_cvt_pk_bf16_f32 v0, v6, v7
  v_lshlrev_b32 v6, 16, v0
  v_and_b32 v7, s95, v0
  v_mul_f32 v6, s94, v6
  v_mul_f32 v7, s94, v7
  v_cvt_pk_bf16_f32 v0, v6, v7
  v_lshlrev_b32 v6, 16, v0
  v_and_b32 v7, s95, v0
  v_max_f32 v14, v6, v7
  s_nop 1
  v_max_f32_dpp v14, v14, v14 row_ror:4 row_mask:0xf bank_mask:0xf
  s_nop 1
  v_max_f32_dpp v14, v14, v14 row_ror:8 row_mask:0xf bank_mask:0xf
  s_nop 1
  v_max_f32_dpp v14, v14, v14 row_bcast:15 row_mask:0xa bank_mask:0xf
  s_nop 1
  v_max_f32_dpp v14, v14, v14 row_bcast:31 row_mask:0xc bank_mask:0xf
  v_mul_f32 v14, 0xbfb8aa3b, v14
  s_nop 0
  v_readlane_b32 s56, v14, 63
  s_nop 1
  v_min_f32 v15, s56, v8
  v_sub_f32 v14, v15, v8
  v_mov_b32 v8, v15
  v_fmamk_f32 v6, v6, 0x3fb8aa3b, v8
  v_fmamk_f32 v7, v7, 0x3fb8aa3b, v8
  v_exp_f32 v6, v6
  v_exp_f32 v7, v7
  v_exp_f32 v14, v14
  s_nop 0
  v_fma_f32 v9, v14, v9, v6
  v_cvt_pk_bf16_f32 v6, v6, v6
  v_add_f32 v9, v9, v7
  v_cvt_pk_bf16_f32 v7, v7, v7
  v_mul_f32 v52, v14, v52
  v_mul_f32 v53, v14, v53
  v_mul_f32 v54, v14, v54
  v_mul_f32 v55, v14, v55
  v_mul_f32 v56, v14, v56
  v_mul_f32 v57, v14, v57
  v_mul_f32 v58, v14, v58
  v_mul_f32 v59, v14, v59
  s_waitcnt vmcnt(7)
  buffer_load_dwordx4 v[36:39], v3, s[20:23], s34 offen sc1
  s_add_u32 s29, s28, s67
  buffer_load_dwordx4 v[128:131], v1, s[4:7], s29 offen offset:0 nt
  ds_read_b128 v[40:43], v4 offset:6144
  ds_read_b128 v[44:47], v4 offset:7168
  ds_read_b128 v[48:51], v4 offset:8192
  v_and_b32 v60, v6, v32
  v_and_b32 v61, v6, v33
  v_and_b32_dpp v62, v6, v34 row_half_mirror row_mask:0xf bank_mask:0xf
  v_and_b32_dpp v63, v6, v35 row_half_mirror row_mask:0xf bank_mask:0xf
  s_waitcnt lgkmcnt(2)
  s_nop 0
  v_mfma_f32_16x16x32_bf16 v[52:55], v[40:43], v[60:63], v[52:55]
  ds_read_b128 v[40:43], v4 offset:9216
  v_mfma_f32_16x16x32_bf16 v[56:59], a[76:79], v[60:63], v[56:59]
  v_and_b32_dpp v60, v6, v32 row_half_mirror row_mask:0xf bank_mask:0xf
  v_and_b32_dpp v61, v6, v33 row_half_mirror row_mask:0xf bank_mask:0xf
  v_and_b32 v62, v6, v34
  v_and_b32 v63, v6, v35
  s_waitcnt lgkmcnt(2)
  s_nop 0
  v_mfma_f32_16x16x32_bf16 v[52:55], v[44:47], v[60:63], v[52:55]
  v_mfma_f32_16x16x32_bf16 v[56:59], a[80:83], v[60:63], v[56:59]
  v_and_b32 v60, v7, v32
  v_and_b32 v61, v7, v33
  v_and_b32_dpp v62, v7, v34 row_half_mirror row_mask:0xf bank_mask:0xf
  v_and_b32_dpp v63, v7, v35 row_half_mirror row_mask:0xf bank_mask:0xf
  s_waitcnt lgkmcnt(1)
  s_nop 0
  v_mfma_f32_16x16x32_bf16 v[52:55], v[48:51], v[60:63], v[52:55]
  v_mfma_f32_16x16x32_bf16 v[56:59], a[84:87], v[60:63], v[56:59]
  v_and_b32_dpp v60, v7, v32 row_half_mirror row_mask:0xf bank_mask:0xf
  v_and_b32_dpp v61, v7, v33 row_half_mirror row_mask:0xf bank_mask:0xf
  v_and_b32 v62, v7, v34
  v_and_b32 v63, v7, v35
  s_waitcnt lgkmcnt(0)
  s_nop 0
  v_mfma_f32_16x16x32_bf16 v[52:55], v[40:43], v[60:63], v[52:55]
  v_mfma_f32_16x16x32_bf16 v[56:59], a[88:91], v[60:63], v[56:59]
  s_waitcnt vmcnt(8)
  buffer_load_dwordx4 v[132:135], v1, s[4:7], s29 offen offset:1024 nt
  s_waitcnt vmcnt(8)
  buffer_load_dwordx4 v[136:139], v1, s[4:7], s29 offen offset:2048 nt
  s_waitcnt vmcnt(8)
  buffer_load_dwordx4 v[140:143], v1, s[4:7], s29 offen offset:3072 nt
  s_waitcnt vmcnt(8)
  s_add_u32 s29, s28, s68
  buffer_load_dwordx4 v[144:147], v1, s[4:7], s29 offen offset:0 nt
  s_waitcnt vmcnt(8)
  buffer_load_dwordx4 v[148:151], v1, s[4:7], s29 offen offset:1024 nt
  s_waitcnt vmcnt(8)
  buffer_load_dwordx4 v[152:155], v1, s[4:7], s29 offen offset:2048 nt
  s_waitcnt vmcnt(8)
  buffer_load_dwordx4 v[156:159], v1, s[4:7], s29 offen offset:3072 nt
  v_mfma_f32_16x16x32_bf16 v[40:43], v[96:99], v[16:19], 0
  v_mfma_f32_16x16x32_bf16 v[40:43], v[100:103], v[24:27], v[40:43]
  v_mfma_f32_16x16x32_bf16 v[40:43], v[104:107], v[20:23], v[40:43]
  v_mfma_f32_16x16x32_bf16 v[40:43], v[108:111], v[28:31], v[40:43]
  v_mfma_f32_16x16x32_bf16 v[44:47], v[112:115], v[16:19], 0
  v_mfma_f32_16x16x32_bf16 v[44:47], v[116:119], v[24:27], v[44:47]
  v_mfma_f32_16x16x32_bf16 v[44:47], v[120:123], v[20:23], v[44:47]
  v_mfma_f32_16x16x32_bf16 v[44:47], v[124:127], v[28:31], v[44:47]
  s_nop 3
  v_mov_b32_dpp v6, v40 quad_perm:[0,0,0,0] row_mask:0xf bank_mask:0xf
  s_nop 2
  v_mov_b32_dpp v7, v44 quad_perm:[0,0,0,0] row_mask:0xf bank_mask:0xf
  v_add_f32_dpp v6, v41, v6 quad_perm:[1,1,1,1] row_mask:0xf bank_mask:0xf
  s_nop 0
  v_add_f32_dpp v7, v45, v7 quad_perm:[1,1,1,1] row_mask:0xf bank_mask:0xf
  v_add_f32_dpp v6, v42, v6 quad_perm:[2,2,2,2] row_mask:0xf bank_mask:0xf
  s_nop 0
  v_add_f32_dpp v7, v46, v7 quad_perm:[2,2,2,2] row_mask:0xf bank_mask:0xf
  v_add_f32_dpp v6, v43, v6 quad_perm:[3,3,3,3] row_mask:0xf bank_mask:0xf
  s_nop 0
  v_add_f32_dpp v7, v47, v7 quad_perm:[3,3,3,3] row_mask:0xf bank_mask:0xf
  v_cvt_pk_bf16_f32 v0, v6, v7
  v_lshlrev_b32 v6, 16, v0
  v_and_b32 v7, s95, v0
  v_mul_f32 v6, s94, v6
  v_mul_f32 v7, s94, v7
  v_cvt_pk_bf16_f32 v0, v6, v7
  v_lshlrev_b32 v6, 16, v0
  v_and_b32 v7, s95, v0
  v_max_f32 v14, v6, v7
  s_nop 1
  v_max_f32_dpp v14, v14, v14 row_ror:4 row_mask:0xf bank_mask:0xf
  s_nop 1
  v_max_f32_dpp v14, v14, v14 row_ror:8 row_mask:0xf bank_mask:0xf
  s_nop 1
  v_max_f32_dpp v14, v14, v14 row_bcast:15 row_mask:0xa bank_mask:0xf
  s_nop 1
  v_max_f32_dpp v14, v14, v14 row_bcast:31 row_mask:0xc bank_mask:0xf
  v_mul_f32 v14, 0xbfb8aa3b, v14
  s_nop 0
  v_readlane_b32 s56, v14, 63
  s_nop 1
  v_min_f32 v15, s56, v8
  v_sub_f32 v14, v15, v8
  v_mov_b32 v8, v15
  v_fmamk_f32 v6, v6, 0x3fb8aa3b, v8
  v_fmamk_f32 v7, v7, 0x3fb8aa3b, v8
  v_exp_f32 v6, v6
  v_exp_f32 v7, v7
  v_exp_f32 v14, v14
  s_nop 0
  v_fma_f32 v9, v14, v9, v6
  v_cvt_pk_bf16_f32 v6, v6, v6
  v_add_f32 v9, v9, v7
  v_cvt_pk_bf16_f32 v7, v7, v7
  v_mul_f32 v52, v14, v52
  v_mul_f32 v53, v14, v53
  v_mul_f32 v54, v14, v54
  v_mul_f32 v55, v14, v55
  v_mul_f32 v56, v14, v56
  v_mul_f32 v57, v14, v57
  v_mul_f32 v58, v14, v58
  v_mul_f32 v59, v14, v59
  ds_read_b128 v[40:43], v4 offset:10240
  ds_read_b128 v[44:47], v4 offset:11264
  ds_read_b128 v[48:51], v4 offset:12288
  v_and_b32 v60, v6, v32
  v_and_b32 v61, v6, v33
  v_and_b32_dpp v62, v6, v34 row_half_mirror row_mask:0xf bank_mask:0xf
  v_and_b32_dpp v63, v6, v35 row_half_mirror row_mask:0xf bank_mask:0xf
  s_waitcnt lgkmcnt(2)
  s_nop 0
  v_mfma_f32_16x16x32_bf16 v[52:55], v[40:43], v[60:63], v[52:55]
  ds_read_b128 v[40:43], v4 offset:13312
  v_mfma_f32_16x16x32_bf16 v[56:59], a[92:95], v[60:63], v[56:59]
  v_and_b32_dpp v60, v6, v32 row_half_mirror row_mask:0xf bank_mask:0xf
  v_and_b32_dpp v61, v6, v33 row_half_mirror row_mask:0xf bank_mask:0xf
  v_and_b32 v62, v6, v34
  v_and_b32 v63, v6, v35
  s_waitcnt lgkmcnt(2)
  s_nop 0
  v_mfma_f32_16x16x32_bf16 v[52:55], v[44:47], v[60:63], v[52:55]
  v_mfma_f32_16x16x32_bf16 v[56:59], a[96:99], v[60:63], v[56:59]
  v_and_b32 v60, v7, v32
  v_and_b32 v61, v7, v33
  v_and_b32_dpp v62, v7, v34 row_half_mirror row_mask:0xf bank_mask:0xf
  v_and_b32_dpp v63, v7, v35 row_half_mirror row_mask:0xf bank_mask:0xf
  s_waitcnt lgkmcnt(1)
  s_nop 0
  v_mfma_f32_16x16x32_bf16 v[52:55], v[48:51], v[60:63], v[52:55]
  v_mfma_f32_16x16x32_bf16 v[56:59], a[100:103], v[60:63], v[56:59]
  v_and_b32_dpp v60, v7, v32 row_half_mirror row_mask:0xf bank_mask:0xf
  v_and_b32_dpp v61, v7, v33 row_half_mirror row_mask:0xf bank_mask:0xf
  v_and_b32 v62, v7, v34
  v_and_b32 v63, v7, v35
  s_waitcnt lgkmcnt(0)
  s_nop 0
  v_mfma_f32_16x16x32_bf16 v[52:55], v[40:43], v[60:63], v[52:55]
  v_mfma_f32_16x16x32_bf16 v[56:59], a[104:107], v[60:63], v[56:59]
  s_add_u32 s28, s28, 0x2000000
  s_add_u32 s35, s35, 8192
  s_waitcnt vmcnt(8)
  v_max3_u32 v0, v36, v37, v38
  v_max_u32 v0, v0, v39
  v_cmp_eq_u32 vcc, -1, v0
  s_cbranch_vccnz Lnoq2_41
  s_mov_b32 s52, 1
  v_cndmask_b32 v16, 0, v36, s[40:41]
  v_cndmask_b32 v17, 0, v37, s[40:41]
  v_cndmask_b32 v18, 0, v38, s[40:41]
  v_cndmask_b32 v19, 0, v39, s[40:41]
  v_cndmask_b32 v20, 0, v36, s[42:43]
  v_cndmask_b32 v21, 0, v37, s[42:43]
  v_cndmask_b32 v22, 0, v38, s[42:43]
  v_cndmask_b32 v23, 0, v39, s[42:43]
  v_cndmask_b32 v24, 0, v36, s[44:45]
  v_cndmask_b32 v25, 0, v37, s[44:45]
  v_cndmask_b32 v26, 0, v38, s[44:45]
  v_cndmask_b32 v27, 0, v39, s[44:45]
  v_cndmask_b32 v28, 0, v36, s[46:47]
  v_cndmask_b32 v29, 0, v37, s[46:47]
  v_cndmask_b32 v30, 0, v38, s[46:47]
  v_cndmask_b32 v31, 0, v39, s[46:47]
  v_mfma_f32_16x16x32_bf16 v[40:43], v[192:195], v[16:19], 0
  v_mfma_f32_16x16x32_bf16 v[40:43], v[196:199], v[24:27], v[40:43]
  v_mfma_f32_16x16x32_bf16 v[40:43], v[200:203], v[20:23], v[40:43]
  v_mfma_f32_16x16x32_bf16 v[40:43], v[204:207], v[28:31], v[40:43]
  v_mfma_f32_16x16x32_bf16 v[44:47], v[160:163], v[16:19], 0
  v_mfma_f32_16x16x32_bf16 v[44:47], v[164:167], v[24:27], v[44:47]
  v_mfma_f32_16x16x32_bf16 v[44:47], v[168:171], v[20:23], v[44:47]
  v_mfma_f32_16x16x32_bf16 v[44:47], v[172:175], v[28:31], v[44:47]
  v_mfma_f32_16x16x32_bf16 v[48:51], v[176:179], v[16:19], 0
  s_nop 2
  v_mov_b32_dpp v197, v40 quad_perm:[0,0,0,0] row_mask:0xf bank_mask:0xf
  v_mov_b32_dpp v204, v42 quad_perm:[2,2,2,2] row_mask:0xf bank_mask:0xf
  v_mfma_f32_16x16x32_bf16 v[48:51], v[180:183], v[24:27], v[48:51]
  v_add_f32_dpp v197, v41, v197 quad_perm:[1,1,1,1] row_mask:0xf bank_mask:0xf
  v_add_f32_dpp v204, v43, v204 quad_perm:[3,3,3,3] row_mask:0xf bank_mask:0xf
  v_mfma_f32_16x16x32_bf16 v[48:51], v[184:187], v[20:23], v[48:51]
  v_add_f32 v197, v197, v204
  v_mfma_f32_16x16x32_bf16 v[48:51], v[188:191], v[28:31], v[48:51]
  buffer_load_dwordx4 v[36:39], v3, s[20:23], s35 offen sc1
  s_waitcnt vmcnt(8)
  s_add_u32 s29, s28, s31
  buffer_load_dwordx4 v[160:163], v1, s[4:7], s29 offen offset:0 nt
  v_mfma_f32_16x16x32_bf16 v[40:43], a[128:131], v[16:19], 0
  v_mov_b32_dpp v192, v44 quad_perm:[0,0,0,0] row_mask:0xf bank_mask:0xf
  v_mov_b32_dpp v204, v46 quad_perm:[2,2,2,2] row_mask:0xf bank_mask:0xf
  v_mfma_f32_16x16x32_bf16 v[40:43], a[132:135], v[24:27], v[40:43]
  v_add_f32_dpp v192, v45, v192 quad_perm:[1,1,1,1] row_mask:0xf bank_mask:0xf
  v_add_f32_dpp v204, v47, v204 quad_perm:[3,3,3,3] row_mask:0xf bank_mask:0xf
  v_mfma_f32_16x16x32_bf16 v[40:43], a[136:139], v[20:23], v[40:43]
  v_add_f32 v192, v192, v204
  v_mfma_f32_16x16x32_bf16 v[40:43], a[140:143], v[28:31], v[40:43]
  v_mfma_f32_16x16x32_bf16 v[44:47], v[224:227], v[16:19], 0
  v_mov_b32_dpp v193, v48 quad_perm:[0,0,0,0] row_mask:0xf bank_mask:0xf
  v_mov_b32_dpp v204, v50 quad_perm:[2,2,2,2] row_mask:0xf bank_mask:0xf
  v_mfma_f32_16x16x32_bf16 v[44:47], v[228:231], v[24:27], v[44:47]
  v_add_f32_dpp v193, v49, v193 quad_perm:[1,1,1,1] row_mask:0xf bank_mask:0xf
  v_add_f32_dpp v204, v51, v204 quad_perm:[3,3,3,3] row_mask:0xf bank_mask:0xf
  v_mfma_f32_16x16x32_bf16 v[44:47], v[232:235], v[20:23], v[44:47]
  v_add_f32 v193, v193, v204
  v_mfma_f32_16x16x32_bf16 v[44:47], v[236:239], v[28:31], v[44:47]
  v_mfma_f32_16x16x32_bf16 v[48:51], v[240:243], v[16:19], 0
  v_mov_b32_dpp v194, v40 quad_perm:[0,0,0,0] row_mask:0xf bank_mask:0xf
  v_mov_b32_dpp v204, v42 quad_perm:[2,2,2,2] row_mask:0xf bank_mask:0xf
  v_mfma_f32_16x16x32_bf16 v[48:51], v[244:247], v[24:27], v[48:51]
  v_add_f32_dpp v194, v41, v194 quad_perm:[1,1,1,1] row_mask:0xf bank_mask:0xf
  v_add_f32_dpp v204, v43, v204 quad_perm:[3,3,3,3] row_mask:0xf bank_mask:0xf
  v_mfma_f32_16x16x32_bf16 v[48:51], v[248:251], v[20:23], v[48:51]
  v_add_f32 v194, v194, v204
  v_mfma_f32_16x16x32_bf16 v[48:51], v[252:255], v[28:31], v[48:51]
  v_mfma_f32_16x16x32_bf16 v[40:43], v[208:211], v[16:19], 0
  v_mov_b32_dpp v199, v44 quad_perm:[0,0,0,0] row_mask:0xf bank_mask:0xf
  v_mov_b32_dpp v204, v46 quad_perm:[2,2,2,2] row_mask:0xf bank_mask:0xf
  v_mfma_f32_16x16x32_bf16 v[40:43], v[212:215], v[24:27], v[40:43]
  v_add_f32_dpp v199, v45, v199 quad_perm:[1,1,1,1] row_mask:0xf bank_mask:0xf
  v_add_f32_dpp v204, v47, v204 quad_perm:[3,3,3,3] row_mask:0xf bank_mask:0xf
  v_mfma_f32_16x16x32_bf16 v[40:43], v[216:219], v[20:23], v[40:43]
  v_add_f32 v199, v199, v204
  v_mfma_f32_16x16x32_bf16 v[40:43], v[220:223], v[28:31], v[40:43]
  s_waitcnt vmcnt(8)
  buffer_load_dwordx4 v[164:167], v1, s[4:7], s29 offen offset:1024 nt
  ds_read_b128 v[224:227], v4 offset:18432
  ds_read_b128 v[228:231], v4 offset:19456
  v_mfma_f32_16x16x32_bf16 v[44:47], a[144:147], v[16:19], 0
  v_mov_b32_dpp v200, v48 quad_perm:[0,0,0,0] row_mask:0xf bank_mask:0xf
  v_mov_b32_dpp v204, v50 quad_perm:[2,2,2,2] row_mask:0xf bank_mask:0xf
  v_mfma_f32_16x16x32_bf16 v[44:47], a[148:151], v[24:27], v[44:47]
  v_add_f32_dpp v200, v49, v200 quad_perm:[1,1,1,1] row_mask:0xf bank_mask:0xf
  v_add_f32_dpp v204, v51, v204 quad_perm:[3,3,3,3] row_mask:0xf bank_mask:0xf
  v_mfma_f32_16x16x32_bf16 v[44:47], a[152:155], v[20:23], v[44:47]
  v_add_f32 v200, v200, v204
  v_mfma_f32_16x16x32_bf16 v[44:47], a[156:159], v[28:31], v[44:47]
  ds_read_b128 v[232:235], v4 offset:20480
  ds_read_b128 v[236:239], v4 offset:21504
  v_mfma_f32_16x16x32_bf16 v[48:51], a[160:163], v[16:19], 0
  v_mov_b32_dpp v198, v40 quad_perm:[0,0,0,0] row_mask:0xf bank_mask:0xf
  v_mov_b32_dpp v204, v42 quad_perm:[2,2,2,2] row_mask:0xf bank_mask:0xf
  v_mfma_f32_16x16x32_bf16 v[48:51], a[164:167], v[24:27], v[48:51]
  v_add_f32_dpp v198, v41, v198 quad_perm:[1,1,1,1] row_mask:0xf bank_mask:0xf
  v_add_f32_dpp v204, v43, v204 quad_perm:[3,3,3,3] row_mask:0xf bank_mask:0xf
  v_mfma_f32_16x16x32_bf16 v[48:51], a[168:171], v[20:23], v[48:51]
  v_add_f32 v198, v198, v204
  v_mfma_f32_16x16x32_bf16 v[48:51], a[172:175], v[28:31], v[48:51]
  ds_read_b128 v[240:243], v4 offset:22528
  ds_read_b128 v[244:247], v4 offset:23552
  v_mfma_f32_16x16x32_bf16 v[40:43], a[176:179], v[16:19], 0
  v_mov_b32_dpp v195, v44 quad_perm:[0,0,0,0] row_mask:0xf bank_mask:0xf
  v_mov_b32_dpp v204, v46 quad_perm:[2,2,2,2] row_mask:0xf bank_mask:0xf
  s_nop 0
  v_add_f32_dpp v195, v45, v195 quad_perm:[1,1,1,1] row_mask:0xf bank_mask:0xf
  v_add_f32_dpp v204, v47, v204 quad_perm:[3,3,3,3] row_mask:0xf bank_mask:0xf
  v_add_f32 v195, v195, v204
  ds_read_b128 v[248:251], v4 offset:24576
  ds_read_b128 v[252:255], v4 offset:25600
  v_mov_b32_dpp v196, v48 quad_perm:[0,0,0,0] row_mask:0xf bank_mask:0xf
  v_mov_b32_dpp v204, v50 quad_perm:[2,2,2,2] row_mask:0xf bank_mask:0xf
  s_nop 0
  v_add_f32_dpp v196, v49, v196 quad_perm:[1,1,1,1] row_mask:0xf bank_mask:0xf
  v_add_f32_dpp v204, v51, v204 quad_perm:[3,3,3,3] row_mask:0xf bank_mask:0xf
  v_add_f32 v196, v196, v204
  s_waitcnt vmcnt(8)
  buffer_load_dwordx4 v[168:171], v1, s[4:7], s29 offen offset:2048 nt
  v_mov_b32_dpp v201, v40 quad_perm:[0,0,0,0] row_mask:0xf bank_mask:0xf
  v_mov_b32_dpp v204, v42 quad_perm:[2,2,2,2] row_mask:0xf bank_mask:0xf
  s_nop 0
  v_add_f32_dpp v201, v41, v201 quad_perm:[1,1,1,1] row_mask:0xf bank_mask:0xf
  v_add_f32_dpp v204, v43, v204 quad_perm:[3,3,3,3] row_mask:0xf bank_mask:0xf
  v_add_f32 v201, v201, v204
  s_mov_b64 exec, s[48:49]
  v_mov_b32 v201, 0xff800000
  s_mov_b64 exec, -1
  s_add_u32 s34, s34, 8192
  v_cndmask_b32 v16, 0, v10, s[40:41]
  v_cndmask_b32 v17, 0, v11, s[40:41]
  v_cndmask_b32 v18, 0, v12, s[40:41]
  v_cndmask_b32 v19, 0, v13, s[40:41]
  v_cndmask_b32 v20, 0, v10, s[42:43]
  v_cndmask_b32 v21, 0, v11, s[42:43]
  v_cndmask_b32 v22, 0, v12, s[42:43]
  v_cndmask_b32 v23, 0, v13, s[42:43]
  v_cndmask_b32 v24, 0, v10, s[44:45]
  v_cndmask_b32 v25, 0, v11, s[44:45]
  v_cndmask_b32 v26, 0, v12, s[44:45]
  v_cndmask_b32 v27, 0, v13, s[44:45]
  v_cndmask_b32 v28, 0, v10, s[46:47]
  v_cndmask_b32 v29, 0, v11, s[46:47]
  v_cndmask_b32 v30, 0, v12, s[46:47]
  v_cndmask_b32 v31, 0, v13, s[46:47]
  ds_read_b128 v[44:47], v4 offset:14336
  ds_read_b128 v[48:51], v4 offset:15360
  v_mfma_f32_16x16x32_bf16 v[40:43], v[128:131], v[16:19], 0
  v_mfma_f32_16x16x32_bf16 v[40:43], v[132:135], v[24:27], v[40:43]
  v_mfma_f32_16x16x32_bf16 v[40:43], v[136:139], v[20:23], v[40:43]
  s_waitcnt vmcnt(8)
  buffer_load_dwordx4 v[172:175], v1, s[4:7], s29 offen offset:3072 nt
  v_mfma_f32_16x16x32_bf16 v[40:43], v[140:143], v[28:31], v[40:43]
  s_nop 7
  v_mov_b32_dpp v6, v40 quad_perm:[0,0,0,0] row_mask:0xf bank_mask:0xf
  s_nop 1
  v_add_f32_dpp v6, v41, v6 quad_perm:[1,1,1,1] row_mask:0xf bank_mask:0xf
  s_nop 1
  v_add_f32_dpp v6, v42, v6 quad_perm:[2,2,2,2] row_mask:0xf bank_mask:0xf
  s_nop 1
  v_add_f32_dpp v6, v43, v6 quad_perm:[3,3,3,3] row_mask:0xf bank_mask:0xf
  v_cvt_pk_bf16_f32 v0, v6, v6
  v_and_b32 v6, s95, v0
  v_mul_f32 v6, s94, v6
  v_cvt_pk_bf16_f32 v0, v6, v6
  v_and_b32 v6, s95, v0
  s_nop 1
  v_max_f32_dpp v14, v6, v6 row_ror:4 row_mask:0xf bank_mask:0xf
  s_nop 1
  v_max_f32_dpp v14, v14, v14 row_ror:8 row_mask:0xf bank_mask:0xf
  s_nop 1
  v_max_f32_dpp v14, v14, v14 row_bcast:15 row_mask:0xa bank_mask:0xf
  s_nop 1
  v_max_f32_dpp v14, v14, v14 row_bcast:31 row_mask:0xc bank_mask:0xf
  v_mul_f32 v14, 0xbfb8aa3b, v14
  s_nop 0
  v_readlane_b32 s56, v14, 63
  s_nop 1
  v_min_f32 v15, s56, v8
  v_sub_f32 v14, v15, v8
  v_mov_b32 v8, v15
  v_fmamk_f32 v6, v6, 0x3fb8aa3b, v8
  v_exp_f32 v6, v6
  v_exp_f32 v14, v14
  s_nop 0
  v_fma_f32 v9, v14, v9, v6
  v_cvt_pk_bf16_f32 v6, v6, v6
  v_mul_f32 v52, v14, v52
  v_mul_f32 v53, v14, v53
  v_mul_f32 v54, v14, v54
  v_mul_f32 v55, v14, v55
  v_and_b32 v60, v6, v32
  v_and_b32 v61, v6, v33
  v_and_b32_dpp v62, v6, v34 row_half_mirror row_mask:0xf bank_mask:0xf
  v_and_b32_dpp v63, v6, v35 row_half_mirror row_mask:0xf bank_mask:0xf
  v_mul_f32 v56, v14, v56
  v_mul_f32 v57, v14, v57
  s_waitcnt lgkmcnt(0)
  v_mfma_f32_16x16x32_bf16 v[52:55], v[44:47], v[60:63], v[52:55]
  v_mul_f32 v58, v14, v58
  v_mul_f32 v59, v14, v59
  v_and_b32_dpp v40, v6, v32 row_half_mirror row_mask:0xf bank_mask:0xf
  v_and_b32_dpp v41, v6, v33 row_half_mirror row_mask:0xf bank_mask:0xf
  v_mfma_f32_16x16x32_bf16 v[56:59], a[108:111], v[60:63], v[56:59]
  v_and_b32 v42, v6, v34
  v_and_b32 v43, v6, v35
  v_mov_b32 v0, s54
  s_nop 0
  v_mfma_f32_16x16x32_bf16 v[52:55], v[48:51], v[40:43], v[52:55]
  v_mfma_f32_16x16x32_bf16 v[56:59], a[112:115], v[40:43], v[56:59]
  s_waitcnt vmcnt(8)
  s_add_u32 s29, s28, s39
  buffer_load_dwordx4 v[176:179], v1, s[4:7], s29 offen offset:0 nt
  ds_read_b128 v[44:47], v4 offset:16384
  ds_read_b128 v[48:51], v4 offset:17408
  v_mfma_f32_16x16x32_bf16 v[40:43], v[144:147], v[16:19], 0
  s_waitcnt vmcnt(8)
  buffer_load_dwordx4 v[180:183], v1, s[4:7], s29 offen offset:1024 nt
  v_mfma_f32_16x16x32_bf16 v[40:43], v[148:151], v[24:27], v[40:43]
  s_waitcnt vmcnt(8)
  buffer_load_dwordx4 v[184:187], v1, s[4:7], s29 offen offset:2048 nt
  v_mfma_f32_16x16x32_bf16 v[40:43], v[152:155], v[20:23], v[40:43]
  s_waitcnt vmcnt(8)
  buffer_load_dwordx4 v[188:191], v1, s[4:7], s29 offen offset:3072 nt
  v_mfma_f32_16x16x32_bf16 v[40:43], v[156:159], v[28:31], v[40:43]
  s_nop 7
  v_mov_b32_dpp v6, v40 quad_perm:[0,0,0,0] row_mask:0xf bank_mask:0xf
  s_nop 1
  v_add_f32_dpp v6, v41, v6 quad_perm:[1,1,1,1] row_mask:0xf bank_mask:0xf
  s_nop 1
  v_add_f32_dpp v6, v42, v6 quad_perm:[2,2,2,2] row_mask:0xf bank_mask:0xf
  s_nop 1
  v_add_f32_dpp v6, v43, v6 quad_perm:[3,3,3,3] row_mask:0xf bank_mask:0xf
  v_cvt_pk_bf16_f32 v0, v6, v6
  v_and_b32 v6, s95, v0
  v_mul_f32 v6, s94, v6
  v_cvt_pk_bf16_f32 v0, v6, v6
  v_and_b32 v6, s95, v0
  s_nop 1
  v_max_f32_dpp v14, v6, v6 row_ror:4 row_mask:0xf bank_mask:0xf
  s_nop 1
  v_max_f32_dpp v14, v14, v14 row_ror:8 row_mask:0xf bank_mask:0xf
  s_nop 1
  v_max_f32_dpp v14, v14, v14 row_bcast:15 row_mask:0xa bank_mask:0xf
  s_nop 1
  v_max_f32_dpp v14, v14, v14 row_bcast:31 row_mask:0xc bank_mask:0xf
  v_mul_f32 v14, 0xbfb8aa3b, v14
  s_nop 0
  v_readlane_b32 s56, v14, 63
  s_nop 1
  v_min_f32 v15, s56, v8
  v_sub_f32 v14, v15, v8
  v_mov_b32 v8, v15
  v_fmamk_f32 v6, v6, 0x3fb8aa3b, v8
  v_exp_f32 v6, v6
  v_exp_f32 v14, v14
  s_nop 0
  v_fma_f32 v9, v14, v9, v6
  v_cvt_pk_bf16_f32 v6, v6, v6
  v_mul_f32 v52, v14, v52
  v_mul_f32 v53, v14, v53
  v_mul_f32 v54, v14, v54
  v_mul_f32 v55, v14, v55
  v_and_b32 v60, v6, v32
  v_and_b32 v61, v6, v33
  v_and_b32_dpp v62, v6, v34 row_half_mirror row_mask:0xf bank_mask:0xf
  v_and_b32_dpp v63, v6, v35 row_half_mirror row_mask:0xf bank_mask:0xf
  v_mul_f32 v56, v14, v56
  v_mul_f32 v57, v14, v57
  s_waitcnt lgkmcnt(0)
  v_mfma_f32_16x16x32_bf16 v[52:55], v[44:47], v[60:63], v[52:55]
  v_mul_f32 v58, v14, v58
  v_mul_f32 v59, v14, v59
  v_add_f32_dpp v9, v9, v9 row_ror:4 row_mask:0xf bank_mask:0xf
  v_and_b32_dpp v40, v6, v32 row_half_mirror row_mask:0xf bank_mask:0xf
  v_and_b32_dpp v41, v6, v33 row_half_mirror row_mask:0xf bank_mask:0xf
  v_mfma_f32_16x16x32_bf16 v[56:59], a[116:119], v[60:63], v[56:59]
  v_and_b32 v42, v6, v34
  v_and_b32 v43, v6, v35
  v_add_f32_dpp v9, v9, v9 row_ror:8 row_mask:0xf bank_mask:0xf
  v_mov_b32 v0, s54
  v_mfma_f32_16x16x32_bf16 v[52:55], v[48:51], v[40:43], v[52:55]
  v_add_f32_dpp v9, v9, v9 row_bcast:15 row_mask:0xa bank_mask:0xf
  v_mfma_f32_16x16x32_bf16 v[56:59], a[120:123], v[40:43], v[56:59]
  s_nop 0
  v_add_f32_dpp v9, v9, v9 row_bcast:31 row_mask:0xc bank_mask:0xf
  s_mov_b32 exec_lo, 0
  s_mov_b32 exec_hi, 0x80000000
  ds_write_b64 v0, v[8:9] offset:8192
  s_mov_b64 exec, -1
  v_lshrrev_b32 v0, 1, v2
  v_add_u32 v5, s53, v0
  v_mov_b32 v42, 1
  v_mov_b32 v43, 0
  v_add_f32_dpp v40, v56, v52 row_ror:8 row_mask:0xf bank_mask:0x3
  v_add_f32_dpp v41, v57, v53 row_ror:8 row_mask:0xf bank_mask:0x3
  s_nop 0
  v_add_f32_dpp v40, v54, v58 row_ror:8 row_mask:0xf bank_mask:0xc
  v_add_f32_dpp v41, v55, v59 row_ror:8 row_mask:0xf bank_mask:0xc
  ds_write_b64 v5, v[40:41] offset:0
  s_mov_b64 exec, 1
  ds_add_rtn_u32 v42, v43, v42 offset:8320
  s_mov_b64 exec, -1
  ds_read_b128 v[16:19], v43 offset:8192
  ds_read_b128 v[20:23], v43 offset:8208
  ds_read_b64 v[24:25], v0 offset:0
  ds_read_b64 v[26:27], v0 offset:512
  ds_read_b64 v[28:29], v0 offset:1024
  ds_read_b64 v[30:31], v0 offset:1536
  s_waitcnt lgkmcnt(4)
  v_readfirstlane_b32 s56, v42
  v_min3_f32 v44, v16, v18, v20
  s_and_b32 s56, s56, 3
  s_cmp_lg_u32 s56, 3
  s_cbranch_scc1 Lpubnot_43
  v_min_f32 v44, v44, v22
  v_sub_f32 v16, v44, v16
  v_sub_f32 v18, v44, v18
  v_sub_f32 v20, v44, v20
  v_sub_f32 v22, v44, v22
  v_exp_f32 v16, v16
  v_exp_f32 v18, v18
  v_exp_f32 v20, v20
  v_exp_f32 v22, v22
  s_waitcnt lgkmcnt(0)
  v_mul_f32 v40, v16, v24
  v_mul_f32 v41, v16, v25
  v_mul_f32 v45, v16, v17
  v_fmac_f32 v40, v18, v26
  v_fmac_f32 v41, v18, v27
  v_fmac_f32 v45, v18, v19
  v_fmac_f32 v40, v20, v28
  v_fmac_f32 v41, v20, v29
  v_fmac_f32 v45, v20, v21
  v_fmac_f32 v40, v22, v30
  v_fmac_f32 v41, v22, v31
  v_fmac_f32 v45, v22, v23
  s_add_u32 s56, s36, s55
  s_cmp_eq_u32 s32, 0
  s_cbranch_scc1 Lpubnl_44
  buffer_store_dwordx2 v[40:41], v0, s[20:23], s36 offen
  s_mov_b64 exec, 1
  buffer_store_dwordx2 v[44:45], off, s[20:23], s56
  s_mov_b64 exec, -1
  s_branch Lpubdone_42
Lpubnl_44:
  buffer_store_dwordx2 v[40:41], v0, s[20:23], s36 offen sc1
  s_mov_b64 exec, 1
  buffer_store_dwordx2 v[44:45], off, s[20:23], s56 sc1
  s_mov_b64 exec, -1
  s_branch Lpubdone_42
Lpubnot_43:
  v_mov_b32 v0, 0x7ffffff0
  s_mov_b64 exec, 1
  buffer_store_dword v0, v0, s[20:23], 0 offen
  buffer_store_dword v0, v0, s[20:23], 0 offen
  s_mov_b64 exec, -1
  s_waitcnt lgkmcnt(0)
Lpubdone_42:
  s_add_u32 s36, s36, 131072
  s_add_u32 s30, s30, 1
  s_branch Lmain1
Lnoq2_41:
  s_nop 7
  s_waitcnt vmcnt(7)
  ds_read_b128 v[44:47], v4 offset:14336
  ds_read_b128 v[48:51], v4 offset:15360
  v_mfma_f32_16x16x32_bf16 v[40:43], v[128:131], v[16:19], 0
  s_waitcnt vmcnt(6)
  v_mfma_f32_16x16x32_bf16 v[40:43], v[132:135], v[24:27], v[40:43]
  s_waitcnt vmcnt(5)
  v_mfma_f32_16x16x32_bf16 v[40:43], v[136:139], v[20:23], v[40:43]
  s_waitcnt vmcnt(4)
  v_mfma_f32_16x16x32_bf16 v[40:43], v[140:143], v[28:31], v[40:43]
  s_nop 7
  v_mov_b32_dpp v6, v40 quad_perm:[0,0,0,0] row_mask:0xf bank_mask:0xf
  s_nop 1
  v_add_f32_dpp v6, v41, v6 quad_perm:[1,1,1,1] row_mask:0xf bank_mask:0xf
  s_nop 1
  v_add_f32_dpp v6, v42, v6 quad_perm:[2,2,2,2] row_mask:0xf bank_mask:0xf
  s_nop 1
  v_add_f32_dpp v6, v43, v6 quad_perm:[3,3,3,3] row_mask:0xf bank_mask:0xf
  v_cvt_pk_bf16_f32 v0, v6, v6
  v_and_b32 v6, s95, v0
  v_mul_f32 v6, s94, v6
  v_cvt_pk_bf16_f32 v0, v6, v6
  v_and_b32 v6, s95, v0
  s_nop 1
  v_max_f32_dpp v14, v6, v6 row_ror:4 row_mask:0xf bank_mask:0xf
  s_nop 1
  v_max_f32_dpp v14, v14, v14 row_ror:8 row_mask:0xf bank_mask:0xf
  s_nop 1
  v_max_f32_dpp v14, v14, v14 row_bcast:15 row_mask:0xa bank_mask:0xf
  s_nop 1
  v_max_f32_dpp v14, v14, v14 row_bcast:31 row_mask:0xc bank_mask:0xf
  v_mul_f32 v14, 0xbfb8aa3b, v14
  s_nop 0
  v_readlane_b32 s56, v14, 63
  s_nop 1
  v_min_f32 v15, s56, v8
  v_sub_f32 v14, v15, v8
  v_mov_b32 v8, v15
  v_fmamk_f32 v6, v6, 0x3fb8aa3b, v8
  v_exp_f32 v6, v6
  v_exp_f32 v14, v14
  s_nop 0
  v_fma_f32 v9, v14, v9, v6
  v_cvt_pk_bf16_f32 v6, v6, v6
  v_mul_f32 v52, v14, v52
  v_mul_f32 v53, v14, v53
  v_mul_f32 v54, v14, v54
  v_mul_f32 v55, v14, v55
  v_and_b32 v60, v6, v32
  v_and_b32 v61, v6, v33
  v_and_b32_dpp v62, v6, v34 row_half_mirror row_mask:0xf bank_mask:0xf
  v_and_b32_dpp v63, v6, v35 row_half_mirror row_mask:0xf bank_mask:0xf
  v_mul_f32 v56, v14, v56
  v_mul_f32 v57, v14, v57
  s_waitcnt lgkmcnt(0)
  v_mfma_f32_16x16x32_bf16 v[52:55], v[44:47], v[60:63], v[52:55]
  v_mul_f32 v58, v14, v58
  v_mul_f32 v59, v14, v59
  v_and_b32_dpp v40, v6, v32 row_half_mirror row_mask:0xf bank_mask:0xf
  v_and_b32_dpp v41, v6, v33 row_half_mirror row_mask:0xf bank_mask:0xf
  v_mfma_f32_16x16x32_bf16 v[56:59], a[108:111], v[60:63], v[56:59]
  v_and_b32 v42, v6, v34
  v_and_b32 v43, v6, v35
  v_mov_b32 v0, s54
  s_nop 0
  v_mfma_f32_16x16x32_bf16 v[52:55], v[48:51], v[40:43], v[52:55]
  v_mfma_f32_16x16x32_bf16 v[56:59], a[112:115], v[40:43], v[56:59]
  s_waitcnt vmcnt(3)
  ds_read_b128 v[44:47], v4 offset:16384
  ds_read_b128 v[48:51], v4 offset:17408
  v_mfma_f32_16x16x32_bf16 v[40:43], v[144:147], v[16:19], 0
  s_waitcnt vmcnt(2)
  v_mfma_f32_16x16x32_bf16 v[40:43], v[148:151], v[24:27], v[40:43]
  buffer_load_dwordx4 v[36:39], v3, s[20:23], s34 offen sc1
  s_waitcnt vmcnt(2)
  v_mfma_f32_16x16x32_bf16 v[40:43], v[152:155], v[20:23], v[40:43]
  s_waitcnt vmcnt(1)
  v_mfma_f32_16x16x32_bf16 v[40:43], v[156:159], v[28:31], v[40:43]
  s_nop 7
  v_mov_b32_dpp v6, v40 quad_perm:[0,0,0,0] row_mask:0xf bank_mask:0xf
  s_nop 1
  v_add_f32_dpp v6, v41, v6 quad_perm:[1,1,1,1] row_mask:0xf bank_mask:0xf
  s_nop 1
  v_add_f32_dpp v6, v42, v6 quad_perm:[2,2,2,2] row_mask:0xf bank_mask:0xf
  s_nop 1
  v_add_f32_dpp v6, v43, v6 quad_perm:[3,3,3,3] row_mask:0xf bank_mask:0xf
  v_cvt_pk_bf16_f32 v0, v6, v6
  v_and_b32 v6, s95, v0
  v_mul_f32 v6, s94, v6
  v_cvt_pk_bf16_f32 v0, v6, v6
  v_and_b32 v6, s95, v0
  s_nop 1
  v_max_f32_dpp v14, v6, v6 row_ror:4 row_mask:0xf bank_mask:0xf
  s_nop 1
  v_max_f32_dpp v14, v14, v14 row_ror:8 row_mask:0xf bank_mask:0xf
  s_nop 1
  v_max_f32_dpp v14, v14, v14 row_bcast:15 row_mask:0xa bank_mask:0xf
  s_nop 1
  v_max_f32_dpp v14, v14, v14 row_bcast:31 row_mask:0xc bank_mask:0xf
  v_mul_f32 v14, 0xbfb8aa3b, v14
  s_nop 0
  v_readlane_b32 s56, v14, 63
  s_nop 1
  v_min_f32 v15, s56, v8
  v_sub_f32 v14, v15, v8
  v_mov_b32 v8, v15
  v_fmamk_f32 v6, v6, 0x3fb8aa3b, v8
  v_exp_f32 v6, v6
  v_exp_f32 v14, v14
  s_nop 0
  v_fma_f32 v9, v14, v9, v6
  v_cvt_pk_bf16_f32 v6, v6, v6
  v_mul_f32 v52, v14, v52
  v_mul_f32 v53, v14, v53
  v_mul_f32 v54, v14, v54
  v_mul_f32 v55, v14, v55
  v_and_b32 v60, v6, v32
  v_and_b32 v61, v6, v33
  v_and_b32_dpp v62, v6, v34 row_half_mirror row_mask:0xf bank_mask:0xf
  v_and_b32_dpp v63, v6, v35 row_half_mirror row_mask:0xf bank_mask:0xf
  v_mul_f32 v56, v14, v56
  v_mul_f32 v57, v14, v57
  s_waitcnt lgkmcnt(0)
  v_mfma_f32_16x16x32_bf16 v[52:55], v[44:47], v[60:63], v[52:55]
  v_mul_f32 v58, v14, v58
  v_mul_f32 v59, v14, v59
  v_add_f32_dpp v9, v9, v9 row_ror:4 row_mask:0xf bank_mask:0xf
  v_and_b32_dpp v40, v6, v32 row_half_mirror row_mask:0xf bank_mask:0xf
  v_and_b32_dpp v41, v6, v33 row_half_mirror row_mask:0xf bank_mask:0xf
  v_mfma_f32_16x16x32_bf16 v[56:59], a[116:119], v[60:63], v[56:59]
  v_and_b32 v42, v6, v34
  v_and_b32 v43, v6, v35
  v_add_f32_dpp v9, v9, v9 row_ror:8 row_mask:0xf bank_mask:0xf
  v_mov_b32 v0, s54
  v_mfma_f32_16x16x32_bf16 v[52:55], v[48:51], v[40:43], v[52:55]
  v_add_f32_dpp v9, v9, v9 row_bcast:15 row_mask:0xa bank_mask:0xf
  v_mfma_f32_16x16x32_bf16 v[56:59], a[120:123], v[40:43], v[56:59]
  s_nop 0
  v_add_f32_dpp v9, v9, v9 row_bcast:31 row_mask:0xc bank_mask:0xf
  s_mov_b32 exec_lo, 0
  s_mov_b32 exec_hi, 0x80000000
  ds_write_b64 v0, v[8:9] offset:8192
  s_mov_b64 exec, -1
  v_lshrrev_b32 v0, 1, v2
  v_add_u32 v5, s53, v0
  v_mov_b32 v42, 1
  v_mov_b32 v43, 0
  v_add_f32_dpp v40, v56, v52 row_ror:8 row_mask:0xf bank_mask:0x3
  v_add_f32_dpp v41, v57, v53 row_ror:8 row_mask:0xf bank_mask:0x3
  s_nop 0
  v_add_f32_dpp v40, v54, v58 row_ror:8 row_mask:0xf bank_mask:0xc
  v_add_f32_dpp v41, v55, v59 row_ror:8 row_mask:0xf bank_mask:0xc
  ds_write_b64 v5, v[40:41] offset:0
  s_mov_b64 exec, 1
  ds_add_rtn_u32 v42, v43, v42 offset:8320
  s_mov_b64 exec, -1
  ds_read_b128 v[16:19], v43 offset:8192
  ds_read_b128 v[20:23], v43 offset:8208
  ds_read_b64 v[24:25], v0 offset:0
  ds_read_b64 v[26:27], v0 offset:512
  ds_read_b64 v[28:29], v0 offset:1024
  ds_read_b64 v[30:31], v0 offset:1536
  s_waitcnt lgkmcnt(4)
  v_readfirstlane_b32 s56, v42
  v_min3_f32 v44, v16, v18, v20
  s_and_b32 s56, s56, 3
  s_cmp_lg_u32 s56, 3
  s_cbranch_scc1 Lpubnot_46
  v_min_f32 v44, v44, v22
  v_sub_f32 v16, v44, v16
  v_sub_f32 v18, v44, v18
  v_sub_f32 v20, v44, v20
  v_sub_f32 v22, v44, v22
  v_exp_f32 v16, v16
  v_exp_f32 v18, v18
  v_exp_f32 v20, v20
  v_exp_f32 v22, v22
  s_waitcnt lgkmcnt(0)
  v_mul_f32 v40, v16, v24
  v_mul_f32 v41, v16, v25
  v_mul_f32 v45, v16, v17
  v_fmac_f32 v40, v18, v26
  v_fmac_f32 v41, v18, v27
  v_fmac_f32 v45, v18, v19
  v_fmac_f32 v40, v20, v28
  v_fmac_f32 v41, v20, v29
  v_fmac_f32 v45, v20, v21
  v_fmac_f32 v40, v22, v30
  v_fmac_f32 v41, v22, v31
  v_fmac_f32 v45, v22, v23
  s_add_u32 s56, s36, s55
  s_cmp_eq_u32 s32, 0
  s_cbranch_scc1 Lpubnl_47
  buffer_store_dwordx2 v[40:41], v0, s[20:23], s36 offen
  s_mov_b64 exec, 1
  buffer_store_dwordx2 v[44:45], off, s[20:23], s56
  s_mov_b64 exec, -1
  s_branch Lpubdone_45
Lpubnl_47:
  buffer_store_dwordx2 v[40:41], v0, s[20:23], s36 offen sc1
  s_mov_b64 exec, 1
  buffer_store_dwordx2 v[44:45], off, s[20:23], s56 sc1
  s_mov_b64 exec, -1
  s_branch Lpubdone_45
Lpubnot_46:
  v_mov_b32 v0, 0x7ffffff0
  s_mov_b64 exec, 1
  buffer_store_dword v0, v0, s[20:23], 0 offen
  buffer_store_dword v0, v0, s[20:23], 0 offen
  s_mov_b64 exec, -1
  s_waitcnt lgkmcnt(0)
Lpubdone_45:
  s_add_u32 s36, s36, 131072
  s_add_u32 s30, s30, 1
  s_waitcnt vmcnt(2)
  s_branch Lqchk_50
Lqw_48:
  s_sub_u32 s33, s33, 1
  s_cbranch_scc1 Lend
  buffer_load_dwordx4 v[36:39], v3, s[20:23], s34 offen sc1
  s_waitcnt vmcnt(0)
Lqchk_50:
  v_max3_u32 v0, v36, v37, v38
  v_max_u32 v0, v0, v39
  v_cmp_eq_u32 vcc, -1, v0
  s_cbranch_vccnz Lqw_48
  s_mov_b32 s52, 0
  v_cndmask_b32 v16, 0, v36, s[40:41]
  v_cndmask_b32 v17, 0, v37, s[40:41]
  v_cndmask_b32 v18, 0, v38, s[40:41]
  v_cndmask_b32 v19, 0, v39, s[40:41]
  v_cndmask_b32 v20, 0, v36, s[42:43]
  v_cndmask_b32 v21, 0, v37, s[42:43]
  v_cndmask_b32 v22, 0, v38, s[42:43]
  v_cndmask_b32 v23, 0, v39, s[42:43]
  v_cndmask_b32 v24, 0, v36, s[44:45]
  v_cndmask_b32 v25, 0, v37, s[44:45]
  v_cndmask_b32 v26, 0, v38, s[44:45]
  v_cndmask_b32 v27, 0, v39, s[44:45]
  v_cndmask_b32 v28, 0, v36, s[46:47]
  v_cndmask_b32 v29, 0, v37, s[46:47]
  v_cndmask_b32 v30, 0, v38, s[46:47]
  v_cndmask_b32 v31, 0, v39, s[46:47]
  v_mfma_f32_16x16x32_bf16 v[40:43], v[192:195], v[16:19], 0
  v_mfma_f32_16x16x32_bf16 v[40:43], v[196:199], v[24:27], v[40:43]
  v_mfma_f32_16x16x32_bf16 v[40:43], v[200:203], v[20:23], v[40:43]
  v_mfma_f32_16x16x32_bf16 v[40:43], v[204:207], v[28:31], v[40:43]
  v_mfma_f32_16x16x32_bf16 v[44:47], v[160:163], v[16:19], 0
  v_mfma_f32_16x16x32_bf16 v[44:47], v[164:167], v[24:27], v[44:47]
  v_mfma_f32_16x16x32_bf16 v[44:47], v[168:171], v[20:23], v[44:47]
  v_mfma_f32_16x16x32_bf16 v[44:47], v[172:175], v[28:31], v[44:47]
  v_mfma_f32_16x16x32_bf16 v[48:51], v[176:179], v[16:19], 0
  s_nop 2
  v_mov_b32_dpp v197, v40 quad_perm:[0,0,0,0] row_mask:0xf bank_mask:0xf
  v_mov_b32_dpp v204, v42 quad_perm:[2,2,2,2] row_mask:0xf bank_mask:0xf
  v_mfma_f32_16x16x32_bf16 v[48:51], v[180:183], v[24:27], v[48:51]
  v_add_f32_dpp v197, v41, v197 quad_perm:[1,1,1,1] row_mask:0xf bank_mask:0xf
  v_add_f32_dpp v204, v43, v204 quad_perm:[3,3,3,3] row_mask:0xf bank_mask:0xf
  v_mfma_f32_16x16x32_bf16 v[48:51], v[184:187], v[20:23], v[48:51]
  v_add_f32 v197, v197, v204
  v_mfma_f32_16x16x32_bf16 v[48:51], v[188:191], v[28:31], v[48:51]
  buffer_load_dwordx4 v[36:39], v3, s[20:23], s35 offen sc1
  s_add_u32 s29, s28, s31
  buffer_load_dwordx4 v[160:163], v1, s[4:7], s29 offen offset:0 nt
  buffer_load_dwordx4 v[164:167], v1, s[4:7], s29 offen offset:1024 nt
  buffer_load_dwordx4 v[168:171], v1, s[4:7], s29 offen offset:2048 nt
  buffer_load_dwordx4 v[172:175], v1, s[4:7], s29 offen offset:3072 nt
  s_add_u32 s29, s28, s39
  buffer_load_dwordx4 v[176:179], v1, s[4:7], s29 offen offset:0 nt
  buffer_load_dwordx4 v[180:183], v1, s[4:7], s29 offen offset:1024 nt
  buffer_load_dwordx4 v[184:187], v1, s[4:7], s29 offen offset:2048 nt
  buffer_load_dwordx4 v[188:191], v1, s[4:7], s29 offen offset:3072 nt
  v_mfma_f32_16x16x32_bf16 v[40:43], a[128:131], v[16:19], 0
  v_mov_b32_dpp v192, v44 quad_perm:[0,0,0,0] row_mask:0xf bank_mask:0xf
  v_mov_b32_dpp v204, v46 quad_perm:[2,2,2,2] row_mask:0xf bank_mask:0xf
  v_mfma_f32_16x16x32_bf16 v[40:43], a[132:135], v[24:27], v[40:43]
  v_add_f32_dpp v192, v45, v192 quad_perm:[1,1,1,1] row_mask:0xf bank_mask:0xf
  v_add_f32_dpp v204, v47, v204 quad_perm:[3,3,3,3] row_mask:0xf bank_mask:0xf
  v_mfma_f32_16x16x32_bf16 v[40:43], a[136:139], v[20:23], v[40:43]
  v_add_f32 v192, v192, v204
  v_mfma_f32_16x16x32_bf16 v[40:43], a[140:143], v[28:31], v[40:43]
  v_mfma_f32_16x16x32_bf16 v[44:47], v[224:227], v[16:19], 0
  v_mov_b32_dpp v193, v48 quad_perm:[0,0,0,0] row_mask:0xf bank_mask:0xf
  v_mov_b32_dpp v204, v50 quad_perm:[2,2,2,2] row_mask:0xf bank_mask:0xf
  v_mfma_f32_16x16x32_bf16 v[44:47], v[228:231], v[24:27], v[44:47]
  v_add_f32_dpp v193, v49, v193 quad_perm:[1,1,1,1] row_mask:0xf bank_mask:0xf
  v_add_f32_dpp v204, v51, v204 quad_perm:[3,3,3,3] row_mask:0xf bank_mask:0xf
  v_mfma_f32_16x16x32_bf16 v[44:47], v[232:235], v[20:23], v[44:47]
  v_add_f32 v193, v193, v204
  v_mfma_f32_16x16x32_bf16 v[44:47], v[236:239], v[28:31], v[44:47]
  v_mfma_f32_16x16x32_bf16 v[48:51], v[240:243], v[16:19], 0
  v_mov_b32_dpp v194, v40 quad_perm:[0,0,0,0] row_mask:0xf bank_mask:0xf
  v_mov_b32_dpp v204, v42 quad_perm:[2,2,2,2] row_mask:0xf bank_mask:0xf
  v_mfma_f32_16x16x32_bf16 v[48:51], v[244:247], v[24:27], v[48:51]
  v_add_f32_dpp v194, v41, v194 quad_perm:[1,1,1,1] row_mask:0xf bank_mask:0xf
  v_add_f32_dpp v204, v43, v204 quad_perm:[3,3,3,3] row_mask:0xf bank_mask:0xf
  v_mfma_f32_16x16x32_bf16 v[48:51], v[248:251], v[20:23], v[48:51]
  v_add_f32 v194, v194, v204
  v_mfma_f32_16x16x32_bf16 v[48:51], v[252:255], v[28:31], v[48:51]
  v_mfma_f32_16x16x32_bf16 v[40:43], v[208:211], v[16:19], 0
  v_mov_b32_dpp v199, v44 quad_perm:[0,0,0,0] row_mask:0xf bank_mask:0xf
  v_mov_b32_dpp v204, v46 quad_perm:[2,2,2,2] row_mask:0xf bank_mask:0xf
  v_mfma_f32_16x16x32_bf16 v[40:43], v[212:215], v[24:27], v[40:43]
  v_add_f32_dpp v199, v45, v199 quad_perm:[1,1,1,1] row_mask:0xf bank_mask:0xf
  v_add_f32_dpp v204, v47, v204 quad_perm:[3,3,3,3] row_mask:0xf bank_mask:0xf
  v_mfma_f32_16x16x32_bf16 v[40:43], v[216:219], v[20:23], v[40:43]
  v_add_f32 v199, v199, v204
  v_mfma_f32_16x16x32_bf16 v[40:43], v[220:223], v[28:31], v[40:43]
  ds_read_b128 v[224:227], v4 offset:18432
  ds_read_b128 v[228:231], v4 offset:19456
  v_mfma_f32_16x16x32_bf16 v[44:47], a[144:147], v[16:19], 0
  v_mov_b32_dpp v200, v48 quad_perm:[0,0,0,0] row_mask:0xf bank_mask:0xf
  v_mov_b32_dpp v204, v50 quad_perm:[2,2,2,2] row_mask:0xf bank_mask:0xf
  v_mfma_f32_16x16x32_bf16 v[44:47], a[148:151], v[24:27], v[44:47]
  v_add_f32_dpp v200, v49, v200 quad_perm:[1,1,1,1] row_mask:0xf bank_mask:0xf
  v_add_f32_dpp v204, v51, v204 quad_perm:[3,3,3,3] row_mask:0xf bank_mask:0xf
  v_mfma_f32_16x16x32_bf16 v[44:47], a[152:155], v[20:23], v[44:47]
  v_add_f32 v200, v200, v204
  v_mfma_f32_16x16x32_bf16 v[44:47], a[156:159], v[28:31], v[44:47]
  ds_read_b128 v[232:235], v4 offset:20480
  ds_read_b128 v[236:239], v4 offset:21504
  v_mfma_f32_16x16x32_bf16 v[48:51], a[160:163], v[16:19], 0
  v_mov_b32_dpp v198, v40 quad_perm:[0,0,0,0] row_mask:0xf bank_mask:0xf
  v_mov_b32_dpp v204, v42 quad_perm:[2,2,2,2] row_mask:0xf bank_mask:0xf
  v_mfma_f32_16x16x32_bf16 v[48:51], a[164:167], v[24:27], v[48:51]
  v_add_f32_dpp v198, v41, v198 quad_perm:[1,1,1,1] row_mask:0xf bank_mask:0xf
  v_add_f32_dpp v204, v43, v204 quad_perm:[3,3,3,3] row_mask:0xf bank_mask:0xf
  v_mfma_f32_16x16x32_bf16 v[48:51], a[168:171], v[20:23], v[48:51]
  v_add_f32 v198, v198, v204
  v_mfma_f32_16x16x32_bf16 v[48:51], a[172:175], v[28:31], v[48:51]
  ds_read_b128 v[240:243], v4 offset:22528
  ds_read_b128 v[244:247], v4 offset:23552
  v_mfma_f32_16x16x32_bf16 v[40:43], a[176:179], v[16:19], 0
  v_mov_b32_dpp v195, v44 quad_perm:[0,0,0,0] row_mask:0xf bank_mask:0xf
  v_mov_b32_dpp v204, v46 quad_perm:[2,2,2,2] row_mask:0xf bank_mask:0xf
  s_nop 0
  v_add_f32_dpp v195, v45, v195 quad_perm:[1,1,1,1] row_mask:0xf bank_mask:0xf
  v_add_f32_dpp v204, v47, v204 quad_perm:[3,3,3,3] row_mask:0xf bank_mask:0xf
  v_add_f32 v195, v195, v204
  ds_read_b128 v[248:251], v4 offset:24576
  ds_read_b128 v[252:255], v4 offset:25600
  v_mov_b32_dpp v196, v48 quad_perm:[0,0,0,0] row_mask:0xf bank_mask:0xf
  v_mov_b32_dpp v204, v50 quad_perm:[2,2,2,2] row_mask:0xf bank_mask:0xf
  s_nop 0
  v_add_f32_dpp v196, v49, v196 quad_perm:[1,1,1,1] row_mask:0xf bank_mask:0xf
  v_add_f32_dpp v204, v51, v204 quad_perm:[3,3,3,3] row_mask:0xf bank_mask:0xf
  v_add_f32 v196, v196, v204
  v_mov_b32_dpp v201, v40 quad_perm:[0,0,0,0] row_mask:0xf bank_mask:0xf
  v_mov_b32_dpp v204, v42 quad_perm:[2,2,2,2] row_mask:0xf bank_mask:0xf
  s_nop 0
  v_add_f32_dpp v201, v41, v201 quad_perm:[1,1,1,1] row_mask:0xf bank_mask:0xf
  v_add_f32_dpp v204, v43, v204 quad_perm:[3,3,3,3] row_mask:0xf bank_mask:0xf
  v_add_f32 v201, v201, v204
  s_mov_b64 exec, s[48:49]
  v_mov_b32 v201, 0xff800000
  s_mov_b64 exec, -1
  s_add_u32 s34, s34, 8192
  v_mov_b32 v0, 0x7ffffff0
  s_mov_b64 exec, 1
  buffer_store_dword v0, v0, s[20:23], 0 offen
  buffer_store_dword v0, v0, s[20:23], 0 offen
  s_mov_b64 exec, -1
  s_branch Lmain1
Lfin:
  s_nop 7
  v_cndmask_b32 v16, 0, v36, s[40:41]
  v_cndmask_b32 v17, 0, v37, s[40:41]
  v_cndmask_b32 v18, 0, v38, s[40:41]
  v_cndmask_b32 v19, 0, v39, s[40:41]
  v_cndmask_b32 v20, 0, v36, s[42:43]
  v_cndmask_b32 v21, 0, v37, s[42:43]
  v_cndmask_b32 v22, 0, v38, s[42:43]
  v_cndmask_b32 v23, 0, v39, s[42:43]
  v_cndmask_b32 v24, 0, v36, s[44:45]
  v_cndmask_b32 v25, 0, v37, s[44:45]
  v_cndmask_b32 v26, 0, v38, s[44:45]
  v_cndmask_b32 v27, 0, v39, s[44:45]
  v_cndmask_b32 v28, 0, v36, s[46:47]
  v_cndmask_b32 v29, 0, v37, s[46:47]
  v_cndmask_b32 v30, 0, v38, s[46:47]
  v_cndmask_b32 v31, 0, v39, s[46:47]
  v_mfma_f32_16x16x32_bf16 v[40:43], v[128:131], v[16:19], 0
  v_mfma_f32_16x16x32_bf16 v[40:43], v[132:135], v[24:27], v[40:43]
  v_mfma_f32_16x16x32_bf16 v[40:43], v[136:139], v[20:23], v[40:43]
  v_mfma_f32_16x16x32_bf16 v[40:43], v[140:143], v[28:31], v[40:43]
  ds_read_b128 v[128:131], v4 offset:0
  ds_read_b128 v[132:135], v4 offset:1024
  ds_read_b128 v[136:139], v4 offset:2048
  ds_read_b128 v[140:143], v4 offset:3072
  v_mfma_f32_16x16x32_bf16 v[44:47], v[96:99], v[16:19], 0
  v_mfma_f32_16x16x32_bf16 v[44:47], v[100:103], v[24:27], v[44:47]
  v_mfma_f32_16x16x32_bf16 v[44:47], v[104:107], v[20:23], v[44:47]
  v_mfma_f32_16x16x32_bf16 v[44:47], v[108:111], v[28:31], v[44:47]
  v_mfma_f32_16x16x32_bf16 v[48:51], v[144:147], v[16:19], 0
  v_mov_b32_dpp v103, v40 quad_perm:[0,0,0,0] row_mask:0xf bank_mask:0xf
  v_mov_b32_dpp v108, v42 quad_perm:[2,2,2,2] row_mask:0xf bank_mask:0xf
  v_mfma_f32_16x16x32_bf16 v[48:51], v[148:151], v[24:27], v[48:51]
  v_add_f32_dpp v103, v41, v103 quad_perm:[1,1,1,1] row_mask:0xf bank_mask:0xf
  v_add_f32_dpp v108, v43, v108 quad_perm:[3,3,3,3] row_mask:0xf bank_mask:0xf
  v_mfma_f32_16x16x32_bf16 v[48:51], v[152:155], v[20:23], v[48:51]
  v_add_f32 v103, v103, v108
  v_mfma_f32_16x16x32_bf16 v[48:51], v[156:159], v[28:31], v[48:51]
  s_waitcnt lgkmcnt(0)
  ds_read_b128 v[144:147], v4 offset:4096
  ds_read_b128 v[148:151], v4 offset:5120
  ds_read_b128 v[152:155], v4 offset:6144
  ds_read_b128 v[156:159], v4 offset:7168
  v_mfma_f32_16x16x32_bf16 v[40:43], v[64:67], v[16:19], 0
  v_mov_b32_dpp v101, v44 quad_perm:[0,0,0,0] row_mask:0xf bank_mask:0xf
  v_mov_b32_dpp v108, v46 quad_perm:[2,2,2,2] row_mask:0xf bank_mask:0xf
  v_mfma_f32_16x16x32_bf16 v[40:43], v[68:71], v[24:27], v[40:43]
  v_add_f32_dpp v101, v45, v101 quad_perm:[1,1,1,1] row_mask:0xf bank_mask:0xf
  v_add_f32_dpp v108, v47, v108 quad_perm:[3,3,3,3] row_mask:0xf bank_mask:0xf
  v_mfma_f32_16x16x32_bf16 v[40:43], v[72:75], v[20:23], v[40:43]
  v_add_f32 v101, v101, v108
  v_mfma_f32_16x16x32_bf16 v[40:43], v[76:79], v[28:31], v[40:43]
  v_mfma_f32_16x16x32_bf16 v[44:47], v[80:83], v[16:19], 0
  v_mov_b32_dpp v104, v48 quad_perm:[0,0,0,0] row_mask:0xf bank_mask:0xf
  v_mov_b32_dpp v108, v50 quad_perm:[2,2,2,2] row_mask:0xf bank_mask:0xf
  v_mfma_f32_16x16x32_bf16 v[44:47], v[84:87], v[24:27], v[44:47]
  v_add_f32_dpp v104, v49, v104 quad_perm:[1,1,1,1] row_mask:0xf bank_mask:0xf
  v_add_f32_dpp v108, v51, v108 quad_perm:[3,3,3,3] row_mask:0xf bank_mask:0xf
  v_mfma_f32_16x16x32_bf16 v[44:47], v[88:91], v[20:23], v[44:47]
  v_add_f32 v104, v104, v108
  v_mfma_f32_16x16x32_bf16 v[44:47], v[92:95], v[28:31], v[44:47]
  s_waitcnt lgkmcnt(0)
  v_mfma_f32_16x16x32_bf16 v[48:51], a[0:3], v[16:19], 0
  v_mov_b32_dpp v96, v40 quad_perm:[0,0,0,0] row_mask:0xf bank_mask:0xf
  v_mov_b32_dpp v108, v42 quad_perm:[2,2,2,2] row_mask:0xf bank_mask:0xf
  v_mfma_f32_16x16x32_bf16 v[48:51], a[4:7], v[24:27], v[48:51]
  v_add_f32_dpp v96, v41, v96 quad_perm:[1,1,1,1] row_mask:0xf bank_mask:0xf
  v_add_f32_dpp v108, v43, v108 quad_perm:[3,3,3,3] row_mask:0xf bank_mask:0xf
  v_mfma_f32_16x16x32_bf16 v[48:51], a[8:11], v[20:23], v[48:51]
  v_add_f32 v96, v96, v108
  v_mfma_f32_16x16x32_bf16 v[48:51], a[12:15], v[28:31], v[48:51]
  v_mfma_f32_16x16x32_bf16 v[40:43], v[112:115], v[16:19], 0
  v_mov_b32_dpp v97, v44 quad_perm:[0,0,0,0] row_mask:0xf bank_mask:0xf
  v_mov_b32_dpp v108, v46 quad_perm:[2,2,2,2] row_mask:0xf bank_mask:0xf
  v_mfma_f32_16x16x32_bf16 v[40:43], v[116:119], v[24:27], v[40:43]
  v_add_f32_dpp v97, v45, v97 quad_perm:[1,1,1,1] row_mask:0xf bank_mask:0xf
  v_add_f32_dpp v108, v47, v108 quad_perm:[3,3,3,3] row_mask:0xf bank_mask:0xf
  v_mfma_f32_16x16x32_bf16 v[40:43], v[120:123], v[20:23], v[40:43]
  v_add_f32 v97, v97, v108
  v_mfma_f32_16x16x32_bf16 v[40:43], v[124:127], v[28:31], v[40:43]
  v_mfma_f32_16x16x32_bf16 v[44:47], a[16:19], v[16:19], 0
  v_mov_b32_dpp v98, v48 quad_perm:[0,0,0,0] row_mask:0xf bank_mask:0xf
  v_mov_b32_dpp v108, v50 quad_perm:[2,2,2,2] row_mask:0xf bank_mask:0xf
  v_mfma_f32_16x16x32_bf16 v[44:47], a[20:23], v[24:27], v[44:47]
  v_add_f32_dpp v98, v49, v98 quad_perm:[1,1,1,1] row_mask:0xf bank_mask:0xf
  v_add_f32_dpp v108, v51, v108 quad_perm:[3,3,3,3] row_mask:0xf bank_mask:0xf
  v_mfma_f32_16x16x32_bf16 v[44:47], a[24:27], v[20:23], v[44:47]
  v_add_f32 v98, v98, v108
  v_mfma_f32_16x16x32_bf16 v[44:47], a[28:31], v[28:31], v[44:47]
  v_mfma_f32_16x16x32_bf16 v[48:51], a[32:35], v[16:19], 0
  v_mov_b32_dpp v102, v40 quad_perm:[0,0,0,0] row_mask:0xf bank_mask:0xf
  v_mov_b32_dpp v108, v42 quad_perm:[2,2,2,2] row_mask:0xf bank_mask:0xf
  v_mfma_f32_16x16x32_bf16 v[48:51], a[36:39], v[24:27], v[48:51]
  v_add_f32_dpp v102, v41, v102 quad_perm:[1,1,1,1] row_mask:0xf bank_mask:0xf
  v_add_f32_dpp v108, v43, v108 quad_perm:[3,3,3,3] row_mask:0xf bank_mask:0xf
  v_mfma_f32_16x16x32_bf16 v[48:51], a[40:43], v[20:23], v[48:51]
  v_add_f32 v102, v102, v108
  v_mfma_f32_16x16x32_bf16 v[48:51], a[44:47], v[28:31], v[48:51]
  v_mfma_f32_16x16x32_bf16 v[40:43], a[48:51], v[16:19], 0
  v_mov_b32_dpp v99, v44 quad_perm:[0,0,0,0] row_mask:0xf bank_mask:0xf
  v_mov_b32_dpp v108, v46 quad_perm:[2,2,2,2] row_mask:0xf bank_mask:0xf
  s_nop 0
  v_add_f32_dpp v99, v45, v99 quad_perm:[1,1,1,1] row_mask:0xf bank_mask:0xf
  v_add_f32_dpp v108, v47, v108 quad_perm:[3,3,3,3] row_mask:0xf bank_mask:0xf
  v_add_f32 v99, v99, v108
  s_nop 0
  v_mov_b32_dpp v100, v48 quad_perm:[0,0,0,0] row_mask:0xf bank_mask:0xf
  v_mov_b32_dpp v108, v50 quad_perm:[2,2,2,2] row_mask:0xf bank_mask:0xf
  s_nop 0
  v_add_f32_dpp v100, v49, v100 quad_perm:[1,1,1,1] row_mask:0xf bank_mask:0xf
  v_add_f32_dpp v108, v51, v108 quad_perm:[3,3,3,3] row_mask:0xf bank_mask:0xf
  v_add_f32 v100, v100, v108
  v_mov_b32_dpp v105, v40 quad_perm:[0,0,0,0] row_mask:0xf bank_mask:0xf
  v_mov_b32_dpp v108, v42 quad_perm:[2,2,2,2] row_mask:0xf bank_mask:0xf
  s_nop 0
  v_add_f32_dpp v105, v41, v105 quad_perm:[1,1,1,1] row_mask:0xf bank_mask:0xf
  v_add_f32_dpp v108, v43, v108 quad_perm:[3,3,3,3] row_mask:0xf bank_mask:0xf
  v_add_f32 v105, v105, v108
  s_mov_b64 exec, s[48:49]
  v_mov_b32 v105, 0xff800000
  s_mov_b64 exec, -1
  s_add_u32 s34, s34, 8192
  v_max3_f32 v106, v96, v97, v98
  v_max3_f32 v109, v99, v100, v101
  v_max3_f32 v106, v106, v102, v103
  v_max3_f32 v109, v109, v104, v105
  v_max_f32 v106, v106, v109
  s_nop 1
  v_max_f32_dpp v106, v106, v106 row_ror:4 row_mask:0xf bank_mask:0xf
  s_nop 1
  v_max_f32_dpp v106, v106, v106 row_ror:8 row_mask:0xf bank_mask:0xf
  s_nop 1
  v_max_f32_dpp v106, v106, v106 row_bcast:15 row_mask:0xa bank_mask:0xf
  s_nop 1
  v_max_f32_dpp v106, v106, v106 row_bcast:31 row_mask:0xc bank_mask:0xf
  v_mul_f32 v106, 0xbe0293ee, v106
  s_nop 0
  v_readlane_b32 s56, v106, 63
  s_nop 1
  v_mov_b32 v106, s56
  v_fmamk_f32 v96, v96, 0x3e0293ee, v106
  v_exp_f32 v96, v96
  s_nop 0
  v_mov_b32 v107, v96
  v_cvt_pk_bf16_f32 v96, v96, v96
  v_and_b32 v120, v96, v32
  v_and_b32 v121, v96, v33
  v_and_b32_dpp v122, v96, v34 row_half_mirror row_mask:0xf bank_mask:0xf
  v_and_b32_dpp v123, v96, v35 row_half_mirror row_mask:0xf bank_mask:0xf
  v_fmamk_f32 v97, v97, 0x3e0293ee, v106
  v_exp_f32 v97, v97
  s_nop 0
  v_add_f32 v107, v107, v97
  v_cvt_pk_bf16_f32 v97, v97, v97
  s_waitcnt lgkmcnt(7)
  v_mfma_f32_16x16x32_bf16 v[112:115], v[128:131], v[120:123], 0
  v_and_b32_dpp v124, v96, v32 row_half_mirror row_mask:0xf bank_mask:0xf
  v_and_b32_dpp v125, v96, v33 row_half_mirror row_mask:0xf bank_mask:0xf
  v_mfma_f32_16x16x32_bf16 v[116:119], a[52:55], v[120:123], 0
  v_and_b32 v126, v96, v34
  v_and_b32 v127, v96, v35
  ds_read_b128 v[128:131], v4 offset:8192
  s_waitcnt lgkmcnt(7)
  v_mfma_f32_16x16x32_bf16 v[112:115], v[132:135], v[124:127], v[112:115]
  v_and_b32 v120, v97, v32
  v_and_b32 v121, v97, v33
  v_mfma_f32_16x16x32_bf16 v[116:119], a[56:59], v[124:127], v[116:119]
  v_and_b32_dpp v122, v97, v34 row_half_mirror row_mask:0xf bank_mask:0xf
  v_and_b32_dpp v123, v97, v35 row_half_mirror row_mask:0xf bank_mask:0xf
  ds_read_b128 v[132:135], v4 offset:9216
  v_fmamk_f32 v98, v98, 0x3e0293ee, v106
  v_exp_f32 v98, v98
  s_nop 0
  v_add_f32 v107, v107, v98
  v_cvt_pk_bf16_f32 v98, v98, v98
  s_waitcnt lgkmcnt(7)
  v_mfma_f32_16x16x32_bf16 v[112:115], v[136:139], v[120:123], v[112:115]
  v_and_b32_dpp v124, v97, v32 row_half_mirror row_mask:0xf bank_mask:0xf
  v_and_b32_dpp v125, v97, v33 row_half_mirror row_mask:0xf bank_mask:0xf
  v_mfma_f32_16x16x32_bf16 v[116:119], a[60:63], v[120:123], v[116:119]
  v_and_b32 v126, v97, v34
  v_and_b32 v127, v97, v35
  ds_read_b128 v[136:139], v4 offset:10240
  s_waitcnt lgkmcnt(7)
  v_mfma_f32_16x16x32_bf16 v[112:115], v[140:143], v[124:127], v[112:115]
  v_and_b32 v120, v98, v32
  v_and_b32 v121, v98, v33
  v_mfma_f32_16x16x32_bf16 v[116:119], a[64:67], v[124:127], v[116:119]
  v_and_b32_dpp v122, v98, v34 row_half_mirror row_mask:0xf bank_mask:0xf
  v_and_b32_dpp v123, v98, v35 row_half_mirror row_mask:0xf bank_mask:0xf
  ds_read_b128 v[140:143], v4 offset:11264
  v_fmamk_f32 v99, v99, 0x3e0293ee, v106
  v_exp_f32 v99, v99
  s_nop 0
  v_add_f32 v107, v107, v99
  v_cvt_pk_bf16_f32 v99, v99, v99
  s_waitcnt lgkmcnt(7)
  v_mfma_f32_16x16x32_bf16 v[112:115], v[144:147], v[120:123], v[112:115]
  v_and_b32_dpp v124, v98, v32 row_half_mirror row_mask:0xf bank_mask:0xf
  v_and_b32_dpp v125, v98, v33 row_half_mirror row_mask:0xf bank_mask:0xf
  v_mfma_f32_16x16x32_bf16 v[116:119], a[68:71], v[120:123], v[116:119]
  v_and_b32 v126, v98, v34
  v_and_b32 v127, v98, v35
  ds_read_b128 v[144:147], v4 offset:12288
  s_waitcnt lgkmcnt(7)
  v_mfma_f32_16x16x32_bf16 v[112:115], v[148:151], v[124:127], v[112:115]
  v_and_b32 v120, v99, v32
  v_and_b32 v121, v99, v33
  v_mfma_f32_16x16x32_bf16 v[116:119], a[72:75], v[124:127], v[116:119]
  v_and_b32_dpp v122, v99, v34 row_half_mirror row_mask:0xf bank_mask:0xf
  v_and_b32_dpp v123, v99, v35 row_half_mirror row_mask:0xf bank_mask:0xf
  ds_read_b128 v[148:151], v4 offset:13312
  v_fmamk_f32 v100, v100, 0x3e0293ee, v106
  v_exp_f32 v100, v100
  s_nop 0
  v_add_f32 v107, v107, v100
  v_cvt_pk_bf16_f32 v100, v100, v100
  s_waitcnt lgkmcnt(7)
  v_mfma_f32_16x16x32_bf16 v[112:115], v[152:155], v[120:123], v[112:115]
  v_and_b32_dpp v124, v99, v32 row_half_mirror row_mask:0xf bank_mask:0xf
  v_and_b32_dpp v125, v99, v33 row_half_mirror row_mask:0xf bank_mask:0xf
  v_mfma_f32_16x16x32_bf16 v[116:119], a[76:79], v[120:123], v[116:119]
  v_and_b32 v126, v99, v34
  v_and_b32 v127, v99, v35
  ds_read_b128 v[152:155], v4 offset:14336
  s_waitcnt lgkmcnt(7)
  v_mfma_f32_16x16x32_bf16 v[112:115], v[156:159], v[124:127], v[112:115]
  v_and_b32 v120, v100, v32
  v_and_b32 v121, v100, v33
  v_mfma_f32_16x16x32_bf16 v[116:119], a[80:83], v[124:127], v[116:119]
  v_and_b32_dpp v122, v100, v34 row_half_mirror row_mask:0xf bank_mask:0xf
  v_and_b32_dpp v123, v100, v35 row_half_mirror row_mask:0xf bank_mask:0xf
  ds_read_b128 v[156:159], v4 offset:15360
  v_fmamk_f32 v101, v101, 0x3e0293ee, v106
  v_exp_f32 v101, v101
  s_nop 0
  v_add_f32 v107, v107, v101
  v_cvt_pk_bf16_f32 v101, v101, v101
  s_waitcnt lgkmcnt(7)
  v_mfma_f32_16x16x32_bf16 v[112:115], v[128:131], v[120:123], v[112:115]
  v_and_b32_dpp v124, v100, v32 row_half_mirror row_mask:0xf bank_mask:0xf
  v_and_b32_dpp v125, v100, v33 row_half_mirror row_mask:0xf bank_mask:0xf
  v_mfma_f32_16x16x32_bf16 v[116:119], a[84:87], v[120:123], v[116:119]
  v_and_b32 v126, v100, v34
  v_and_b32 v127, v100, v35
  ds_read_b128 v[128:131], v4 offset:16384
  s_waitcnt lgkmcnt(7)
  v_mfma_f32_16x16x32_bf16 v[112:115], v[132:135], v[124:127], v[112:115]
  v_and_b32 v120, v101, v32
  v_and_b32 v121, v101, v33
  v_mfma_f32_16x16x32_bf16 v[116:119], a[88:91], v[124:127], v[116:119]
  v_and_b32_dpp v122, v101, v34 row_half_mirror row_mask:0xf bank_mask:0xf
  v_and_b32_dpp v123, v101, v35 row_half_mirror row_mask:0xf bank_mask:0xf
  ds_read_b128 v[132:135], v4 offset:17408
  v_fmamk_f32 v102, v102, 0x3e0293ee, v106
  v_exp_f32 v102, v102
  s_nop 0
  v_add_f32 v107, v107, v102
  v_cvt_pk_bf16_f32 v102, v102, v102
  s_waitcnt lgkmcnt(7)
  v_mfma_f32_16x16x32_bf16 v[112:115], v[136:139], v[120:123], v[112:115]
  v_and_b32_dpp v124, v101, v32 row_half_mirror row_mask:0xf bank_mask:0xf
  v_and_b32_dpp v125, v101, v33 row_half_mirror row_mask:0xf bank_mask:0xf
  v_mfma_f32_16x16x32_bf16 v[116:119], a[92:95], v[120:123], v[116:119]
  v_and_b32 v126, v101, v34
  v_and_b32 v127, v101, v35
  s_waitcnt lgkmcnt(6)
  s_nop 0
  v_mfma_f32_16x16x32_bf16 v[112:115], v[140:143], v[124:127], v[112:115]
  v_and_b32 v120, v102, v32
  v_and_b32 v121, v102, v33
  v_mfma_f32_16x16x32_bf16 v[116:119], a[96:99], v[124:127], v[116:119]
  v_and_b32_dpp v122, v102, v34 row_half_mirror row_mask:0xf bank_mask:0xf
  v_and_b32_dpp v123, v102, v35 row_half_mirror row_mask:0xf bank_mask:0xf
  v_fmamk_f32 v103, v103, 0x3e0293ee, v106
  v_exp_f32 v103, v103
  s_nop 0
  v_add_f32 v107, v107, v103
  v_cvt_pk_bf16_f32 v103, v103, v103
  s_waitcnt lgkmcnt(5)
  v_mfma_f32_16x16x32_bf16 v[112:115], v[144:147], v[120:123], v[112:115]
  v_and_b32_dpp v124, v102, v32 row_half_mirror row_mask:0xf bank_mask:0xf
  v_and_b32_dpp v125, v102, v33 row_half_mirror row_mask:0xf bank_mask:0xf
  v_mfma_f32_16x16x32_bf16 v[116:119], a[100:103], v[120:123], v[116:119]
  v_and_b32 v126, v102, v34
  v_and_b32 v127, v102, v35
  s_waitcnt lgkmcnt(4)
  s_nop 0
  v_mfma_f32_16x16x32_bf16 v[112:115], v[148:151], v[124:127], v[112:115]
  v_and_b32 v120, v103, v32
  v_and_b32 v121, v103, v33
  v_mfma_f32_16x16x32_bf16 v[116:119], a[104:107], v[124:127], v[116:119]
  v_and_b32_dpp v122, v103, v34 row_half_mirror row_mask:0xf bank_mask:0xf
  v_and_b32_dpp v123, v103, v35 row_half_mirror row_mask:0xf bank_mask:0xf
  v_fmamk_f32 v104, v104, 0x3e0293ee, v106
  v_exp_f32 v104, v104
  s_nop 0
  v_add_f32 v107, v107, v104
  v_cvt_pk_bf16_f32 v104, v104, v104
  s_waitcnt lgkmcnt(3)
  v_mfma_f32_16x16x32_bf16 v[112:115], v[152:155], v[120:123], v[112:115]
  v_and_b32_dpp v124, v103, v32 row_half_mirror row_mask:0xf bank_mask:0xf
  v_and_b32_dpp v125, v103, v33 row_half_mirror row_mask:0xf bank_mask:0xf
  v_mfma_f32_16x16x32_bf16 v[116:119], a[108:111], v[120:123], v[116:119]
  v_and_b32 v126, v103, v34
  v_and_b32 v127, v103, v35
  s_waitcnt lgkmcnt(2)
  s_nop 0
  v_mfma_f32_16x16x32_bf16 v[112:115], v[156:159], v[124:127], v[112:115]
  v_and_b32 v120, v104, v32
  v_and_b32 v121, v104, v33
  v_mfma_f32_16x16x32_bf16 v[116:119], a[112:115], v[124:127], v[116:119]
  v_and_b32_dpp v122, v104, v34 row_half_mirror row_mask:0xf bank_mask:0xf
  v_and_b32_dpp v123, v104, v35 row_half_mirror row_mask:0xf bank_mask:0xf
  v_fmamk_f32 v105, v105, 0x3e0293ee, v106
  v_exp_f32 v105, v105
  s_nop 0
  v_add_f32 v107, v107, v105
  v_cvt_pk_bf16_f32 v105, v105, v105
  s_waitcnt lgkmcnt(1)
  v_mfma_f32_16x16x32_bf16 v[112:115], v[128:131], v[120:123], v[112:115]
  v_and_b32_dpp v124, v104, v32 row_half_mirror row_mask:0xf bank_mask:0xf
  v_and_b32_dpp v125, v104, v33 row_half_mirror row_mask:0xf bank_mask:0xf
  v_mfma_f32_16x16x32_bf16 v[116:119], a[116:119], v[120:123], v[116:119]
  v_and_b32 v126, v104, v34
  v_and_b32 v127, v104, v35
  s_waitcnt lgkmcnt(0)
  s_nop 0
  v_mfma_f32_16x16x32_bf16 v[112:115], v[132:135], v[124:127], v[112:115]
  v_and_b32 v120, v105, v32
  v_and_b32 v121, v105, v33
  v_mfma_f32_16x16x32_bf16 v[116:119], a[120:123], v[124:127], v[116:119]
  v_and_b32_dpp v122, v105, v34 row_half_mirror row_mask:0xf bank_mask:0xf
  v_and_b32_dpp v123, v105, v35 row_half_mirror row_mask:0xf bank_mask:0xf
  s_nop 1
  v_mfma_f32_16x16x32_bf16 v[112:115], a[124:127], v[120:123], v[112:115]
  v_add_f32_dpp v107, v107, v107 row_ror:4 row_mask:0xf bank_mask:0xf
  s_nop 1
  v_add_f32_dpp v107, v107, v107 row_ror:8 row_mask:0xf bank_mask:0xf
  s_nop 1
  v_add_f32_dpp v107, v107, v107 row_bcast:15 row_mask:0xa bank_mask:0xf
  s_nop 1
  v_add_f32_dpp v107, v107, v107 row_bcast:31 row_mask:0xc bank_mask:0xf
  v_mov_b32 v0, s54
  s_mov_b32 exec_lo, 0
  s_mov_b32 exec_hi, 0x80000000
  ds_write_b64 v0, v[106:107] offset:8256
  s_mov_b64 exec, -1
  v_lshrrev_b32 v0, 1, v2
  v_add_u32 v5, s53, v0
  v_mov_b32 v42, 1
  v_mov_b32 v43, 0
  v_add_f32_dpp v40, v116, v112 row_ror:8 row_mask:0xf bank_mask:0x3
  v_add_f32_dpp v41, v117, v113 row_ror:8 row_mask:0xf bank_mask:0x3
  s_nop 0
  v_add_f32_dpp v40, v114, v118 row_ror:8 row_mask:0xf bank_mask:0xc
  v_add_f32_dpp v41, v115, v119 row_ror:8 row_mask:0xf bank_mask:0xc
  ds_write_b64 v5, v[40:41] offset:4096
  s_mov_b64 exec, 1
  ds_add_rtn_u32 v42, v43, v42 offset:8328
  s_mov_b64 exec, -1
  ds_read_b128 v[16:19], v43 offset:8256
  ds_read_b128 v[20:23], v43 offset:8272
  ds_read_b64 v[24:25], v0 offset:4096
  ds_read_b64 v[26:27], v0 offset:4608
  ds_read_b64 v[28:29], v0 offset:5120
  ds_read_b64 v[30:31], v0 offset:5632
  s_waitcnt lgkmcnt(4)
  v_readfirstlane_b32 s56, v42
  v_min3_f32 v44, v16, v18, v20
  s_and_b32 s56, s56, 3
  s_cmp_lg_u32 s56, 3
  s_cbranch_scc1 Lpubnot_52
  v_min_f32 v44, v44, v22
  v_sub_f32 v16, v44, v16
  v_sub_f32 v18, v44, v18
  v_sub_f32 v20, v44, v20
  v_sub_f32 v22, v44, v22
  v_exp_f32 v16, v16
  v_exp_f32 v18, v18
  v_exp_f32 v20, v20
  v_exp_f32 v22, v22
  s_waitcnt lgkmcnt(0)
  v_mul_f32 v40, v16, v24
  v_mul_f32 v41, v16, v25
  v_mul_f32 v45, v16, v17
  v_fmac_f32 v40, v18, v26
  v_fmac_f32 v41, v18, v27
  v_fmac_f32 v45, v18, v19
  v_fmac_f32 v40, v20, v28
  v_fmac_f32 v41, v20, v29
  v_fmac_f32 v45, v20, v21
  v_fmac_f32 v40, v22, v30
  v_fmac_f32 v41, v22, v31
  v_fmac_f32 v45, v22, v23
  s_add_u32 s56, s37, s55
  s_cmp_eq_u32 s32, 0
  s_cbranch_scc1 Lpubnl_53
  buffer_store_dwordx2 v[40:41], v0, s[20:23], s37 offen
  s_mov_b64 exec, 1
  buffer_store_dwordx2 v[44:45], off, s[20:23], s56
  s_mov_b64 exec, -1
  s_branch Lpubdone_51
Lpubnl_53:
  buffer_store_dwordx2 v[40:41], v0, s[20:23], s37 offen sc1
  s_mov_b64 exec, 1
  buffer_store_dwordx2 v[44:45], off, s[20:23], s56 sc1
  s_mov_b64 exec, -1
  s_branch Lpubdone_51
Lpubnot_52:
  v_mov_b32 v0, 0x7ffffff0
  s_mov_b64 exec, 1
  buffer_store_dword v0, v0, s[20:23], 0 offen
  buffer_store_dword v0, v0, s[20:23], 0 offen
  s_mov_b64 exec, -1
  s_waitcnt lgkmcnt(0)
Lpubdone_51:
  s_add_u32 s37, s37, 131072
  ds_read_b128 v[64:67], v4 offset:18432
  ds_read_b128 v[68:71], v4 offset:19456
  ds_read_b128 v[72:75], v4 offset:20480
  ds_read_b128 v[76:79], v4 offset:21504
  ds_read_b128 v[80:83], v4 offset:22528
  ds_read_b128 v[84:87], v4 offset:23552
  ds_read_b128 v[88:91], v4 offset:24576
  ds_read_b128 v[92:95], v4 offset:25600
  ds_read_b128 v[96:99], v4 offset:26624
  ds_read_b128 v[100:103], v4 offset:27648
  ds_read_b128 v[104:107], v4 offset:28672
  ds_read_b128 v[108:111], v4 offset:29696
  s_waitcnt lgkmcnt(4)
  ds_read_b128 v[112:115], v4 offset:30720
  ds_read_b128 v[116:119], v4 offset:31744
  ds_read_b128 v[120:123], v4 offset:32768
  ds_read_b128 v[124:127], v4 offset:33792
  ds_read_b128 v[128:131], v4 offset:34816
  ds_read_b128 v[132:135], v4 offset:35840
  s_waitcnt lgkmcnt(0)
Lqw_54:
  s_sub_u32 s33, s33, 1
  s_cbranch_scc1 Lend
  buffer_load_dwordx4 v[36:39], v3, s[20:23], s34 offen sc1
  s_waitcnt vmcnt(0)
Lqchk_56:
  v_max3_u32 v0, v36, v37, v38
  v_max_u32 v0, v0, v39
  v_cmp_eq_u32 vcc, -1, v0
  s_cbranch_vccnz Lqw_54
Lp2f:
  v_cndmask_b32 v16, 0, v36, s[40:41]
  v_cndmask_b32 v17, 0, v37, s[40:41]
  v_cndmask_b32 v18, 0, v38, s[40:41]
  v_cndmask_b32 v19, 0, v39, s[40:41]
  v_cndmask_b32 v24, 0, v36, s[44:45]
  v_cndmask_b32 v25, 0, v37, s[44:45]
  v_cndmask_b32 v26, 0, v38, s[44:45]
  v_cndmask_b32 v27, 0, v39, s[44:45]
  v_mfma_f32_16x16x32_bf16 v[136:139], a[176:179], v[16:19], 0
  v_cndmask_b32 v20, 0, v36, s[42:43]
  v_cndmask_b32 v21, 0, v37, s[42:43]
  v_cndmask_b32 v22, 0, v38, s[42:43]
  v_cndmask_b32 v23, 0, v39, s[42:43]
  v_mfma_f32_16x16x32_bf16 v[140:143], v[160:163], v[16:19], 0
  v_cndmask_b32 v28, 0, v36, s[46:47]
  v_cndmask_b32 v29, 0, v37, s[46:47]
  v_cndmask_b32 v30, 0, v38, s[46:47]
  v_cndmask_b32 v31, 0, v39, s[46:47]
  v_mfma_f32_16x16x32_bf16 v[140:143], v[164:167], v[24:27], v[140:143]
  v_mfma_f32_16x16x32_bf16 v[140:143], v[168:171], v[20:23], v[140:143]
  v_mov_b32_dpp v15, v136 quad_perm:[0,0,0,0] row_mask:0xf bank_mask:0xf
  v_mov_b32_dpp v156, v138 quad_perm:[2,2,2,2] row_mask:0xf bank_mask:0xf
  v_mfma_f32_16x16x32_bf16 v[140:143], v[172:175], v[28:31], v[140:143]
  v_add_f32_dpp v15, v137, v15 quad_perm:[1,1,1,1] row_mask:0xf bank_mask:0xf
  v_add_f32_dpp v156, v139, v156 quad_perm:[3,3,3,3] row_mask:0xf bank_mask:0xf
  v_mfma_f32_16x16x32_bf16 v[144:147], v[176:179], v[16:19], 0
  v_add_f32 v15, v15, v156
  s_mov_b64 exec, s[48:49]
  v_mov_b32 v15, 0xff800000
  s_mov_b64 exec, -1
  v_mfma_f32_16x16x32_bf16 v[144:147], v[180:183], v[24:27], v[144:147]
  v_mfma_f32_16x16x32_bf16 v[144:147], v[184:187], v[20:23], v[144:147]
  v_mov_b32_dpp v6, v140 quad_perm:[0,0,0,0] row_mask:0xf bank_mask:0xf
  v_mov_b32_dpp v156, v142 quad_perm:[2,2,2,2] row_mask:0xf bank_mask:0xf
  v_mfma_f32_16x16x32_bf16 v[144:147], v[188:191], v[28:31], v[144:147]
  v_add_f32_dpp v6, v141, v6 quad_perm:[1,1,1,1] row_mask:0xf bank_mask:0xf
  v_add_f32_dpp v156, v143, v156 quad_perm:[3,3,3,3] row_mask:0xf bank_mask:0xf
  v_mfma_f32_16x16x32_bf16 v[148:151], a[128:131], v[16:19], 0
  v_add_f32 v6, v6, v156
  v_max_f32 v158, v15, v6
  v_mfma_f32_16x16x32_bf16 v[148:151], a[132:135], v[24:27], v[148:151]
  v_mfma_f32_16x16x32_bf16 v[148:151], a[136:139], v[20:23], v[148:151]
  s_nop 0
  v_mov_b32_dpp v7, v144 quad_perm:[0,0,0,0] row_mask:0xf bank_mask:0xf
  v_mov_b32_dpp v156, v146 quad_perm:[2,2,2,2] row_mask:0xf bank_mask:0xf
  v_mfma_f32_16x16x32_bf16 v[148:151], a[140:143], v[28:31], v[148:151]
  v_add_f32_dpp v7, v145, v7 quad_perm:[1,1,1,1] row_mask:0xf bank_mask:0xf
  v_add_f32_dpp v156, v147, v156 quad_perm:[3,3,3,3] row_mask:0xf bank_mask:0xf
  v_mfma_f32_16x16x32_bf16 v[152:155], a[144:147], v[16:19], 0
  v_add_f32 v7, v7, v156
  v_max_f32 v158, v158, v7
  v_mfma_f32_16x16x32_bf16 v[152:155], a[148:151], v[24:27], v[152:155]
  v_mfma_f32_16x16x32_bf16 v[152:155], a[152:155], v[20:23], v[152:155]
  s_nop 0
  v_mov_b32_dpp v8, v148 quad_perm:[0,0,0,0] row_mask:0xf bank_mask:0xf
  v_mov_b32_dpp v156, v150 quad_perm:[2,2,2,2] row_mask:0xf bank_mask:0xf
  v_mfma_f32_16x16x32_bf16 v[152:155], a[156:159], v[28:31], v[152:155]
  v_add_f32_dpp v8, v149, v8 quad_perm:[1,1,1,1] row_mask:0xf bank_mask:0xf
  v_add_f32_dpp v156, v151, v156 quad_perm:[3,3,3,3] row_mask:0xf bank_mask:0xf
  v_mfma_f32_16x16x32_bf16 v[136:139], a[160:163], v[16:19], 0
  v_add_f32 v8, v8, v156
  v_max_f32 v158, v158, v8
  v_mfma_f32_16x16x32_bf16 v[136:139], a[164:167], v[24:27], v[136:139]
  v_mfma_f32_16x16x32_bf16 v[136:139], a[168:171], v[20:23], v[136:139]
  s_nop 0
  v_mov_b32_dpp v9, v152 quad_perm:[0,0,0,0] row_mask:0xf bank_mask:0xf
  v_mov_b32_dpp v156, v154 quad_perm:[2,2,2,2] row_mask:0xf bank_mask:0xf
  v_mfma_f32_16x16x32_bf16 v[136:139], a[172:175], v[28:31], v[136:139]
  v_add_f32_dpp v9, v153, v9 quad_perm:[1,1,1,1] row_mask:0xf bank_mask:0xf
  v_add_f32_dpp v156, v155, v156 quad_perm:[3,3,3,3] row_mask:0xf bank_mask:0xf
  v_mfma_f32_16x16x32_bf16 v[140:143], v[192:195], v[16:19], 0
  v_add_f32 v9, v9, v156
  v_max_f32 v158, v158, v9
  v_mfma_f32_16x16x32_bf16 v[140:143], v[196:199], v[24:27], v[140:143]
  v_mfma_f32_16x16x32_bf16 v[140:143], v[200:203], v[20:23], v[140:143]
  s_nop 0
  v_mov_b32_dpp v10, v136 quad_perm:[0,0,0,0] row_mask:0xf bank_mask:0xf
  v_mov_b32_dpp v156, v138 quad_perm:[2,2,2,2] row_mask:0xf bank_mask:0xf
  v_mfma_f32_16x16x32_bf16 v[140:143], v[204:207], v[28:31], v[140:143]
  v_add_f32_dpp v10, v137, v10 quad_perm:[1,1,1,1] row_mask:0xf bank_mask:0xf
  v_add_f32_dpp v156, v139, v156 quad_perm:[3,3,3,3] row_mask:0xf bank_mask:0xf
  v_mfma_f32_16x16x32_bf16 v[144:147], v[208:211], v[16:19], 0
  v_add_f32 v10, v10, v156
  v_max_f32 v158, v158, v10
  v_mfma_f32_16x16x32_bf16 v[144:147], v[212:215], v[24:27], v[144:147]
  v_mfma_f32_16x16x32_bf16 v[144:147], v[216:219], v[20:23], v[144:147]
  s_nop 0
  v_mov_b32_dpp v11, v140 quad_perm:[0,0,0,0] row_mask:0xf bank_mask:0xf
  v_mov_b32_dpp v156, v142 quad_perm:[2,2,2,2] row_mask:0xf bank_mask:0xf
  v_mfma_f32_16x16x32_bf16 v[144:147], v[220:223], v[28:31], v[144:147]
  v_add_f32_dpp v11, v141, v11 quad_perm:[1,1,1,1] row_mask:0xf bank_mask:0xf
  v_add_f32_dpp v156, v143, v156 quad_perm:[3,3,3,3] row_mask:0xf bank_mask:0xf
  v_mfma_f32_16x16x32_bf16 v[148:151], v[224:227], v[16:19], 0
  v_add_f32 v11, v11, v156
  v_max_f32 v158, v158, v11
  v_mfma_f32_16x16x32_bf16 v[148:151], v[228:231], v[24:27], v[148:151]
  v_mfma_f32_16x16x32_bf16 v[148:151], v[232:235], v[20:23], v[148:151]
  s_nop 0
  v_mov_b32_dpp v12, v144 quad_perm:[0,0,0,0] row_mask:0xf bank_mask:0xf
  v_mov_b32_dpp v156, v146 quad_perm:[2,2,2,2] row_mask:0xf bank_mask:0xf
  v_mfma_f32_16x16x32_bf16 v[148:151], v[236:239], v[28:31], v[148:151]
  v_add_f32_dpp v12, v145, v12 quad_perm:[1,1,1,1] row_mask:0xf bank_mask:0xf
  v_add_f32_dpp v156, v147, v156 quad_perm:[3,3,3,3] row_mask:0xf bank_mask:0xf
  v_mfma_f32_16x16x32_bf16 v[152:155], v[240:243], v[16:19], 0
  v_add_f32 v12, v12, v156
  v_max_f32 v158, v158, v12
  v_mfma_f32_16x16x32_bf16 v[152:155], v[244:247], v[24:27], v[152:155]
  v_mfma_f32_16x16x32_bf16 v[152:155], v[248:251], v[20:23], v[152:155]
  s_nop 0
  v_mov_b32_dpp v13, v148 quad_perm:[0,0,0,0] row_mask:0xf bank_mask:0xf
  v_mov_b32_dpp v156, v150 quad_perm:[2,2,2,2] row_mask:0xf bank_mask:0xf
  v_mfma_f32_16x16x32_bf16 v[152:155], v[252:255], v[28:31], v[152:155]
  v_add_f32_dpp v13, v149, v13 quad_perm:[1,1,1,1] row_mask:0xf bank_mask:0xf
  v_add_f32_dpp v156, v151, v156 quad_perm:[3,3,3,3] row_mask:0xf bank_mask:0xf
  v_add_f32 v13, v13, v156
  v_max_f32 v158, v158, v13
  s_nop 3
  v_mov_b32_dpp v14, v152 quad_perm:[0,0,0,0] row_mask:0xf bank_mask:0xf
  v_mov_b32_dpp v156, v154 quad_perm:[2,2,2,2] row_mask:0xf bank_mask:0xf
  s_nop 0
  v_add_f32_dpp v14, v153, v14 quad_perm:[1,1,1,1] row_mask:0xf bank_mask:0xf
  v_add_f32_dpp v156, v155, v156 quad_perm:[3,3,3,3] row_mask:0xf bank_mask:0xf
  v_add_f32 v14, v14, v156
  v_max_f32 v158, v158, v14
  s_nop 1
  v_max_f32_dpp v158, v158, v158 row_ror:4 row_mask:0xf bank_mask:0xf
  s_nop 1
  v_max_f32_dpp v158, v158, v158 row_ror:8 row_mask:0xf bank_mask:0xf
  s_nop 1
  v_max_f32_dpp v158, v158, v158 row_bcast:15 row_mask:0xa bank_mask:0xf
  s_nop 1
  v_max_f32_dpp v158, v158, v158 row_bcast:31 row_mask:0xc bank_mask:0xf
  v_mul_f32 v158, 0xbe0293ee, v158
  s_nop 0
  v_readlane_b32 s56, v158, 63
  s_nop 1
  v_mov_b32 v158, s56
  v_fmamk_f32 v6, v6, 0x3e0293ee, v158
  v_fmamk_f32 v7, v7, 0x3e0293ee, v158
  v_exp_f32 v6, v6
  v_exp_f32 v7, v7
  v_mov_b32 v159, v6
  v_cvt_pk_bf16_f32 v6, v6, v6
  v_add_f32 v159, v159, v7
  v_cvt_pk_bf16_f32 v7, v7, v7
  v_and_b32 v44, v6, v32
  v_and_b32 v45, v6, v33
  v_and_b32_dpp v46, v6, v34 row_half_mirror row_mask:0xf bank_mask:0xf
  v_and_b32_dpp v47, v6, v35 row_half_mirror row_mask:0xf bank_mask:0xf
  s_nop 1
  v_mfma_f32_16x16x32_bf16 v[52:55], v[64:67], v[44:47], 0
  v_and_b32_dpp v48, v6, v32 row_half_mirror row_mask:0xf bank_mask:0xf
  v_and_b32_dpp v49, v6, v33 row_half_mirror row_mask:0xf bank_mask:0xf
  v_and_b32 v50, v6, v34
  v_mfma_f32_16x16x32_bf16 v[56:59], a[180:183], v[44:47], 0
  v_and_b32 v51, v6, v35
  v_fmamk_f32 v8, v8, 0x3e0293ee, v158
  v_exp_f32 v8, v8
  v_mfma_f32_16x16x32_bf16 v[52:55], v[68:71], v[48:51], v[52:55]
  v_and_b32 v44, v7, v32
  v_and_b32 v45, v7, v33
  v_and_b32_dpp v46, v7, v34 row_half_mirror row_mask:0xf bank_mask:0xf
  v_mfma_f32_16x16x32_bf16 v[56:59], a[184:187], v[48:51], v[56:59]
  v_and_b32_dpp v47, v7, v35 row_half_mirror row_mask:0xf bank_mask:0xf
  v_add_f32 v159, v159, v8
  v_cvt_pk_bf16_f32 v8, v8, v8
  v_mfma_f32_16x16x32_bf16 v[52:55], v[72:75], v[44:47], v[52:55]
  v_and_b32_dpp v48, v7, v32 row_half_mirror row_mask:0xf bank_mask:0xf
  v_and_b32_dpp v49, v7, v33 row_half_mirror row_mask:0xf bank_mask:0xf
  v_and_b32 v50, v7, v34
  v_mfma_f32_16x16x32_bf16 v[56:59], a[188:191], v[44:47], v[56:59]
  v_and_b32 v51, v7, v35
  v_fmamk_f32 v9, v9, 0x3e0293ee, v158
  v_exp_f32 v9, v9
  v_mfma_f32_16x16x32_bf16 v[52:55], v[76:79], v[48:51], v[52:55]
  v_and_b32 v44, v8, v32
  v_and_b32 v45, v8, v33
  v_and_b32_dpp v46, v8, v34 row_half_mirror row_mask:0xf bank_mask:0xf
  v_mfma_f32_16x16x32_bf16 v[56:59], a[192:195], v[48:51], v[56:59]
  v_and_b32_dpp v47, v8, v35 row_half_mirror row_mask:0xf bank_mask:0xf
  v_add_f32 v159, v159, v9
  v_cvt_pk_bf16_f32 v9, v9, v9
  v_mfma_f32_16x16x32_bf16 v[52:55], v[80:83], v[44:47], v[52:55]
  v_and_b32_dpp v48, v8, v32 row_half_mirror row_mask:0xf bank_mask:0xf
  v_and_b32_dpp v49, v8, v33 row_half_mirror row_mask:0xf bank_mask:0xf
  v_and_b32 v50, v8, v34
  v_mfma_f32_16x16x32_bf16 v[56:59], a[196:199], v[44:47], v[56:59]
  v_and_b32 v51, v8, v35
  v_fmamk_f32 v10, v10, 0x3e0293ee, v158
  v_exp_f32 v10, v10
  v_mfma_f32_16x16x32_bf16 v[52:55], v[84:87], v[48:51], v[52:55]
  v_and_b32 v44, v9, v32
  v_and_b32 v45, v9, v33
  v_and_b32_dpp v46, v9, v34 row_half_mirror row_mask:0xf bank_mask:0xf
  v_mfma_f32_16x16x32_bf16 v[56:59], a[200:203], v[48:51], v[56:59]
  v_and_b32_dpp v47, v9, v35 row_half_mirror row_mask:0xf bank_mask:0xf
  v_add_f32 v159, v159, v10
  v_cvt_pk_bf16_f32 v10, v10, v10
  v_mfma_f32_16x16x32_bf16 v[52:55], v[88:91], v[44:47], v[52:55]
  v_and_b32_dpp v48, v9, v32 row_half_mirror row_mask:0xf bank_mask:0xf
  v_and_b32_dpp v49, v9, v33 row_half_mirror row_mask:0xf bank_mask:0xf
  v_and_b32 v50, v9, v34
  v_mfma_f32_16x16x32_bf16 v[56:59], a[204:207], v[44:47], v[56:59]
  v_and_b32 v51, v9, v35
  v_fmamk_f32 v11, v11, 0x3e0293ee, v158
  v_exp_f32 v11, v11
  v_mfma_f32_16x16x32_bf16 v[52:55], v[92:95], v[48:51], v[52:55]
  v_and_b32 v44, v10, v32
  v_and_b32 v45, v10, v33
  v_and_b32_dpp v46, v10, v34 row_half_mirror row_mask:0xf bank_mask:0xf
  v_mfma_f32_16x16x32_bf16 v[56:59], a[208:211], v[48:51], v[56:59]
  v_and_b32_dpp v47, v10, v35 row_half_mirror row_mask:0xf bank_mask:0xf
  v_add_f32 v159, v159, v11
  v_cvt_pk_bf16_f32 v11, v11, v11
  v_mfma_f32_16x16x32_bf16 v[52:55], v[96:99], v[44:47], v[52:55]
  v_and_b32_dpp v48, v10, v32 row_half_mirror row_mask:0xf bank_mask:0xf
  v_and_b32_dpp v49, v10, v33 row_half_mirror row_mask:0xf bank_mask:0xf
  v_and_b32 v50, v10, v34
  v_mfma_f32_16x16x32_bf16 v[56:59], a[212:215], v[44:47], v[56:59]
  v_and_b32 v51, v10, v35
  v_fmamk_f32 v12, v12, 0x3e0293ee, v158
  v_exp_f32 v12, v12
  v_mfma_f32_16x16x32_bf16 v[52:55], v[100:103], v[48:51], v[52:55]
  v_and_b32 v44, v11, v32
  v_and_b32 v45, v11, v33
  v_and_b32_dpp v46, v11, v34 row_half_mirror row_mask:0xf bank_mask:0xf
  v_mfma_f32_16x16x32_bf16 v[56:59], a[216:219], v[48:51], v[56:59]
  v_and_b32_dpp v47, v11, v35 row_half_mirror row_mask:0xf bank_mask:0xf
  v_add_f32 v159, v159, v12
  v_cvt_pk_bf16_f32 v12, v12, v12
  v_mfma_f32_16x16x32_bf16 v[52:55], v[104:107], v[44:47], v[52:55]
  v_and_b32_dpp v48, v11, v32 row_half_mirror row_mask:0xf bank_mask:0xf
  v_and_b32_dpp v49, v11, v33 row_half_mirror row_mask:0xf bank_mask:0xf
  v_and_b32 v50, v11, v34
  v_mfma_f32_16x16x32_bf16 v[56:59], a[220:223], v[44:47], v[56:59]
  v_and_b32 v51, v11, v35
  v_fmamk_f32 v13, v13, 0x3e0293ee, v158
  v_exp_f32 v13, v13
  v_mfma_f32_16x16x32_bf16 v[52:55], v[108:111], v[48:51], v[52:55]
  v_and_b32 v44, v12, v32
  v_and_b32 v45, v12, v33
  v_and_b32_dpp v46, v12, v34 row_half_mirror row_mask:0xf bank_mask:0xf
  v_mfma_f32_16x16x32_bf16 v[56:59], a[224:227], v[48:51], v[56:59]
  v_and_b32_dpp v47, v12, v35 row_half_mirror row_mask:0xf bank_mask:0xf
  v_add_f32 v159, v159, v13
  v_cvt_pk_bf16_f32 v13, v13, v13
  v_mfma_f32_16x16x32_bf16 v[52:55], v[112:115], v[44:47], v[52:55]
  v_and_b32_dpp v48, v12, v32 row_half_mirror row_mask:0xf bank_mask:0xf
  v_and_b32_dpp v49, v12, v33 row_half_mirror row_mask:0xf bank_mask:0xf
  v_and_b32 v50, v12, v34
  v_mfma_f32_16x16x32_bf16 v[56:59], a[228:231], v[44:47], v[56:59]
  v_and_b32 v51, v12, v35
  v_fmamk_f32 v14, v14, 0x3e0293ee, v158
  v_exp_f32 v14, v14
  v_mfma_f32_16x16x32_bf16 v[52:55], v[116:119], v[48:51], v[52:55]
  v_and_b32 v44, v13, v32
  v_and_b32 v45, v13, v33
  v_and_b32_dpp v46, v13, v34 row_half_mirror row_mask:0xf bank_mask:0xf
  v_mfma_f32_16x16x32_bf16 v[56:59], a[232:235], v[48:51], v[56:59]
  v_and_b32_dpp v47, v13, v35 row_half_mirror row_mask:0xf bank_mask:0xf
  v_add_f32 v159, v159, v14
  v_cvt_pk_bf16_f32 v14, v14, v14
  v_mfma_f32_16x16x32_bf16 v[52:55], v[120:123], v[44:47], v[52:55]
  v_and_b32_dpp v48, v13, v32 row_half_mirror row_mask:0xf bank_mask:0xf
  v_and_b32_dpp v49, v13, v33 row_half_mirror row_mask:0xf bank_mask:0xf
  v_and_b32 v50, v13, v34
  v_mfma_f32_16x16x32_bf16 v[56:59], a[236:239], v[44:47], v[56:59]
  v_and_b32 v51, v13, v35
  v_fmamk_f32 v15, v15, 0x3e0293ee, v158
  v_exp_f32 v15, v15
  v_mfma_f32_16x16x32_bf16 v[52:55], v[124:127], v[48:51], v[52:55]
  v_and_b32 v44, v14, v32
  v_and_b32 v45, v14, v33
  v_and_b32_dpp v46, v14, v34 row_half_mirror row_mask:0xf bank_mask:0xf
  v_mfma_f32_16x16x32_bf16 v[56:59], a[240:243], v[48:51], v[56:59]
  v_and_b32_dpp v47, v14, v35 row_half_mirror row_mask:0xf bank_mask:0xf
  v_add_f32 v159, v159, v15
  v_cvt_pk_bf16_f32 v15, v15, v15
  v_mfma_f32_16x16x32_bf16 v[52:55], v[128:131], v[44:47], v[52:55]
  v_and_b32_dpp v48, v14, v32 row_half_mirror row_mask:0xf bank_mask:0xf
  v_and_b32_dpp v49, v14, v33 row_half_mirror row_mask:0xf bank_mask:0xf
  v_and_b32 v50, v14, v34
  v_mfma_f32_16x16x32_bf16 v[56:59], a[244:247], v[44:47], v[56:59]
  v_and_b32 v51, v14, v35
  v_add_f32_dpp v159, v159, v159 row_ror:4 row_mask:0xf bank_mask:0xf
  s_nop 0
  s_nop 0
  v_add_f32_dpp v159, v159, v159 row_ror:8 row_mask:0xf bank_mask:0xf
  s_nop 0
  v_mfma_f32_16x16x32_bf16 v[52:55], v[132:135], v[48:51], v[52:55]
  v_and_b32 v44, v15, v32
  v_and_b32 v45, v15, v33
  v_and_b32_dpp v46, v15, v34 row_half_mirror row_mask:0xf bank_mask:0xf
  v_mfma_f32_16x16x32_bf16 v[56:59], a[248:251], v[48:51], v[56:59]
  v_and_b32_dpp v47, v15, v35 row_half_mirror row_mask:0xf bank_mask:0xf
  v_add_f32_dpp v159, v159, v159 row_bcast:15 row_mask:0xa bank_mask:0xf
  s_nop 0
  s_nop 0
  v_add_f32_dpp v159, v159, v159 row_bcast:31 row_mask:0xc bank_mask:0xf
  v_mfma_f32_16x16x32_bf16 v[52:55], a[252:255], v[44:47], v[52:55]
  v_mov_b32 v0, s54
  s_mov_b32 exec_lo, 0
  s_mov_b32 exec_hi, 0x80000000
  ds_write_b64 v0, v[158:159] offset:8288
  s_mov_b64 exec, -1
  v_lshrrev_b32 v0, 1, v2
  v_add_u32 v5, s53, v0
  v_mov_b32 v42, 1
  v_mov_b32 v43, 0
  v_add_f32_dpp v40, v56, v52 row_ror:8 row_mask:0xf bank_mask:0x3
  v_add_f32_dpp v41, v57, v53 row_ror:8 row_mask:0xf bank_mask:0x3
  s_nop 0
  v_add_f32_dpp v40, v54, v58 row_ror:8 row_mask:0xf bank_mask:0xc
  v_add_f32_dpp v41, v55, v59 row_ror:8 row_mask:0xf bank_mask:0xc
  ds_write_b64 v5, v[40:41] offset:6144
  s_mov_b64 exec, 1
  ds_add_rtn_u32 v42, v43, v42 offset:8332
  s_mov_b64 exec, -1
  ds_read_b128 v[16:19], v43 offset:8288
  ds_read_b128 v[20:23], v43 offset:8304
  ds_read_b64 v[24:25], v0 offset:6144
  ds_read_b64 v[26:27], v0 offset:6656
  ds_read_b64 v[28:29], v0 offset:7168
  ds_read_b64 v[30:31], v0 offset:7680
  s_waitcnt lgkmcnt(4)
  v_readfirstlane_b32 s56, v42
  v_min3_f32 v44, v16, v18, v20
  s_and_b32 s56, s56, 3
  s_cmp_lg_u32 s56, 3
  s_cbranch_scc1 Lpubnot_58
  v_min_f32 v44, v44, v22
  v_sub_f32 v16, v44, v16
  v_sub_f32 v18, v44, v18
  v_sub_f32 v20, v44, v20
  v_sub_f32 v22, v44, v22
  v_exp_f32 v16, v16
  v_exp_f32 v18, v18
  v_exp_f32 v20, v20
  v_exp_f32 v22, v22
  s_waitcnt lgkmcnt(0)
  v_mul_f32 v40, v16, v24
  v_mul_f32 v41, v16, v25
  v_mul_f32 v45, v16, v17
  v_fmac_f32 v40, v18, v26
  v_fmac_f32 v41, v18, v27
  v_fmac_f32 v45, v18, v19
  v_fmac_f32 v40, v20, v28
  v_fmac_f32 v41, v20, v29
  v_fmac_f32 v45, v20, v21
  v_fmac_f32 v40, v22, v30
  v_fmac_f32 v41, v22, v31
  v_fmac_f32 v45, v22, v23
  s_add_u32 s56, s37, s55
  s_cmp_eq_u32 s32, 0
  s_cbranch_scc1 Lpubnl_59
  buffer_store_dwordx2 v[40:41], v0, s[20:23], s37 offen
  s_mov_b64 exec, 1
  buffer_store_dwordx2 v[44:45], off, s[20:23], s56
  s_mov_b64 exec, -1
  s_branch Lpubdone_57
Lpubnl_59:
  buffer_store_dwordx2 v[40:41], v0, s[20:23], s37 offen sc1
  s_mov_b64 exec, 1
  buffer_store_dwordx2 v[44:45], off, s[20:23], s56 sc1
  s_mov_b64 exec, -1
  s_branch Lpubdone_57
Lpubnot_58:
  v_mov_b32 v0, 0x7ffffff0
  s_mov_b64 exec, 1
  buffer_store_dword v0, v0, s[20:23], 0 offen
  buffer_store_dword v0, v0, s[20:23], 0 offen
  s_mov_b64 exec, -1
  s_waitcnt lgkmcnt(0)
Lpubdone_57:
  s_branch Lend
Lchain:
  s_load_dwordx2 s[72:73], s[0:1], 0
  s_load_dwordx4 s[76:79], s[0:1], 24
  s_load_dwordx8 s[80:87], s[0:1], 48
  v_lshlrev_b32 v2, 4, v0
  v_lshlrev_b32 v3, 3, v0
  v_lshrrev_b32 v14, 4, v0
  v_and_b32 v15, 15, v0
  s_lshl_b32 s57, s90, 2
  s_add_u32 s57, s57, s91
  s_waitcnt lgkmcnt(0)
  s_mov_b32 s20, s70
  s_mov_b32 s21, s71
  s_mov_b32 s22, 0x600000
  s_mov_b32 s23, 0x20000
  s_mov_b32 s16, s72
  s_mov_b32 s17, s73
  s_mov_b32 s18, 8192
  s_mov_b32 s19, 0x20000
  s_mov_b32 s4, s76
  s_mov_b32 s5, s77
  s_mov_b32 s6, 0x400000
  s_mov_b32 s7, 0x20000
  v_lshlrev_b32 v30, 5, v0
  s_lshl_b32 s58, s92, 11
  buffer_load_dwordx4 v[32:35], v30, s[16:19], s58 offen
  buffer_load_dwordx4 v[36:39], v30, s[16:19], s58 offen offset:16
  v_lshrrev_b32 v64, 1, v15
  v_xor_b32 v64, v64, v14
  v_lshlrev_b32 v64, 5, v64
  v_and_b32 v67, 1, v15
  v_lshl_add_u32 v64, v67, 4, v64
  s_lshl_b32 s60, s92, 13
  s_add_u32 s60, s60, 32768
  s_mov_b32 s24, s68
  s_mov_b32 s25, s69
  s_mov_b32 s26, 256
  s_mov_b32 s27, 0x20000
  s_lshl_b32 s59, s57, 8
  s_mul_i32 s58, s92, 262144
  s_add_u32 s58, s58, s59
  v_lshl_add_u32 v65, v14, 13, v64
  v_xor_b32 v66, 128, v65
  v_add_u32 v65, s58, v65
  v_add_u32 v66, s58, v66
  s_add_u32 m0, s60, 0
  v_add_u32 v67, 0, v65
  buffer_load_dwordx4 v67, s[4:7], 0 offen nt lds
  s_add_u32 m0, s60, 1024
  v_add_u32 v67, 32768, v65
  buffer_load_dwordx4 v67, s[4:7], 0 offen nt lds
  s_add_u32 m0, s60, 2048
  v_add_u32 v67, 65536, v66
  buffer_load_dwordx4 v67, s[4:7], 0 offen nt lds
  s_add_u32 m0, s60, 3072
  v_add_u32 v67, 98304, v66
  buffer_load_dwordx4 v67, s[4:7], 0 offen nt lds
  s_add_u32 m0, s60, 4096
  v_add_u32 v67, 131072, v65
  buffer_load_dwordx4 v67, s[4:7], 0 offen nt lds
  s_add_u32 m0, s60, 5120
  v_add_u32 v67, 163840, v65
  buffer_load_dwordx4 v67, s[4:7], 0 offen nt lds
  s_add_u32 m0, s60, 6144
  v_add_u32 v67, 196608, v66
  buffer_load_dwordx4 v67, s[4:7], 0 offen nt lds
  s_add_u32 m0, s60, 7168
  v_add_u32 v67, 229376, v66
  buffer_load_dwordx4 v67, s[4:7], 0 offen nt lds
  s_add_u32 m0, s60, 32768
  v_add_u32 v67, 1048576, v65
  buffer_load_dwordx4 v67, s[4:7], 0 offen nt lds
  s_add_u32 m0, s60, 33792
  v_add_u32 v67, 1081344, v65
  buffer_load_dwordx4 v67, s[4:7], 0 offen nt lds
  s_add_u32 m0, s60, 34816
  v_add_u32 v67, 1114112, v66
  buffer_load_dwordx4 v67, s[4:7], 0 offen nt lds
  s_add_u32 m0, s60, 35840
  v_add_u32 v67, 1146880, v66
  buffer_load_dwordx4 v67, s[4:7], 0 offen nt lds
  s_add_u32 m0, s60, 36864
  v_add_u32 v67, 1179648, v65
  buffer_load_dwordx4 v67, s[4:7], 0 offen nt lds
  s_add_u32 m0, s60, 37888
  v_add_u32 v67, 1212416, v65
  buffer_load_dwordx4 v67, s[4:7], 0 offen nt lds
  s_add_u32 m0, s60, 38912
  v_add_u32 v67, 1245184, v66
  buffer_load_dwordx4 v67, s[4:7], 0 offen nt lds
  s_add_u32 m0, s60, 39936
  v_add_u32 v67, 1277952, v66
  buffer_load_dwordx4 v67, s[4:7], 0 offen nt lds
  v_mov_b32 v20, -1
  v_mov_b32 v21, -1
  v_mov_b32 v22, -1
  v_mov_b32 v23, -1
  s_lshl_b32 s58, s91, 14
  s_lshl_b32 s59, s90, 10
  s_add_u32 s31, s58, s59
  s_add_u32 s31, s31, 4194304
  s_add_u32 s35, s59, 2752512
  s_lshl_b32 s58, s91, 2
  s_add_u32 s58, s58, s92
  s_lshl_b32 s58, s58, 13
  s_add_u32 s58, s58, s35
  buffer_store_dwordx4 v[20:23], v2, s[20:23], s58 offen sc1
  s_lshl_b32 s36, s57, 8
  s_add_u32 s36, s36, 2883584
  v_lshlrev_b32 v30, 13, v14
  v_lshl_add_u32 v30, v15, 4, v30
  s_lshl_b32 s58, s92, 15
  s_add_u32 s58, s58, s36
  buffer_store_dwordx4 v[20:23], v30, s[20:23], s58 offen sc1
  s_mov_b32 s33, 400000
  s_mov_b32 s94, 0x3db504f3
  s_mov_b32 s95, 0xffff0000
  s_getreg_b32 s56, hwreg(HW_REG_XCC_ID, 0, 4)
  s_and_b32 s56, s56, 7
  s_mul_i32 s93, s56, s56
  s_lshl_b32 s93, s93, 14
  s_lshl_b32 s56, s56, 6
  s_add_u32 s93, s93, s56
  s_add_u32 s93, s93, 1
  s_mov_b32 s40, s78
  s_mov_b32 s41, s79
  s_mov_b32 s42, 0x400000
  s_mov_b32 s43, 0x20000
  s_mov_b32 s44, s84
  s_mov_b32 s45, s85
  s_mov_b32 s46, 0x158000
  s_mov_b32 s47, 0x20000
  s_mov_b32 s48, s86
  s_mov_b32 s49, s87
  s_mov_b32 s50, 8192
  s_mov_b32 s51, 0x20000
  s_mul_i32 s58, s90, 12
  s_mul_i32 s59, s91, 3
  s_add_u32 s59, s59, s92
  s_add_u32 s58, s58, s59
  s_cmp_lt_u32 s58, 86
  s_cselect_b32 s61, 1409024, 0
  s_cmp_lt_u32 s92, 3
  s_cselect_b32 s61, s61, 0
  s_mov_b32 s8, s80
  s_mov_b32 s9, s81
  s_mov_b32 s10, s61
  s_mov_b32 s11, 0x20000
  s_mov_b32 s12, s82
  s_mov_b32 s13, s83
  s_mov_b32 s14, s61
  s_mov_b32 s15, 0x20000
  v_bfe_u32 v70, v0, 3, 2
  v_lshlrev_b32 v70, 3, v70
  v_lshrrev_b32 v67, 5, v0
  v_lshl_add_u32 v70, v67, 2, v70
  v_bfe_u32 v67, v0, 1, 2
  v_add_u32 v70, v70, v67
  v_mul_u32_u24 v70, 2752, v70
  v_and_b32 v67, 1, v0
  v_lshl_add_u32 v70, v67, 4, v70
  s_lshl_b32 s58, s58, 5
  v_add_u32 v70, s58, v70
  v_lshrrev_b32 v30, 2, v15
  v_and_b32 v31, 1, v14
  v_lshl_add_u32 v31, v31, 2, v30
  s_lshl_b32 s58, s92, 1
  v_xor_b32 v31, s58, v31
  v_lshl_add_u32 v30, v14, 3, v30
  v_lshlrev_b32 v30, 8, v30
  v_lshl_add_u32 v68, v31, 5, v30
  v_and_b32 v30, 3, v15
  v_lshl_add_u32 v68, v30, 3, v68
  v_xor_b32 v69, 32, v68
  v_lshrrev_b32 v6, 3, v15
  v_lshlrev_b32 v6, 9, v6
  v_lshl_add_u32 v6, v14, 3, v6
  s_lshl_b32 s58, s59, 5
  v_add_u32 v6, s58, v6
  v_lshrrev_b32 v4, 3, v15
  v_lshlrev_b32 v4, 9, v4
  v_lshl_add_u32 v4, v14, 4, v4
  v_bfe_u32 v30, v15, 1, 1
  v_lshl_add_u32 v4, v30, 13, v4
  v_and_b32 v30, 1, v15
  v_lshl_add_u32 v4, v30, 6, v4
  s_lshl_b32 s58, s92, 7
  v_add_u32 v4, s58, v4
  v_lshlrev_b32 v7, 13, v15
  v_lshl_add_u32 v7, v14, 3, v7
  s_lshl_b32 s58, s92, 6
  v_add_u32 v7, s58, v7
  v_lshrrev_b32 v30, 3, v15
  v_lshlrev_b32 v5, 9, v30
  v_lshl_add_u32 v5, v14, 4, v5
  v_and_b32 v31, 7, v15
  v_mul_u32_u24 v1, 1056, v31
  v_lshl_add_u32 v1, v14, 4, v1
  v_cmp_eq_u32 vcc, 7, v31
  s_nop 1
  v_cndmask_b32 v11, v31, 0, vcc
  v_lshlrev_b32 v11, 3, v11
  v_add_u32 v11, 3584, v11
  v_lshrrev_b32 v10, 3, v15
  v_lshl_add_u32 v10, v10, 4, v31
  v_lshl_add_u32 v10, v14, 5, v10
  v_lshlrev_b32 v10, 1, v10
  s_lshl_b32 s58, s92, 8
  v_add_u32 v10, s58, v10
  v_and_b32 v30, 31, v0
  v_lshlrev_b32 v30, 3, v30
  v_add_u32 v30, s58, v30
  v_lshrrev_b32 v31, 5, v0
  v_lshl_add_u32 v8, v31, 13, v30
  v_mul_u32_u24 v9, 1056, v31
  v_add_u32 v9, v9, v30
  v_lshlrev_b32 v13, 5, v31
  s_lshl_b32 s58, s92, 3
  v_add_u32 v12, s58, v13
  v_lshrrev_b32 v13, 3, v15
  v_lshlrev_b32 v13, 5, v13
  v_and_b32 v30, 3, v0
  v_lshl_add_u32 v13, v30, 3, v13
  s_mov_b32 s52, 0x01010101
  s_mov_b32 s53, 0x01010101
  s_mov_b32 s88, 0x55555555
  s_mov_b32 s89, 0x55555555
  s_mov_b32 s80, 0x0f0f0f0f
  s_mov_b32 s81, 0x0f0f0f0f
  s_mov_b32 s54, 0x00010001
  s_mov_b32 s55, 0x00010001
  s_waitcnt vmcnt(18)
  v_lshlrev_b32 v30, 5, v0
  s_lshl_b32 s58, s92, 11
  v_add_u32 v30, s58, v30
  ds_write_b128 v30, v[32:35] offset:0
  ds_write_b128 v30, v[36:39] offset:16
  v_mov_b32 v24, 0
  v_mov_b32 v25, 0
  s_lshl_b32 s58, s92, 9
  v_add_u32 v30, s58, v3
  ds_write_b64 v30, v[24:25] offset:8192
  v_lshlrev_b32 v40, 16, v32
  v_and_b32 v41, s95, v32
  v_lshlrev_b32 v42, 16, v33
  v_and_b32 v43, s95, v33
  v_lshlrev_b32 v44, 16, v34
  v_and_b32 v45, s95, v34
  v_lshlrev_b32 v46, 16, v35
  v_and_b32 v47, s95, v35
  v_lshlrev_b32 v48, 16, v36
  v_and_b32 v49, s95, v36
  v_lshlrev_b32 v50, 16, v37
  v_and_b32 v51, s95, v37
  v_lshlrev_b32 v52, 16, v38
  v_and_b32 v53, s95, v38
  v_lshlrev_b32 v54, 16, v39
  v_and_b32 v55, s95, v39
  v_add_f32 v16, v40, v41
  v_mul_f32 v17, v40, v40
  v_fmac_f32 v17, v41, v41
  v_add_f32 v16, v16, v42
  v_fmac_f32 v17, v42, v42
  v_add_f32 v16, v16, v43
  v_fmac_f32 v17, v43, v43
  v_add_f32 v16, v16, v44
  v_fmac_f32 v17, v44, v44
  v_add_f32 v16, v16, v45
  v_fmac_f32 v17, v45, v45
  v_add_f32 v16, v16, v46
  v_fmac_f32 v17, v46, v46
  v_add_f32 v16, v16, v47
  v_fmac_f32 v17, v47, v47
  v_add_f32 v16, v16, v48
  v_fmac_f32 v17, v48, v48
  v_add_f32 v16, v16, v49
  v_fmac_f32 v17, v49, v49
  v_add_f32 v16, v16, v50
  v_fmac_f32 v17, v50, v50
  v_add_f32 v16, v16, v51
  v_fmac_f32 v17, v51, v51
  v_add_f32 v16, v16, v52
  v_fmac_f32 v17, v52, v52
  v_add_f32 v16, v16, v53
  v_fmac_f32 v17, v53, v53
  v_add_f32 v16, v16, v54
  v_fmac_f32 v17, v54, v54
  v_add_f32 v16, v16, v55
  v_fmac_f32 v17, v55, v55
  s_nop 0
  v_add_f32_dpp v16, v16, v16 quad_perm:[1,0,3,2] row_mask:0xf bank_mask:0xf
  v_add_f32_dpp v17, v17, v17 quad_perm:[1,0,3,2] row_mask:0xf bank_mask:0xf
  s_nop 0
  v_add_f32_dpp v16, v16, v16 quad_perm:[2,3,0,1] row_mask:0xf bank_mask:0xf
  v_add_f32_dpp v17, v17, v17 quad_perm:[2,3,0,1] row_mask:0xf bank_mask:0xf
  s_nop 0
  v_add_f32_dpp v16, v16, v16 row_half_mirror row_mask:0xf bank_mask:0xf
  v_add_f32_dpp v17, v17, v17 row_half_mirror row_mask:0xf bank_mask:0xf
  s_nop 0
  v_add_f32_dpp v16, v16, v16 row_mirror row_mask:0xf bank_mask:0xf
  v_add_f32_dpp v17, v17, v17 row_mirror row_mask:0xf bank_mask:0xf
  ds_swizzle_b32 v30, v16 offset:0x401F
  ds_swizzle_b32 v31, v17 offset:0x401F
  s_waitcnt lgkmcnt(0)
  v_add_f32 v16, v16, v30
  v_add_f32 v17, v17, v31
  v_mul_f32 v16, 0x3b000000, v16
  v_mul_f32 v17, 0x3b000000, v17
  v_fma_f32 v17, -v16, v16, v17
  v_max_f32 v17, 0, v17
  v_cvt_pk_bf16_f32 v18, v16, v17
  v_and_b32 v17, s95, v18
  v_lshlrev_b32 v16, 16, v18
  v_add_f32 v17, 0x3727c5ac, v17
  v_cvt_pk_bf16_f32 v18, v17, v17
  v_and_b32 v17, s95, v18
  v_sqrt_f32 v17, v17
  v_sub_f32 v40, v40, v16
  v_sub_f32 v41, v41, v16
  v_sub_f32 v42, v42, v16
  v_sub_f32 v43, v43, v16
  v_sub_f32 v44, v44, v16
  v_sub_f32 v45, v45, v16
  v_sub_f32 v46, v46, v16
  v_sub_f32 v47, v47, v16
  v_sub_f32 v48, v48, v16
  v_sub_f32 v49, v49, v16
  v_sub_f32 v50, v50, v16
  v_sub_f32 v51, v51, v16
  v_sub_f32 v52, v52, v16
  v_sub_f32 v53, v53, v16
  v_sub_f32 v54, v54, v16
  v_sub_f32 v55, v55, v16
  v_cvt_pk_bf16_f32 v18, v17, v17
  v_and_b32 v17, s95, v18
  v_rcp_f32 v17, v17
  v_cvt_pk_bf16_f32 v32, v40, v41
  v_cvt_pk_bf16_f32 v33, v42, v43
  v_cvt_pk_bf16_f32 v34, v44, v45
  v_cvt_pk_bf16_f32 v35, v46, v47
  v_cvt_pk_bf16_f32 v36, v48, v49
  v_cvt_pk_bf16_f32 v37, v50, v51
  v_cvt_pk_bf16_f32 v38, v52, v53
  v_cvt_pk_bf16_f32 v39, v54, v55
  v_lshlrev_b32 v40, 16, v32
  v_and_b32 v41, s95, v32
  v_lshlrev_b32 v42, 16, v33
  v_and_b32 v43, s95, v33
  v_lshlrev_b32 v44, 16, v34
  v_and_b32 v45, s95, v34
  v_lshlrev_b32 v46, 16, v35
  v_and_b32 v47, s95, v35
  v_lshlrev_b32 v48, 16, v36
  v_and_b32 v49, s95, v36
  v_lshlrev_b32 v50, 16, v37
  v_and_b32 v51, s95, v37
  v_lshlrev_b32 v52, 16, v38
  v_and_b32 v53, s95, v38
  v_lshlrev_b32 v54, 16, v39
  v_and_b32 v55, s95, v39
  v_mul_f32 v40, v40, v17
  v_mul_f32 v41, v41, v17
  v_mul_f32 v42, v42, v17
  v_mul_f32 v43, v43, v17
  v_mul_f32 v44, v44, v17
  v_mul_f32 v45, v45, v17
  v_mul_f32 v46, v46, v17
  v_mul_f32 v47, v47, v17
  v_mul_f32 v48, v48, v17
  v_mul_f32 v49, v49, v17
  v_mul_f32 v50, v50, v17
  v_mul_f32 v51, v51, v17
  v_mul_f32 v52, v52, v17
  v_mul_f32 v53, v53, v17
  v_mul_f32 v54, v54, v17
  v_mul_f32 v55, v55, v17
  v_cvt_pk_bf16_f32 v32, v40, v41
  v_cvt_pk_bf16_f32 v33, v42, v43
  v_cvt_pk_bf16_f32 v34, v44, v45
  v_cvt_pk_bf16_f32 v35, v46, v47
  v_cvt_pk_bf16_f32 v36, v48, v49
  v_cvt_pk_bf16_f32 v37, v50, v51
  v_cvt_pk_bf16_f32 v38, v52, v53
  v_cvt_pk_bf16_f32 v39, v54, v55
  v_lshrrev_b32 v31, 5, v0
  v_mul_u32_u24 v31, 1056, v31
  v_and_b32 v30, 31, v0
  v_lshl_add_u32 v30, v30, 5, v31
  s_mul_i32 s58, s92, 2112
  v_add_u32 v30, s58, v30
  ds_write_b128 v30, v[32:35] offset:18432
  ds_write_b128 v30, v[36:39] offset:18448
  s_waitcnt lgkmcnt(0)
  v_mov_b32 v30, 0
  ds_write_b32 v30, v30 offset:27008
  s_waitcnt lgkmcnt(0)
  s_waitcnt vmcnt(10)
  s_barrier
  s_add_u32 m0, s60, 65536
  v_add_u32 v67, 2097152, v65
  buffer_load_dwordx4 v67, s[4:7], 0 offen nt lds
  s_add_u32 m0, s60, 66560
  v_add_u32 v67, 2129920, v65
  buffer_load_dwordx4 v67, s[4:7], 0 offen nt lds
  s_add_u32 m0, s60, 67584
  v_add_u32 v67, 2162688, v66
  buffer_load_dwordx4 v67, s[4:7], 0 offen nt lds
  s_add_u32 m0, s60, 68608
  v_add_u32 v67, 2195456, v66
  buffer_load_dwordx4 v67, s[4:7], 0 offen nt lds
  s_add_u32 m0, s60, 69632
  v_add_u32 v67, 2228224, v65
  buffer_load_dwordx4 v67, s[4:7], 0 offen nt lds
  s_add_u32 m0, s60, 70656
  v_add_u32 v67, 2260992, v65
  buffer_load_dwordx4 v67, s[4:7], 0 offen nt lds
  s_add_u32 m0, s60, 71680
  v_add_u32 v67, 2293760, v66
  buffer_load_dwordx4 v67, s[4:7], 0 offen nt lds
  s_add_u32 m0, s60, 72704
  v_add_u32 v67, 2326528, v66
  buffer_load_dwordx4 v67, s[4:7], 0 offen nt lds
  v_add_u32 v71, 32768, v68
  v_add_u32 v72, 32768, v69
  ds_read_b64_tr_b16 a[0:1], v71 offset:0
  ds_read_b64_tr_b16 a[2:3], v71 offset:1024
  ds_read_b64_tr_b16 a[4:5], v72 offset:0
  ds_read_b64_tr_b16 a[6:7], v72 offset:1024
  ds_read_b64_tr_b16 a[8:9], v71 offset:8192
  ds_read_b64_tr_b16 a[10:11], v71 offset:9216
  ds_read_b64_tr_b16 a[12:13], v72 offset:8192
  ds_read_b64_tr_b16 a[14:15], v72 offset:9216
  ds_read_b64_tr_b16 a[16:17], v71 offset:16384
  ds_read_b64_tr_b16 a[18:19], v71 offset:17408
  ds_read_b64_tr_b16 a[20:21], v72 offset:16384
  ds_read_b64_tr_b16 a[22:23], v72 offset:17408
  s_waitcnt lgkmcnt(4)
  ds_read_b64_tr_b16 a[24:25], v71 offset:24576
  ds_read_b64_tr_b16 a[26:27], v71 offset:25600
  ds_read_b64_tr_b16 a[28:29], v72 offset:24576
  ds_read_b64_tr_b16 a[30:31], v72 offset:25600
  s_waitcnt lgkmcnt(0)
  s_waitcnt vmcnt(10)
  s_barrier
  s_add_u32 m0, s60, 98304
  v_add_u32 v67, 3145728, v65
  buffer_load_dwordx4 v67, s[4:7], 0 offen nt lds
  s_add_u32 m0, s60, 99328
  v_add_u32 v67, 3178496, v65
  buffer_load_dwordx4 v67, s[4:7], 0 offen nt lds
  s_add_u32 m0, s60, 100352
  v_add_u32 v67, 3211264, v66
  buffer_load_dwordx4 v67, s[4:7], 0 offen nt lds
  s_add_u32 m0, s60, 101376
  v_add_u32 v67, 3244032, v66
  buffer_load_dwordx4 v67, s[4:7], 0 offen nt lds
  s_add_u32 m0, s60, 102400
  v_add_u32 v67, 3276800, v65
  buffer_load_dwordx4 v67, s[4:7], 0 offen nt lds
  s_add_u32 m0, s60, 103424
  v_add_u32 v67, 3309568, v65
  buffer_load_dwordx4 v67, s[4:7], 0 offen nt lds
  s_add_u32 m0, s60, 104448
  v_add_u32 v67, 3342336, v66
  buffer_load_dwordx4 v67, s[4:7], 0 offen nt lds
  s_add_u32 m0, s60, 105472
  v_add_u32 v67, 3375104, v66
  buffer_load_dwordx4 v67, s[4:7], 0 offen nt lds
  v_add_u32 v71, 65536, v68
  v_add_u32 v72, 65536, v69
  ds_read_b64_tr_b16 a[32:33], v71 offset:0
  ds_read_b64_tr_b16 a[34:35], v71 offset:1024
  ds_read_b64_tr_b16 a[36:37], v72 offset:0
  ds_read_b64_tr_b16 a[38:39], v72 offset:1024
  ds_read_b64_tr_b16 a[40:41], v71 offset:8192
  ds_read_b64_tr_b16 a[42:43], v71 offset:9216
  ds_read_b64_tr_b16 a[44:45], v72 offset:8192
  ds_read_b64_tr_b16 a[46:47], v72 offset:9216
  ds_read_b64_tr_b16 a[48:49], v71 offset:16384
  ds_read_b64_tr_b16 a[50:51], v71 offset:17408
  ds_read_b64_tr_b16 a[52:53], v72 offset:16384
  ds_read_b64_tr_b16 a[54:55], v72 offset:17408
  s_waitcnt lgkmcnt(4)
  ds_read_b64_tr_b16 a[56:57], v71 offset:24576
  ds_read_b64_tr_b16 a[58:59], v71 offset:25600
  ds_read_b64_tr_b16 a[60:61], v72 offset:24576
  ds_read_b64_tr_b16 a[62:63], v72 offset:25600
  s_waitcnt lgkmcnt(0)
  s_waitcnt vmcnt(8)
  s_barrier
  s_cmp_lg_u32 s92, 0
  s_cbranch_scc1 Lcat_60
  s_lshl_b32 s58, s90, 4
  v_mov_b32 v30, s93
  s_mov_b64 exec, 1
  buffer_atomic_add v30, off, s[24:27], s58 sc1
  s_mov_b64 exec, -1
Lcat_60:
  s_lshl_b32 s59, s90, 19
  s_lshl_b32 s61, s91, 8
  s_add_u32 s59, s59, s61
  s_mul_i32 s58, s92, 32768
  s_add_u32 s58, s58, s59
  v_lshl_add_u32 v65, v14, 10, v64
  v_xor_b32 v66, 128, v65
  v_add_u32 v65, s58, v65
  v_add_u32 v66, s58, v66
  s_add_u32 m0, s60, 0
  v_add_u32 v67, 0, v65
  buffer_load_dwordx4 v67, s[40:43], 0 offen nt lds
  s_add_u32 m0, s60, 1024
  v_add_u32 v67, 4096, v65
  buffer_load_dwordx4 v67, s[40:43], 0 offen nt lds
  s_add_u32 m0, s60, 2048
  v_add_u32 v67, 8192, v66
  buffer_load_dwordx4 v67, s[40:43], 0 offen nt lds
  s_add_u32 m0, s60, 3072
  v_add_u32 v67, 12288, v66
  buffer_load_dwordx4 v67, s[40:43], 0 offen nt lds
  s_add_u32 m0, s60, 4096
  v_add_u32 v67, 16384, v65
  buffer_load_dwordx4 v67, s[40:43], 0 offen nt lds
  s_add_u32 m0, s60, 5120
  v_add_u32 v67, 20480, v65
  buffer_load_dwordx4 v67, s[40:43], 0 offen nt lds
  s_add_u32 m0, s60, 6144
  v_add_u32 v67, 24576, v66
  buffer_load_dwordx4 v67, s[40:43], 0 offen nt lds
  s_add_u32 m0, s60, 7168
  v_add_u32 v67, 28672, v66
  buffer_load_dwordx4 v67, s[40:43], 0 offen nt lds
  v_add_u32 v71, 98304, v68
  v_add_u32 v72, 98304, v69
  ds_read_b64_tr_b16 a[64:65], v71 offset:0
  ds_read_b64_tr_b16 a[66:67], v71 offset:1024
  ds_read_b64_tr_b16 a[68:69], v72 offset:0
  ds_read_b64_tr_b16 a[70:71], v72 offset:1024
  ds_read_b64_tr_b16 a[72:73], v71 offset:8192
  ds_read_b64_tr_b16 a[74:75], v71 offset:9216
  ds_read_b64_tr_b16 a[76:77], v72 offset:8192
  ds_read_b64_tr_b16 a[78:79], v72 offset:9216
  ds_read_b64_tr_b16 a[80:81], v71 offset:16384
  ds_read_b64_tr_b16 a[82:83], v71 offset:17408
  ds_read_b64_tr_b16 a[84:85], v72 offset:16384
  ds_read_b64_tr_b16 a[86:87], v72 offset:17408
  s_waitcnt lgkmcnt(4)
  ds_read_b64_tr_b16 a[88:89], v71 offset:24576
  ds_read_b64_tr_b16 a[90:91], v71 offset:25600
  ds_read_b64_tr_b16 a[92:93], v72 offset:24576
  ds_read_b64_tr_b16 a[94:95], v72 offset:25600
  s_waitcnt lgkmcnt(0)
  s_waitcnt vmcnt(8)
  s_barrier
  v_add_u32 v71, 131072, v68
  v_add_u32 v72, 131072, v69
  ds_read_b64_tr_b16 a[96:97], v71 offset:0
  ds_read_b64_tr_b16 a[98:99], v71 offset:1024
  ds_read_b64_tr_b16 a[100:101], v72 offset:0
  ds_read_b64_tr_b16 a[102:103], v72 offset:1024
  ds_read_b64_tr_b16 a[104:105], v71 offset:8192
  ds_read_b64_tr_b16 a[106:107], v71 offset:9216
  ds_read_b64_tr_b16 a[108:109], v72 offset:8192
  ds_read_b64_tr_b16 a[110:111], v72 offset:9216
  ds_read_b64_tr_b16 a[112:113], v71 offset:16384
  ds_read_b64_tr_b16 a[114:115], v71 offset:17408
  ds_read_b64_tr_b16 a[116:117], v72 offset:16384
  ds_read_b64_tr_b16 a[118:119], v72 offset:17408
  s_waitcnt lgkmcnt(4)
  ds_read_b64_tr_b16 a[120:121], v71 offset:24576
  ds_read_b64_tr_b16 a[122:123], v71 offset:25600
  ds_read_b64_tr_b16 a[124:125], v72 offset:24576
  ds_read_b64_tr_b16 a[126:127], v72 offset:25600
  s_waitcnt lgkmcnt(0)
  ds_read_b128 v[32:35], v1 offset:18432
  ds_read_b128 v[36:39], v1 offset:18496
  ds_read_b128 v[40:43], v1 offset:18560
  ds_read_b128 v[44:47], v1 offset:18624
  ds_read_b128 v[48:51], v1 offset:18688
  ds_read_b128 v[52:55], v1 offset:18752
  ds_read_b128 v[56:59], v1 offset:18816
  ds_read_b128 v[60:63], v1 offset:18880
  s_waitcnt lgkmcnt(7)
  v_mfma_f32_16x16x32_bf16 v[20:23], a[0:3], v[32:35], 0
  v_mfma_f32_16x16x32_bf16 v[24:27], a[4:7], v[32:35], 0
  ds_read_b128 v[32:35], v1 offset:18944
  s_waitcnt lgkmcnt(7)
  v_mfma_f32_16x16x32_bf16 v[20:23], a[8:11], v[36:39], v[20:23]
  v_mfma_f32_16x16x32_bf16 v[24:27], a[12:15], v[36:39], v[24:27]
  ds_read_b128 v[36:39], v1 offset:19008
  s_waitcnt lgkmcnt(7)
  v_mfma_f32_16x16x32_bf16 v[20:23], a[16:19], v[40:43], v[20:23]
  v_mfma_f32_16x16x32_bf16 v[24:27], a[20:23], v[40:43], v[24:27]
  ds_read_b128 v[40:43], v1 offset:19072
  s_waitcnt lgkmcnt(7)
  v_mfma_f32_16x16x32_bf16 v[20:23], a[24:27], v[44:47], v[20:23]
  v_mfma_f32_16x16x32_bf16 v[24:27], a[28:31], v[44:47], v[24:27]
  ds_read_b128 v[44:47], v1 offset:19136
  s_waitcnt lgkmcnt(7)
  v_mfma_f32_16x16x32_bf16 v[20:23], a[32:35], v[48:51], v[20:23]
  v_mfma_f32_16x16x32_bf16 v[24:27], a[36:39], v[48:51], v[24:27]
  ds_read_b128 v[48:51], v1 offset:19200
  s_waitcnt lgkmcnt(7)
  v_mfma_f32_16x16x32_bf16 v[20:23], a[40:43], v[52:55], v[20:23]
  v_mfma_f32_16x16x32_bf16 v[24:27], a[44:47], v[52:55], v[24:27]
  ds_read_b128 v[52:55], v1 offset:19264
  s_waitcnt lgkmcnt(7)
  v_mfma_f32_16x16x32_bf16 v[20:23], a[48:51], v[56:59], v[20:23]
  v_mfma_f32_16x16x32_bf16 v[24:27], a[52:55], v[56:59], v[24:27]
  ds_read_b128 v[56:59], v1 offset:19328
  s_waitcnt lgkmcnt(7)
  v_mfma_f32_16x16x32_bf16 v[20:23], a[56:59], v[60:63], v[20:23]
  v_mfma_f32_16x16x32_bf16 v[24:27], a[60:63], v[60:63], v[24:27]
  ds_read_b128 v[60:63], v1 offset:19392
  s_waitcnt lgkmcnt(7)
  v_mfma_f32_16x16x32_bf16 v[20:23], a[64:67], v[32:35], v[20:23]
  v_mfma_f32_16x16x32_bf16 v[24:27], a[68:71], v[32:35], v[24:27]
  s_waitcnt lgkmcnt(6)
  v_mfma_f32_16x16x32_bf16 v[20:23], a[72:75], v[36:39], v[20:23]
  v_mfma_f32_16x16x32_bf16 v[24:27], a[76:79], v[36:39], v[24:27]
  s_waitcnt lgkmcnt(5)
  v_mfma_f32_16x16x32_bf16 v[20:23], a[80:83], v[40:43], v[20:23]
  v_mfma_f32_16x16x32_bf16 v[24:27], a[84:87], v[40:43], v[24:27]
  s_waitcnt lgkmcnt(4)
  v_mfma_f32_16x16x32_bf16 v[20:23], a[88:91], v[44:47], v[20:23]
  v_mfma_f32_16x16x32_bf16 v[24:27], a[92:95], v[44:47], v[24:27]
  s_waitcnt lgkmcnt(3)
  v_mfma_f32_16x16x32_bf16 v[20:23], a[96:99], v[48:51], v[20:23]
  v_mfma_f32_16x16x32_bf16 v[24:27], a[100:103], v[48:51], v[24:27]
  s_waitcnt lgkmcnt(2)
  v_mfma_f32_16x16x32_bf16 v[20:23], a[104:107], v[52:55], v[20:23]
  v_mfma_f32_16x16x32_bf16 v[24:27], a[108:111], v[52:55], v[24:27]
  s_waitcnt lgkmcnt(1)
  v_mfma_f32_16x16x32_bf16 v[20:23], a[112:115], v[56:59], v[20:23]
  v_mfma_f32_16x16x32_bf16 v[24:27], a[116:119], v[56:59], v[24:27]
  s_waitcnt lgkmcnt(0)
  v_mfma_f32_16x16x32_bf16 v[20:23], a[120:123], v[60:63], v[20:23]
  v_mfma_f32_16x16x32_bf16 v[24:27], a[124:127], v[60:63], v[24:27]
  s_nop 6
  v_cvt_pk_bf16_f32 v20, v20, v21
  v_cvt_pk_bf16_f32 v21, v22, v23
  v_cvt_pk_bf16_f32 v24, v24, v25
  v_cvt_pk_bf16_f32 v25, v26, v27
  v_min_u32 v20, -2, v20
  v_min_u32 v21, -2, v21
  v_min_u32 v24, -2, v24
  v_min_u32 v25, -2, v25
  s_mov_b32 exec_lo, 0x00ff00ff
  s_mov_b32 exec_hi, 0x00ff00ff
  buffer_store_dwordx2 v[20:21], v7, s[20:23], s36 offen offset:0 sc1
  buffer_store_dwordx2 v[24:25], v7, s[20:23], s36 offen offset:32 sc1
  s_mov_b64 exec, -1
  s_add_u32 s36, s36, 65536
  s_lshl_b32 s58, s2, 8
  s_lshl_b32 s59, s92, 14
  s_add_u32 s58, s58, s59
  s_add_u32 s58, s58, 6029312
  s_and_b32 s66, s91, 1
  s_lshl_b32 s59, s66, 13
  s_add_u32 s58, s58, s59
  s_xor_b32 s59, s58, 8192
  s_waitcnt vmcnt(0)
  s_barrier
  s_mov_b64 exec, 1
  s_memtime s[72:73]
  s_waitcnt lgkmcnt(0)
  buffer_load_dword v30, off, s[20:23], s59 nt
  s_waitcnt vmcnt(0)
  s_memtime s[62:63]
  s_waitcnt lgkmcnt(0)
  s_sub_u32 s72, s72, s62
  s_barrier
  s_memtime s[62:63]
  s_waitcnt lgkmcnt(0)
  buffer_load_dword v30, off, s[20:23], s58 nt
  s_waitcnt vmcnt(0)
  s_memtime s[64:65]
  s_waitcnt lgkmcnt(0)
  s_add_u32 s72, s72, s64
  s_sub_u32 s72, s72, s62
  s_bfe_u32 s59, s93, 0x10008
  s_xor_b32 s59, s59, s66
  s_sub_u32 s73, 0, s72
  s_cmp_lg_u32 s59, 0
  s_cselect_b32 s72, s73, s72
  v_mov_b32 v30, s72
  v_mov_b32 v31, 0
  ds_add_u32 v31, v30 offset:27008
  s_waitcnt lgkmcnt(0)
  s_barrier
  ds_read_b32 v30, v31 offset:27008
  s_waitcnt lgkmcnt(0)
  s_lshl_b32 s58, s2, 2
  s_cmp_lg_u32 s92, 0
  s_cbranch_scc1 Lvst_61
  buffer_store_dword v30, off, s[24:27], s58 offset:128 sc1
Lvst_61:
  s_mov_b64 exec, -1
  s_add_u32 m0, s60, 32768
  v_add_u32 v67, 131072, v65
  buffer_load_dwordx4 v67, s[40:43], 0 offen nt lds
  s_add_u32 m0, s60, 33792
  v_add_u32 v67, 135168, v65
  buffer_load_dwordx4 v67, s[40:43], 0 offen nt lds
  s_add_u32 m0, s60, 34816
  v_add_u32 v67, 139264, v66
  buffer_load_dwordx4 v67, s[40:43], 0 offen nt lds
  s_add_u32 m0, s60, 35840
  v_add_u32 v67, 143360, v66
  buffer_load_dwordx4 v67, s[40:43], 0 offen nt lds
  s_add_u32 m0, s60, 36864
  v_add_u32 v67, 147456, v65
  buffer_load_dwordx4 v67, s[40:43], 0 offen nt lds
  s_add_u32 m0, s60, 37888
  v_add_u32 v67, 151552, v65
  buffer_load_dwordx4 v67, s[40:43], 0 offen nt lds
  s_add_u32 m0, s60, 38912
  v_add_u32 v67, 155648, v66
  buffer_load_dwordx4 v67, s[40:43], 0 offen nt lds
  s_add_u32 m0, s60, 39936
  v_add_u32 v67, 159744, v66
  buffer_load_dwordx4 v67, s[40:43], 0 offen nt lds
  s_barrier
  s_add_u32 m0, s60, 65536
  v_add_u32 v67, 262144, v65
  buffer_load_dwordx4 v67, s[40:43], 0 offen nt lds
  s_add_u32 m0, s60, 66560
  v_add_u32 v67, 266240, v65
  buffer_load_dwordx4 v67, s[40:43], 0 offen nt lds
  s_add_u32 m0, s60, 67584
  v_add_u32 v67, 270336, v66
  buffer_load_dwordx4 v67, s[40:43], 0 offen nt lds
  s_add_u32 m0, s60, 68608
  v_add_u32 v67, 274432, v66
  buffer_load_dwordx4 v67, s[40:43], 0 offen nt lds
  s_add_u32 m0, s60, 69632
  v_add_u32 v67, 278528, v65
  buffer_load_dwordx4 v67, s[40:43], 0 offen nt lds
  s_add_u32 m0, s60, 70656
  v_add_u32 v67, 282624, v65
  buffer_load_dwordx4 v67, s[40:43], 0 offen nt lds
  s_add_u32 m0, s60, 71680
  v_add_u32 v67, 286720, v66
  buffer_load_dwordx4 v67, s[40:43], 0 offen nt lds
  s_add_u32 m0, s60, 72704
  v_add_u32 v67, 290816, v66
  buffer_load_dwordx4 v67, s[40:43], 0 offen nt lds
  v_add_u32 v71, 32768, v68
  v_add_u32 v72, 32768, v69
  ds_read_b64_tr_b16 a[128:129], v71 offset:0
  ds_read_b64_tr_b16 a[130:131], v71 offset:1024
  ds_read_b64_tr_b16 a[132:133], v72 offset:0
  ds_read_b64_tr_b16 a[134:135], v72 offset:1024
  ds_read_b64_tr_b16 a[136:137], v71 offset:8192
  ds_read_b64_tr_b16 a[138:139], v71 offset:9216
  ds_read_b64_tr_b16 a[140:141], v72 offset:8192
  ds_read_b64_tr_b16 a[142:143], v72 offset:9216
  ds_read_b64_tr_b16 a[144:145], v71 offset:16384
  ds_read_b64_tr_b16 a[146:147], v71 offset:17408
  ds_read_b64_tr_b16 a[148:149], v72 offset:16384
  ds_read_b64_tr_b16 a[150:151], v72 offset:17408
  s_waitcnt lgkmcnt(4)
  ds_read_b64_tr_b16 a[152:153], v71 offset:24576
  ds_read_b64_tr_b16 a[154:155], v71 offset:25600
  ds_read_b64_tr_b16 a[156:157], v72 offset:24576
  ds_read_b64_tr_b16 a[158:159], v72 offset:25600
  s_waitcnt lgkmcnt(0)
  s_waitcnt vmcnt(8)
  s_barrier
  s_add_u32 m0, s60, 98304
  v_add_u32 v67, 393216, v65
  buffer_load_dwordx4 v67, s[40:43], 0 offen nt lds
  s_add_u32 m0, s60, 99328
  v_add_u32 v67, 397312, v65
  buffer_load_dwordx4 v67, s[40:43], 0 offen nt lds
  s_add_u32 m0, s60, 100352
  v_add_u32 v67, 401408, v66
  buffer_load_dwordx4 v67, s[40:43], 0 offen nt lds
  s_add_u32 m0, s60, 101376
  v_add_u32 v67, 405504, v66
  buffer_load_dwordx4 v67, s[40:43], 0 offen nt lds
  s_add_u32 m0, s60, 102400
  v_add_u32 v67, 409600, v65
  buffer_load_dwordx4 v67, s[40:43], 0 offen nt lds
  s_add_u32 m0, s60, 103424
  v_add_u32 v67, 413696, v65
  buffer_load_dwordx4 v67, s[40:43], 0 offen nt lds
  s_add_u32 m0, s60, 104448
  v_add_u32 v67, 417792, v66
  buffer_load_dwordx4 v67, s[40:43], 0 offen nt lds
  s_add_u32 m0, s60, 105472
  v_add_u32 v67, 421888, v66
  buffer_load_dwordx4 v67, s[40:43], 0 offen nt lds
  v_bfe_u32 v30, v0, 3, 1
  v_and_b32 v31, 4, v0
  v_cmp_eq_u32 vcc, 0, v31
  s_nop 1
  v_cndmask_b32 v30, 2, v30, vcc
  v_mul_u32_u24 v1, 1056, v30
  v_lshl_add_u32 v1, v14, 4, v1
  v_mov_b32 v30, 0
  s_lshl_b32 s58, s92, 8
  v_lshl_add_u32 v31, v0, 2, s58
  ds_write_b32 v31, v30 offset:19488
  v_mov_b32 v30, 0x3f803f80
  ds_write_b32 v31, v30 offset:22656
  v_add_u32 v71, 65536, v68
  v_add_u32 v72, 65536, v69
  ds_read_b64_tr_b16 a[160:161], v71 offset:0
  ds_read_b64_tr_b16 a[162:163], v71 offset:1024
  ds_read_b64_tr_b16 a[164:165], v72 offset:0
  ds_read_b64_tr_b16 a[166:167], v72 offset:1024
  ds_read_b64_tr_b16 a[168:169], v71 offset:8192
  ds_read_b64_tr_b16 a[170:171], v71 offset:9216
  ds_read_b64_tr_b16 a[172:173], v72 offset:8192
  ds_read_b64_tr_b16 a[174:175], v72 offset:9216
  ds_read_b64_tr_b16 a[176:177], v71 offset:16384
  ds_read_b64_tr_b16 a[178:179], v71 offset:17408
  ds_read_b64_tr_b16 a[180:181], v72 offset:16384
  ds_read_b64_tr_b16 a[182:183], v72 offset:17408
  s_waitcnt lgkmcnt(4)
  ds_read_b64_tr_b16 a[184:185], v71 offset:24576
  ds_read_b64_tr_b16 a[186:187], v71 offset:25600
  ds_read_b64_tr_b16 a[188:189], v72 offset:24576
  ds_read_b64_tr_b16 a[190:191], v72 offset:25600
  s_waitcnt lgkmcnt(0)
  s_waitcnt vmcnt(8)
  s_barrier
  s_add_u32 m0, s60, 0
  v_add_u32 v67, 0, v70
  buffer_load_dwordx4 v67, s[8:11], 0 offen lds
  s_add_u32 m0, s60, 1024
  v_add_u32 v67, 88064, v70
  buffer_load_dwordx4 v67, s[8:11], 0 offen lds
  s_add_u32 m0, s60, 2048
  v_add_u32 v67, 176128, v70
  buffer_load_dwordx4 v67, s[8:11], 0 offen lds
  s_add_u32 m0, s60, 3072
  v_add_u32 v67, 264192, v70
  buffer_load_dwordx4 v67, s[8:11], 0 offen lds
  s_add_u32 m0, s60, 4096
  v_add_u32 v67, 352256, v70
  buffer_load_dwordx4 v67, s[8:11], 0 offen lds
  s_add_u32 m0, s60, 5120
  v_add_u32 v67, 440320, v70
  buffer_load_dwordx4 v67, s[8:11], 0 offen lds
  s_add_u32 m0, s60, 6144
  v_add_u32 v67, 528384, v70
  buffer_load_dwordx4 v67, s[8:11], 0 offen lds
  s_add_u32 m0, s60, 7168
  v_add_u32 v67, 616448, v70
  buffer_load_dwordx4 v67, s[8:11], 0 offen lds
  v_add_u32 v71, 98304, v68
  v_add_u32 v72, 98304, v69
  ds_read_b64_tr_b16 a[192:193], v71 offset:0
  ds_read_b64_tr_b16 a[194:195], v71 offset:1024
  ds_read_b64_tr_b16 a[196:197], v72 offset:0
  ds_read_b64_tr_b16 a[198:199], v72 offset:1024
  ds_read_b64_tr_b16 a[200:201], v71 offset:8192
  ds_read_b64_tr_b16 a[202:203], v71 offset:9216
  ds_read_b64_tr_b16 a[204:205], v72 offset:8192
  ds_read_b64_tr_b16 a[206:207], v72 offset:9216
  ds_read_b64_tr_b16 a[208:209], v71 offset:16384
  ds_read_b64_tr_b16 a[210:211], v71 offset:17408
  ds_read_b64_tr_b16 a[212:213], v72 offset:16384
  ds_read_b64_tr_b16 a[214:215], v72 offset:17408
  s_waitcnt lgkmcnt(4)
  ds_read_b64_tr_b16 a[216:217], v71 offset:24576
  ds_read_b64_tr_b16 a[218:219], v71 offset:25600
  ds_read_b64_tr_b16 a[220:221], v72 offset:24576
  ds_read_b64_tr_b16 a[222:223], v72 offset:25600
  s_waitcnt lgkmcnt(0)
  s_waitcnt vmcnt(8)
  s_barrier
  s_add_u32 m0, s60, 32768
  v_add_u32 v67, 704512, v70
  buffer_load_dwordx4 v67, s[8:11], 0 offen lds
  s_add_u32 m0, s60, 33792
  v_add_u32 v67, 792576, v70
  buffer_load_dwordx4 v67, s[8:11], 0 offen lds
  s_add_u32 m0, s60, 34816
  v_add_u32 v67, 880640, v70
  buffer_load_dwordx4 v67, s[8:11], 0 offen lds
  s_add_u32 m0, s60, 35840
  v_add_u32 v67, 968704, v70
  buffer_load_dwordx4 v67, s[8:11], 0 offen lds
  s_add_u32 m0, s60, 36864
  v_add_u32 v67, 1056768, v70
  buffer_load_dwordx4 v67, s[8:11], 0 offen lds
  s_add_u32 m0, s60, 37888
  v_add_u32 v67, 1144832, v70
  buffer_load_dwordx4 v67, s[8:11], 0 offen lds
  s_add_u32 m0, s60, 38912
  v_add_u32 v67, 1232896, v70
  buffer_load_dwordx4 v67, s[8:11], 0 offen lds
  s_add_u32 m0, s60, 39936
  v_add_u32 v67, 1320960, v70
  buffer_load_dwordx4 v67, s[8:11], 0 offen lds
  v_add_u32 v71, 131072, v68
  v_add_u32 v72, 131072, v69
  ds_read_b64_tr_b16 a[224:225], v71 offset:0
  ds_read_b64_tr_b16 a[226:227], v71 offset:1024
  ds_read_b64_tr_b16 a[228:229], v72 offset:0
  ds_read_b64_tr_b16 a[230:231], v72 offset:1024
  ds_read_b64_tr_b16 a[232:233], v71 offset:8192
  ds_read_b64_tr_b16 a[234:235], v71 offset:9216
  ds_read_b64_tr_b16 a[236:237], v72 offset:8192
  ds_read_b64_tr_b16 a[238:239], v72 offset:9216
  ds_read_b64_tr_b16 a[240:241], v71 offset:16384
  ds_read_b64_tr_b16 a[242:243], v71 offset:17408
  ds_read_b64_tr_b16 a[244:245], v72 offset:16384
  ds_read_b64_tr_b16 a[246:247], v72 offset:17408
  s_waitcnt lgkmcnt(4)
  ds_read_b64_tr_b16 a[248:249], v71 offset:24576
  ds_read_b64_tr_b16 a[250:251], v71 offset:25600
  ds_read_b64_tr_b16 a[252:253], v72 offset:24576
  ds_read_b64_tr_b16 a[254:255], v72 offset:25600
  s_waitcnt lgkmcnt(0)
  s_waitcnt vmcnt(8)
  s_barrier
  s_add_u32 m0, s60, 65536
  v_add_u32 v67, 0, v70
  buffer_load_dwordx4 v67, s[12:15], 0 offen lds
  s_add_u32 m0, s60, 66560
  v_add_u32 v67, 88064, v70
  buffer_load_dwordx4 v67, s[12:15], 0 offen lds
  s_add_u32 m0, s60, 67584
  v_add_u32 v67, 176128, v70
  buffer_load_dwordx4 v67, s[12:15], 0 offen lds
  s_add_u32 m0, s60, 68608
  v_add_u32 v67, 264192, v70
  buffer_load_dwordx4 v67, s[12:15], 0 offen lds
  s_add_u32 m0, s60, 69632
  v_add_u32 v67, 352256, v70
  buffer_load_dwordx4 v67, s[12:15], 0 offen lds
  s_add_u32 m0, s60, 70656
  v_add_u32 v67, 440320, v70
  buffer_load_dwordx4 v67, s[12:15], 0 offen lds
  s_add_u32 m0, s60, 71680
  v_add_u32 v67, 528384, v70
  buffer_load_dwordx4 v67, s[12:15], 0 offen lds
  s_add_u32 m0, s60, 72704
  v_add_u32 v67, 616448, v70
  buffer_load_dwordx4 v67, s[12:15], 0 offen lds
  v_add_u32 v71, s60, v3
  v_add_u32 v71, 0, v71
  ds_read_b64_tr_b16 v[80:81], v71 offset:0
  ds_read_b64_tr_b16 v[82:83], v71 offset:512
  ds_read_b64_tr_b16 v[84:85], v71 offset:1024
  ds_read_b64_tr_b16 v[86:87], v71 offset:1536
  ds_read_b64_tr_b16 v[88:89], v71 offset:2048
  ds_read_b64_tr_b16 v[90:91], v71 offset:2560
  ds_read_b64_tr_b16 v[92:93], v71 offset:3072
  ds_read_b64_tr_b16 v[94:95], v71 offset:3584
  ds_read_b64_tr_b16 v[96:97], v71 offset:4096
  ds_read_b64_tr_b16 v[98:99], v71 offset:4608
  ds_read_b64_tr_b16 v[100:101], v71 offset:5120
  ds_read_b64_tr_b16 v[102:103], v71 offset:5632
  s_waitcnt lgkmcnt(4)
  ds_read_b64_tr_b16 v[104:105], v71 offset:6144
  ds_read_b64_tr_b16 v[106:107], v71 offset:6656
  ds_read_b64_tr_b16 v[108:109], v71 offset:7168
  ds_read_b64_tr_b16 v[110:111], v71 offset:7680
  s_waitcnt lgkmcnt(0)
  s_waitcnt vmcnt(8)
  s_barrier
  s_add_u32 m0, s60, 98304
  v_add_u32 v67, 704512, v70
  buffer_load_dwordx4 v67, s[12:15], 0 offen lds
  s_add_u32 m0, s60, 99328
  v_add_u32 v67, 792576, v70
  buffer_load_dwordx4 v67, s[12:15], 0 offen lds
  s_add_u32 m0, s60, 100352
  v_add_u32 v67, 880640, v70
  buffer_load_dwordx4 v67, s[12:15], 0 offen lds
  s_add_u32 m0, s60, 101376
  v_add_u32 v67, 968704, v70
  buffer_load_dwordx4 v67, s[12:15], 0 offen lds
  s_add_u32 m0, s60, 102400
  v_add_u32 v67, 1056768, v70
  buffer_load_dwordx4 v67, s[12:15], 0 offen lds
  s_add_u32 m0, s60, 103424
  v_add_u32 v67, 1144832, v70
  buffer_load_dwordx4 v67, s[12:15], 0 offen lds
  s_add_u32 m0, s60, 104448
  v_add_u32 v67, 1232896, v70
  buffer_load_dwordx4 v67, s[12:15], 0 offen lds
  s_add_u32 m0, s60, 105472
  v_add_u32 v67, 1320960, v70
  buffer_load_dwordx4 v67, s[12:15], 0 offen lds
  v_add_u32 v71, s60, v3
  v_add_u32 v71, 32768, v71
  ds_read_b64_tr_b16 v[112:113], v71 offset:0
  ds_read_b64_tr_b16 v[114:115], v71 offset:512
  ds_read_b64_tr_b16 v[116:117], v71 offset:1024
  ds_read_b64_tr_b16 v[118:119], v71 offset:1536
  ds_read_b64_tr_b16 v[120:121], v71 offset:2048
  ds_read_b64_tr_b16 v[122:123], v71 offset:2560
  ds_read_b64_tr_b16 v[124:125], v71 offset:3072
  ds_read_b64_tr_b16 v[126:127], v71 offset:3584
  ds_read_b64_tr_b16 v[128:129], v71 offset:4096
  ds_read_b64_tr_b16 v[130:131], v71 offset:4608
  ds_read_b64_tr_b16 v[132:133], v71 offset:5120
  ds_read_b64_tr_b16 v[134:135], v71 offset:5632
  s_waitcnt lgkmcnt(4)
  ds_read_b64_tr_b16 v[136:137], v71 offset:6144
  ds_read_b64_tr_b16 v[138:139], v71 offset:6656
  ds_read_b64_tr_b16 v[140:141], v71 offset:7168
  ds_read_b64_tr_b16 v[142:143], v71 offset:7680
  s_waitcnt lgkmcnt(0)
  s_waitcnt vmcnt(8)
  s_barrier
  s_mul_i32 s59, s90, 196608
  s_lshl_b32 s61, s91, 8
  s_add_u32 s59, s59, s61
  s_mul_i32 s58, s92, 32768
  s_add_u32 s58, s58, s59
  v_lshl_add_u32 v65, v14, 10, v64
  v_xor_b32 v66, 128, v65
  v_add_u32 v65, s58, v65
  v_add_u32 v66, s58, v66
  s_add_u32 m0, s60, 0
  v_add_u32 v67, 0, v65
  buffer_load_dwordx4 v67, s[44:47], 0 offen nt lds
  s_add_u32 m0, s60, 1024
  v_add_u32 v67, 4096, v65
  buffer_load_dwordx4 v67, s[44:47], 0 offen nt lds
  s_add_u32 m0, s60, 2048
  v_add_u32 v67, 8192, v66
  buffer_load_dwordx4 v67, s[44:47], 0 offen nt lds
  s_add_u32 m0, s60, 3072
  v_add_u32 v67, 12288, v66
  buffer_load_dwordx4 v67, s[44:47], 0 offen nt lds
  s_add_u32 m0, s60, 4096
  v_add_u32 v67, 16384, v65
  buffer_load_dwordx4 v67, s[44:47], 0 offen nt lds
  s_add_u32 m0, s60, 5120
  v_add_u32 v67, 20480, v65
  buffer_load_dwordx4 v67, s[44:47], 0 offen nt lds
  s_add_u32 m0, s60, 6144
  v_add_u32 v67, 24576, v66
  buffer_load_dwordx4 v67, s[44:47], 0 offen nt lds
  s_add_u32 m0, s60, 7168
  v_add_u32 v67, 28672, v66
  buffer_load_dwordx4 v67, s[44:47], 0 offen nt lds
  v_add_u32 v71, s60, v3
  v_add_u32 v71, 65536, v71
  ds_read_b64_tr_b16 v[144:145], v71 offset:0
  ds_read_b64_tr_b16 v[146:147], v71 offset:512
  ds_read_b64_tr_b16 v[148:149], v71 offset:1024
  ds_read_b64_tr_b16 v[150:151], v71 offset:1536
  ds_read_b64_tr_b16 v[152:153], v71 offset:2048
  ds_read_b64_tr_b16 v[154:155], v71 offset:2560
  ds_read_b64_tr_b16 v[156:157], v71 offset:3072
  ds_read_b64_tr_b16 v[158:159], v71 offset:3584
  ds_read_b64_tr_b16 v[160:161], v71 offset:4096
  ds_read_b64_tr_b16 v[162:163], v71 offset:4608
  ds_read_b64_tr_b16 v[164:165], v71 offset:5120
  ds_read_b64_tr_b16 v[166:167], v71 offset:5632
  s_waitcnt lgkmcnt(4)
  ds_read_b64_tr_b16 v[168:169], v71 offset:6144
  ds_read_b64_tr_b16 v[170:171], v71 offset:6656
  ds_read_b64_tr_b16 v[172:173], v71 offset:7168
  ds_read_b64_tr_b16 v[174:175], v71 offset:7680
  s_waitcnt lgkmcnt(0)
  s_waitcnt vmcnt(8)
  s_barrier
  s_mul_i32 s58, s92, 16384
  s_add_u32 s58, s58, s59
  v_lshl_add_u32 v65, v14, 10, v64
  v_xor_b32 v66, 128, v65
  v_add_u32 v65, s58, v65
  v_add_u32 v66, s58, v66
  s_lshl_b32 s61, s92, 12
  s_add_u32 m0, s61, 65536
  v_add_u32 v67, 131072, v65
  buffer_load_dwordx4 v67, s[44:47], 0 offen nt lds
  s_add_u32 m0, s61, 66560
  v_add_u32 v67, 135168, v65
  buffer_load_dwordx4 v67, s[44:47], 0 offen nt lds
  s_add_u32 m0, s61, 67584
  v_add_u32 v67, 139264, v66
  buffer_load_dwordx4 v67, s[44:47], 0 offen nt lds
  s_add_u32 m0, s61, 68608
  v_add_u32 v67, 143360, v66
  buffer_load_dwordx4 v67, s[44:47], 0 offen nt lds
  v_add_u32 v71, s60, v3
  v_add_u32 v71, 98304, v71
  ds_read_b64_tr_b16 v[176:177], v71 offset:0
  ds_read_b64_tr_b16 v[178:179], v71 offset:512
  ds_read_b64_tr_b16 v[180:181], v71 offset:1024
  ds_read_b64_tr_b16 v[182:183], v71 offset:1536
  ds_read_b64_tr_b16 v[184:185], v71 offset:2048
  ds_read_b64_tr_b16 v[186:187], v71 offset:2560
  ds_read_b64_tr_b16 v[188:189], v71 offset:3072
  ds_read_b64_tr_b16 v[190:191], v71 offset:3584
  ds_read_b64_tr_b16 v[192:193], v71 offset:4096
  ds_read_b64_tr_b16 v[194:195], v71 offset:4608
  ds_read_b64_tr_b16 v[196:197], v71 offset:5120
  ds_read_b64_tr_b16 v[198:199], v71 offset:5632
  s_waitcnt lgkmcnt(4)
  ds_read_b64_tr_b16 v[200:201], v71 offset:6144
  ds_read_b64_tr_b16 v[202:203], v71 offset:6656
  ds_read_b64_tr_b16 v[204:205], v71 offset:7168
  ds_read_b64_tr_b16 v[206:207], v71 offset:7680
  s_waitcnt lgkmcnt(0)
  s_waitcnt vmcnt(4)
  s_barrier
  v_add_u32 v71, 32768, v68
  v_add_u32 v72, 32768, v69
  ds_read_b64_tr_b16 v[208:209], v71 offset:0
  ds_read_b64_tr_b16 v[210:211], v71 offset:1024
  ds_read_b64_tr_b16 v[212:213], v72 offset:0
  ds_read_b64_tr_b16 v[214:215], v72 offset:1024
  ds_read_b64_tr_b16 v[216:217], v71 offset:8192
  ds_read_b64_tr_b16 v[218:219], v71 offset:9216
  ds_read_b64_tr_b16 v[220:221], v72 offset:8192
  ds_read_b64_tr_b16 v[222:223], v72 offset:9216
  ds_read_b64_tr_b16 v[224:225], v71 offset:16384
  ds_read_b64_tr_b16 v[226:227], v71 offset:17408
  ds_read_b64_tr_b16 v[228:229], v72 offset:16384
  ds_read_b64_tr_b16 v[230:231], v72 offset:17408
  s_waitcnt lgkmcnt(4)
  ds_read_b64_tr_b16 v[232:233], v71 offset:24576
  ds_read_b64_tr_b16 v[234:235], v71 offset:25600
  ds_read_b64_tr_b16 v[236:237], v72 offset:24576
  ds_read_b64_tr_b16 v[238:239], v72 offset:25600
  s_waitcnt lgkmcnt(0)
  s_waitcnt vmcnt(0)
  s_barrier
  v_add_u32 v71, 65536, v68
  v_add_u32 v72, 65536, v69
  ds_read_b64_tr_b16 v[240:241], v71 offset:0
  ds_read_b64_tr_b16 v[242:243], v71 offset:1024
  ds_read_b64_tr_b16 v[244:245], v72 offset:0
  ds_read_b64_tr_b16 v[246:247], v72 offset:1024
  ds_read_b64_tr_b16 v[248:249], v71 offset:8192
  ds_read_b64_tr_b16 v[250:251], v71 offset:9216
  ds_read_b64_tr_b16 v[252:253], v72 offset:8192
  ds_read_b64_tr_b16 v[254:255], v72 offset:9216
  s_waitcnt lgkmcnt(0)
  v_and_b32 v30, 7, v0
  v_lshlrev_b32 v30, 4, v30
Lcfl_62:
  s_sub_u32 s33, s33, 1
  s_cbranch_scc1 Lend
  buffer_load_dword v31, v30, s[24:27], 0 offen sc1
  s_waitcnt vmcnt(0)
  v_and_b32 v32, 63, v31
  v_cmp_ne_u32 vcc, 32, v32
  s_cbranch_vccnz Lcfl_62
  v_readlane_b32 s58, v31, s90
  s_lshl_b32 s59, s93, 5
  s_cmp_eq_u32 s58, s59
  s_cselect_b32 s32, 1, 0
  s_mov_b32 s28, 0
  s_lshl_b32 s58, s90, 2
  s_add_u32 s58, s58, s92
  s_lshl_b32 s29, s58, 12
  s_add_u32 s30, s29, 786432
  s_lshl_b32 s34, s92, 14
  s_add_u32 s34, s34, 4194304
  s_mov_b32 s39, 0
  v_lshlrev_b32 v30, 2, v0
  buffer_load_dword v32, v30, s[24:27], 0 offen offset:128 sc1
  s_waitcnt vmcnt(0)
  v_add_u32_dpp v32, v32, v32 quad_perm:[1,0,3,2] row_mask:0xf bank_mask:0xf
  s_nop 1
  v_add_u32_dpp v32, v32, v32 quad_perm:[2,3,0,1] row_mask:0xf bank_mask:0xf
  s_nop 1
  v_add_u32_dpp v32, v32, v32 row_half_mirror row_mask:0xf bank_mask:0xf
  s_nop 1
  v_add_u32_dpp v32, v32, v32 row_mirror row_mask:0xf bank_mask:0xf
  s_nop 0
  v_readlane_b32 s58, v32, 0
  v_readlane_b32 s59, v32, 16
  s_add_i32 s58, s58, s59
  s_cmp_gt_i32 s58, 0
  s_cselect_b32 s58, 1, 0
  s_bfe_u32 s59, s93, 0x10008
  s_xor_b32 s58, s58, s59
  s_lshl_b32 s39, s58, 13
  s_xor_b32 s72, s90, 0
  s_lshl_b32 s72, s72, 10
  s_xor_b32 s73, s90, 1
  s_lshl_b32 s73, s73, 10
  s_xor_b32 s74, s90, 2
  s_lshl_b32 s74, s74, 10
  s_xor_b32 s75, s90, 3
  s_lshl_b32 s75, s75, 10
  s_xor_b32 s76, s90, 4
  s_lshl_b32 s76, s76, 10
  s_xor_b32 s77, s90, 5
  s_lshl_b32 s77, s77, 10
  s_xor_b32 s78, s90, 6
  s_lshl_b32 s78, s78, 10
  s_xor_b32 s79, s90, 7
  s_lshl_b32 s79, s79, 10
  v_and_b32 v15, 7, v0
  v_cmp_eq_u32 vcc, 7, v15
  s_nop 1
  v_cndmask_b32 v15, 1.0, 0, vcc
  s_mov_b32 s84, 0x3f803f80
  s_mov_b32 s37, s2
  s_mov_b32 s38, 4294965248
Lstep:
  s_nop 7
  v_mov_b32 v64, -1
  v_mov_b32 v65, -1
  v_mov_b32 v66, -1
  v_mov_b32 v67, -1
  s_cmp_eq_u32 s32, 0
  s_cbranch_scc1 Lcpt_63
  s_cmp_eq_u32 s28, 8
  s_cselect_b32 exec_lo, 0, s54
  s_mov_b32 exec_hi, exec_lo
  buffer_store_dwordx2 v[64:65], v7, s[20:23], s36 offen offset:0
  buffer_store_dwordx2 v[64:65], v7, s[20:23], s36 offen offset:32
  s_cmp_eq_u32 s92, 3
  s_cselect_b32 exec_lo, 0, s52
  s_mov_b32 exec_hi, exec_lo
  buffer_store_dwordx2 v[64:65], v6, s[20:23], s35 offen
  s_mov_b64 exec, -1
  s_nop 1
Lcpt_63:
  s_cmp_lt_u32 s28, 2
  s_cbranch_scc1 Lnob_64
Lcb_66:
  s_sub_u32 s33, s33, 1
  s_cbranch_scc1 Lend
  buffer_load_dwordx2 v[32:33], v11, s[20:23], s30 offen sc1
  buffer_load_dwordx2 v[34:35], v3, s[20:23], s30 offen offset:0 sc1
  buffer_load_dwordx2 v[36:37], v3, s[20:23], s30 offen offset:512 sc1
  buffer_load_dwordx2 v[38:39], v3, s[20:23], s30 offen offset:1024 sc1
  buffer_load_dwordx2 v[40:41], v3, s[20:23], s30 offen offset:1536 sc1
  buffer_load_dwordx2 v[42:43], v3, s[20:23], s30 offen offset:2048 sc1
  buffer_load_dwordx2 v[44:45], v3, s[20:23], s30 offen offset:2560 sc1
  buffer_load_dwordx2 v[46:47], v3, s[20:23], s30 offen offset:3072 sc1
  s_waitcnt vmcnt(7)
  v_max_u32 v48, v32, v33
  v_cmp_eq_u32 vcc, -1, v48
  s_cbranch_vccnz Lcb_66
  v_min_f32_dpp v48, v32, v32 quad_perm:[1,0,3,2] row_mask:0xf bank_mask:0xf
  v_mul_f32 v33, v33, v15
  s_nop 0
  v_min_f32_dpp v48, v48, v48 quad_perm:[2,3,0,1] row_mask:0xf bank_mask:0xf
  s_nop 1
  v_min_f32_dpp v48, v48, v48 row_half_mirror row_mask:0xf bank_mask:0xf
  v_sub_f32 v49, v48, v32
  v_exp_f32 v49, v49
  s_nop 0
  v_mul_f32 v50, v49, v33
  s_waitcnt vmcnt(0)
  v_mul_f32_dpp v52, v49, v34 row_newbcast:0 row_mask:0xf bank_mask:0xf
  v_mul_f32_dpp v53, v49, v35 row_newbcast:0 row_mask:0xf bank_mask:0xf
  v_add_f32_dpp v50, v50, v50 quad_perm:[1,0,3,2] row_mask:0xf bank_mask:0xf
  v_mul_f32_dpp v54, v49, v36 row_newbcast:1 row_mask:0xf bank_mask:0xf
  v_mul_f32_dpp v55, v49, v37 row_newbcast:1 row_mask:0xf bank_mask:0xf
  v_add_f32_dpp v50, v50, v50 quad_perm:[2,3,0,1] row_mask:0xf bank_mask:0xf
  v_fmac_f32_dpp v52, v49, v38 row_newbcast:2 row_mask:0xf bank_mask:0xf
  v_fmac_f32_dpp v53, v49, v39 row_newbcast:2 row_mask:0xf bank_mask:0xf
  v_add_f32_dpp v50, v50, v50 row_half_mirror row_mask:0xf bank_mask:0xf
  v_fmac_f32_dpp v54, v49, v40 row_newbcast:3 row_mask:0xf bank_mask:0xf
  v_fmac_f32_dpp v55, v49, v41 row_newbcast:3 row_mask:0xf bank_mask:0xf
  v_rcp_f32 v50, v50
  v_fmac_f32_dpp v52, v49, v42 row_newbcast:4 row_mask:0xf bank_mask:0xf
  v_fmac_f32_dpp v53, v49, v43 row_newbcast:4 row_mask:0xf bank_mask:0xf
  v_fmac_f32_dpp v54, v49, v44 row_newbcast:5 row_mask:0xf bank_mask:0xf
  v_fmac_f32_dpp v55, v49, v45 row_newbcast:5 row_mask:0xf bank_mask:0xf
  v_fmac_f32_dpp v52, v49, v46 row_newbcast:6 row_mask:0xf bank_mask:0xf
  v_fmac_f32_dpp v53, v49, v47 row_newbcast:6 row_mask:0xf bank_mask:0xf
  v_add_f32 v52, v52, v54
  v_add_f32 v53, v53, v55
  v_mul_f32 v52, v52, v50
  v_mul_f32 v53, v53, v50
  v_cmp_u_f32 vcc, v52, v53
  v_cvt_pk_bf16_f32 v52, v52, v53
  s_cbranch_vccnz Lcbnan_68
Lcbok_67:
  ds_write_b16 v10, v52 offset:19488
  ds_write_b16_d16_hi v10, v52 offset:19504
  s_branch Lnovote_65
Lnob_64:
Lnovote_65:
  s_cmp_lg_u32 s28, 8
  s_cbranch_scc1 Lnofin_69
  s_add_u32 s29, s29, 917504
  s_mov_b32 exec_lo, -1
  s_mov_b32 exec_hi, 0
  v_add_u32 v8, 9216, v8
  s_mov_b64 exec, -1
Lnofin_69:
  ds_read_b64 v[28:29], v8 offset:0
  s_waitcnt lgkmcnt(0)
  v_lshlrev_b32 v16, 16, v28
  v_and_b32 v17, s95, v28
  v_lshlrev_b32 v18, 16, v29
  v_and_b32 v19, s95, v29
Lcb_70:
  s_sub_u32 s33, s33, 1
  s_cbranch_scc1 Lend
  buffer_load_dwordx2 v[32:33], v11, s[20:23], s29 offen sc1
  buffer_load_dwordx2 v[34:35], v3, s[20:23], s29 offen offset:0 sc1
  buffer_load_dwordx2 v[36:37], v3, s[20:23], s29 offen offset:512 sc1
  buffer_load_dwordx2 v[38:39], v3, s[20:23], s29 offen offset:1024 sc1
  buffer_load_dwordx2 v[40:41], v3, s[20:23], s29 offen offset:1536 sc1
  buffer_load_dwordx2 v[42:43], v3, s[20:23], s29 offen offset:2048 sc1
  buffer_load_dwordx2 v[44:45], v3, s[20:23], s29 offen offset:2560 sc1
  buffer_load_dwordx2 v[46:47], v3, s[20:23], s29 offen offset:3072 sc1
  s_waitcnt vmcnt(7)
  v_max_u32 v48, v32, v33
  v_cmp_eq_u32 vcc, -1, v48
  s_cbranch_vccnz Lcb_70
  v_min_f32_dpp v48, v32, v32 quad_perm:[1,0,3,2] row_mask:0xf bank_mask:0xf
  v_mul_f32 v33, v33, v15
  s_nop 0
  v_min_f32_dpp v48, v48, v48 quad_perm:[2,3,0,1] row_mask:0xf bank_mask:0xf
  s_nop 1
  v_min_f32_dpp v48, v48, v48 row_half_mirror row_mask:0xf bank_mask:0xf
  v_sub_f32 v49, v48, v32
  v_exp_f32 v49, v49
  s_nop 0
  v_mul_f32 v50, v49, v33
  s_waitcnt vmcnt(0)
  v_mul_f32_dpp v52, v49, v34 row_newbcast:0 row_mask:0xf bank_mask:0xf
  v_mul_f32_dpp v53, v49, v35 row_newbcast:0 row_mask:0xf bank_mask:0xf
  v_add_f32_dpp v50, v50, v50 quad_perm:[1,0,3,2] row_mask:0xf bank_mask:0xf
  v_mul_f32_dpp v54, v49, v36 row_newbcast:1 row_mask:0xf bank_mask:0xf
  v_mul_f32_dpp v55, v49, v37 row_newbcast:1 row_mask:0xf bank_mask:0xf
  v_add_f32_dpp v50, v50, v50 quad_perm:[2,3,0,1] row_mask:0xf bank_mask:0xf
  v_fmac_f32_dpp v52, v49, v38 row_newbcast:2 row_mask:0xf bank_mask:0xf
  v_fmac_f32_dpp v53, v49, v39 row_newbcast:2 row_mask:0xf bank_mask:0xf
  v_add_f32_dpp v50, v50, v50 row_half_mirror row_mask:0xf bank_mask:0xf
  v_fmac_f32_dpp v54, v49, v40 row_newbcast:3 row_mask:0xf bank_mask:0xf
  v_fmac_f32_dpp v55, v49, v41 row_newbcast:3 row_mask:0xf bank_mask:0xf
  v_rcp_f32 v50, v50
  v_fmac_f32_dpp v52, v49, v42 row_newbcast:4 row_mask:0xf bank_mask:0xf
  v_fmac_f32_dpp v53, v49, v43 row_newbcast:4 row_mask:0xf bank_mask:0xf
  v_fmac_f32_dpp v54, v49, v44 row_newbcast:5 row_mask:0xf bank_mask:0xf
  v_fmac_f32_dpp v55, v49, v45 row_newbcast:5 row_mask:0xf bank_mask:0xf
  v_fmac_f32_dpp v52, v49, v46 row_newbcast:6 row_mask:0xf bank_mask:0xf
  v_fmac_f32_dpp v53, v49, v47 row_newbcast:6 row_mask:0xf bank_mask:0xf
  v_add_f32 v52, v52, v54
  v_add_f32 v53, v53, v55
  v_mul_f32 v52, v52, v50
  v_mul_f32 v53, v53, v50
  v_cmp_u_f32 vcc, v52, v53
  v_cvt_pk_bf16_f32 v52, v52, v53
  s_cbranch_vccnz Lcbnan_72
Lcbok_71:
  ds_write_b16 v10, v52 offset:18432
  ds_write_b16_d16_hi v10, v52 offset:18448
  s_waitcnt lgkmcnt(0)
  s_barrier
  ds_read_b128 v[64:67], v1 offset:18432
  ds_read_b128 v[68:71], v1 offset:18496
  ds_read_b128 v[72:75], v1 offset:18560
  ds_read_b128 v[76:79], v1 offset:18624
  s_add_u32 s58, s34, 0
  s_add_u32 s58, s58, s39
  v_add_u32 v14, s58, v2
  s_waitcnt lgkmcnt(3)
  v_mfma_f32_16x16x32_bf16 v[20:23], a[128:131], v[64:67], 0
  v_mfma_f32_16x16x32_bf16 v[24:27], a[132:135], v[64:67], 0
  ds_read_b128 v[64:67], v1 offset:18688
  s_waitcnt lgkmcnt(3)
  v_mfma_f32_16x16x32_bf16 v[20:23], a[136:139], v[68:71], v[20:23]
  v_mfma_f32_16x16x32_bf16 v[24:27], a[140:143], v[68:71], v[24:27]
  ds_read_b128 v[68:71], v1 offset:18752
  s_waitcnt lgkmcnt(3)
  v_mfma_f32_16x16x32_bf16 v[20:23], a[144:147], v[72:75], v[20:23]
  v_mfma_f32_16x16x32_bf16 v[24:27], a[148:151], v[72:75], v[24:27]
  ds_read_b128 v[72:75], v1 offset:18816
  s_waitcnt lgkmcnt(3)
  v_mfma_f32_16x16x32_bf16 v[20:23], a[152:155], v[76:79], v[20:23]
  v_mfma_f32_16x16x32_bf16 v[24:27], a[156:159], v[76:79], v[24:27]
  ds_read_b128 v[76:79], v1 offset:18880
  s_waitcnt lgkmcnt(3)
  v_mfma_f32_16x16x32_bf16 v[20:23], a[160:163], v[64:67], v[20:23]
  v_mfma_f32_16x16x32_bf16 v[24:27], a[164:167], v[64:67], v[24:27]
  ds_read_b128 v[64:67], v1 offset:18944
  s_waitcnt lgkmcnt(3)
  v_mfma_f32_16x16x32_bf16 v[20:23], a[168:171], v[68:71], v[20:23]
  v_mfma_f32_16x16x32_bf16 v[24:27], a[172:175], v[68:71], v[24:27]
  ds_read_b128 v[68:71], v1 offset:19008
  s_waitcnt lgkmcnt(3)
  v_mfma_f32_16x16x32_bf16 v[20:23], a[176:179], v[72:75], v[20:23]
  v_mfma_f32_16x16x32_bf16 v[24:27], a[180:183], v[72:75], v[24:27]
  ds_read_b128 v[72:75], v1 offset:19072
  s_waitcnt lgkmcnt(3)
  v_mfma_f32_16x16x32_bf16 v[20:23], a[184:187], v[76:79], v[20:23]
  v_mfma_f32_16x16x32_bf16 v[24:27], a[188:191], v[76:79], v[24:27]
  ds_read_b128 v[76:79], v1 offset:19136
  s_waitcnt lgkmcnt(3)
  v_mfma_f32_16x16x32_bf16 v[20:23], a[192:195], v[64:67], v[20:23]
  v_mfma_f32_16x16x32_bf16 v[24:27], a[196:199], v[64:67], v[24:27]
  ds_read_b128 v[64:67], v1 offset:19200
  s_waitcnt lgkmcnt(3)
  v_mfma_f32_16x16x32_bf16 v[20:23], a[200:203], v[68:71], v[20:23]
  v_mfma_f32_16x16x32_bf16 v[24:27], a[204:207], v[68:71], v[24:27]
  ds_read_b128 v[68:71], v1 offset:19264
  s_waitcnt lgkmcnt(3)
  v_mfma_f32_16x16x32_bf16 v[20:23], a[208:211], v[72:75], v[20:23]
  v_mfma_f32_16x16x32_bf16 v[24:27], a[212:215], v[72:75], v[24:27]
  ds_read_b128 v[72:75], v1 offset:19328
  s_waitcnt lgkmcnt(3)
  v_mfma_f32_16x16x32_bf16 v[20:23], a[216:219], v[76:79], v[20:23]
  v_mfma_f32_16x16x32_bf16 v[24:27], a[220:223], v[76:79], v[24:27]
  ds_read_b128 v[76:79], v1 offset:19392
  s_waitcnt lgkmcnt(3)
  v_mfma_f32_16x16x32_bf16 v[20:23], a[224:227], v[64:67], v[20:23]
  v_mfma_f32_16x16x32_bf16 v[24:27], a[228:231], v[64:67], v[24:27]
  s_waitcnt lgkmcnt(2)
  v_mfma_f32_16x16x32_bf16 v[20:23], a[232:235], v[68:71], v[20:23]
  v_mfma_f32_16x16x32_bf16 v[24:27], a[236:239], v[68:71], v[24:27]
  s_waitcnt lgkmcnt(1)
  v_mfma_f32_16x16x32_bf16 v[20:23], a[240:243], v[72:75], v[20:23]
  v_mfma_f32_16x16x32_bf16 v[24:27], a[244:247], v[72:75], v[24:27]
  s_waitcnt lgkmcnt(0)
  v_mfma_f32_16x16x32_bf16 v[20:23], a[248:251], v[76:79], v[20:23]
  v_mfma_f32_16x16x32_bf16 v[24:27], a[252:255], v[76:79], v[24:27]
  s_add_u32 s58, s31, 0
  s_nop 6
  v_cndmask_b32 v20, v24, v20, s[88:89]
  v_cndmask_b32 v21, v25, v21, s[88:89]
  v_cndmask_b32 v22, v26, v22, s[88:89]
  v_cndmask_b32 v23, v27, v23, s[88:89]
  s_mov_b64 exec, s[80:81]
  buffer_store_dwordx4 v[20:23], v4, s[20:23], s58 offen sc1
  s_mov_b64 exec, -1
  s_sleep 7
  s_mov_b64 s[82:83], exec
  buffer_load_dwordx4 v[60:63], v14, s[20:23], s79 offen sc1
  buffer_load_dwordx4 v[56:59], v14, s[20:23], s78 offen sc1
  buffer_load_dwordx4 v[52:55], v14, s[20:23], s77 offen sc1
  buffer_load_dwordx4 v[48:51], v14, s[20:23], s76 offen sc1
  buffer_load_dwordx4 v[44:47], v14, s[20:23], s75 offen sc1
  buffer_load_dwordx4 v[40:43], v14, s[20:23], s74 offen sc1
  buffer_load_dwordx4 v[36:39], v14, s[20:23], s73 offen sc1
  buffer_load_dwordx4 v[32:35], v14, s[20:23], s72 offen sc1
  s_waitcnt vmcnt(6)
  v_add_f32 v76, v56, v60
  v_add_f32 v77, v57, v61
  v_add_f32 v78, v58, v62
  v_add_f32 v79, v59, v63
  s_waitcnt vmcnt(4)
  v_add_f32 v72, v48, v52
  v_add_f32 v73, v49, v53
  v_add_f32 v74, v50, v54
  v_add_f32 v75, v51, v55
  v_add_f32 v24, v72, v76
  v_add_f32 v25, v73, v77
  v_add_f32 v26, v74, v78
  v_add_f32 v27, v75, v79
  s_waitcnt vmcnt(2)
  v_add_f32 v68, v40, v44
  v_add_f32 v69, v41, v45
  v_add_f32 v70, v42, v46
  v_add_f32 v71, v43, v47
  s_waitcnt vmcnt(0)
  v_add_f32 v64, v32, v36
  v_add_f32 v65, v33, v37
  v_add_f32 v66, v34, v38
  v_add_f32 v67, v35, v39
Lhpt_75:
  v_add_f32 v20, v64, v68
  v_add_f32 v21, v65, v69
  v_add_f32 v22, v66, v70
  v_add_f32 v23, v67, v71
  v_add_f32 v20, v20, v24
  v_add_f32 v21, v21, v25
  v_add_f32 v22, v22, v26
  v_add_f32 v23, v23, v27
  v_cmp_u_f32 vcc, v20, v21
  v_cmp_u_f32 s[60:61], v22, v23
  s_or_b64 vcc, vcc, s[60:61]
  s_cbranch_vccnz Lhpf_76
Lhpok_74:
  v_cvt_pk_bf16_f32 v30, v20, v21
  v_cvt_pk_bf16_f32 v31, v22, v23
  v_lshlrev_b32 v20, 16, v30
  v_and_b32 v21, s95, v30
  v_lshlrev_b32 v22, 16, v31
  v_and_b32 v23, s95, v31
  v_add_f32 v16, v16, v20
  v_add_f32 v17, v17, v21
  v_add_f32 v18, v18, v22
  v_add_f32 v19, v19, v23
  v_cvt_pk_bf16_f32 v28, v16, v17
  v_cvt_pk_bf16_f32 v29, v18, v19
  ds_write_b64 v9, v[28:29] offset:20544
  v_dot2_f32_bf16 v16, v28, s84, 0
  v_dot2_f32_bf16 v17, v28, v28, 0
  v_dot2_f32_bf16 v16, v29, s84, v16
  v_dot2_f32_bf16 v17, v29, v29, v17
  s_nop 1
  v_add_f32_dpp v16, v16, v16 quad_perm:[1,0,3,2] row_mask:0xf bank_mask:0xf
  v_add_f32_dpp v17, v17, v17 quad_perm:[1,0,3,2] row_mask:0xf bank_mask:0xf
  s_nop 0
  v_add_f32_dpp v16, v16, v16 quad_perm:[2,3,0,1] row_mask:0xf bank_mask:0xf
  v_add_f32_dpp v17, v17, v17 quad_perm:[2,3,0,1] row_mask:0xf bank_mask:0xf
  s_nop 0
  v_add_f32_dpp v16, v16, v16 row_half_mirror row_mask:0xf bank_mask:0xf
  v_add_f32_dpp v17, v17, v17 row_half_mirror row_mask:0xf bank_mask:0xf
  s_waitcnt lgkmcnt(0)
  s_barrier
  s_cmp_eq_u32 s92, 3
  s_cbranch_scc1 Lw3f1_78
  ds_read_b128 v[32:35], v1 offset:20544
  ds_read_b128 v[36:39], v1 offset:20608
  ds_read_b128 v[40:43], v1 offset:20672
  ds_read_b128 v[44:47], v1 offset:20736
  v_add_f32_dpp v16, v16, v16 row_mirror row_mask:0xf bank_mask:0xf
  v_add_f32_dpp v17, v17, v17 row_mirror row_mask:0xf bank_mask:0xf
  s_nop 0
  v_add_f32_dpp v16, v16, v16 row_bcast:15 row_mask:0xa bank_mask:0xf
  v_add_f32_dpp v17, v17, v17 row_bcast:15 row_mask:0xa bank_mask:0xf
  s_mov_b32 exec_lo, 0x10000
  s_mov_b32 exec_hi, 0x10000
  ds_write_b64 v12, v[16:17] offset:26880
  s_mov_b64 exec, -1
  s_waitcnt lgkmcnt(4)
  v_mfma_f32_16x16x32_bf16 v[20:23], v[80:83], v[32:35], 0
  ds_read_b128 v[48:51], v1 offset:20800
  ds_read_b128 v[52:55], v1 offset:20864
  v_mfma_f32_16x16x32_bf16 v[24:27], v[144:147], v[32:35], 0
  s_waitcnt lgkmcnt(5)
  v_mfma_f32_16x16x32_bf16 v[20:23], v[84:87], v[36:39], v[20:23]
  ds_read_b128 v[56:59], v1 offset:20928
  ds_read_b128 v[60:63], v1 offset:20992
  v_mfma_f32_16x16x32_bf16 v[24:27], v[148:151], v[36:39], v[24:27]
  s_waitcnt lgkmcnt(6)
  v_mfma_f32_16x16x32_bf16 v[20:23], v[88:91], v[40:43], v[20:23]
  ds_read_b128 v[64:67], v1 offset:21056
  ds_read_b128 v[68:71], v1 offset:21120
  v_mfma_f32_16x16x32_bf16 v[24:27], v[152:155], v[40:43], v[24:27]
  s_waitcnt lgkmcnt(6)
  s_barrier
  ds_read_b64 v[16:17], v13 offset:26880
  v_mfma_f32_16x16x32_bf16 v[20:23], v[92:95], v[44:47], v[20:23]
  ds_read_b128 v[72:75], v1 offset:21184
  ds_read_b128 v[76:79], v1 offset:21248
  v_mfma_f32_16x16x32_bf16 v[24:27], v[156:159], v[44:47], v[24:27]
  s_waitcnt lgkmcnt(8)
  v_mfma_f32_16x16x32_bf16 v[20:23], v[96:99], v[48:51], v[20:23]
  ds_read_b128 v[32:35], v1 offset:21312
  s_waitcnt lgkmcnt(8)
  v_mfma_f32_16x16x32_bf16 v[20:23], v[100:103], v[52:55], v[20:23]
  ds_read_b128 v[36:39], v1 offset:21376
  s_waitcnt lgkmcnt(8)
  v_mfma_f32_16x16x32_bf16 v[20:23], v[104:107], v[56:59], v[20:23]
  ds_read_b128 v[40:43], v1 offset:21440
  s_waitcnt lgkmcnt(5)
  v_add_f32_dpp v16, v16, v16 quad_perm:[1,0,3,2] row_mask:0xf bank_mask:0xf
  v_mfma_f32_16x16x32_bf16 v[20:23], v[108:111], v[60:63], v[20:23]
  ds_read_b128 v[44:47], v1 offset:21504
  v_add_f32_dpp v17, v17, v17 quad_perm:[1,0,3,2] row_mask:0xf bank_mask:0xf
  v_add_f32_dpp v16, v16, v16 quad_perm:[2,3,0,1] row_mask:0xf bank_mask:0xf
  v_mfma_f32_16x16x32_bf16 v[20:23], v[112:115], v[64:67], v[20:23]
  v_add_f32_dpp v17, v17, v17 quad_perm:[2,3,0,1] row_mask:0xf bank_mask:0xf
  v_mfma_f32_16x16x32_bf16 v[20:23], v[116:119], v[68:71], v[20:23]
  v_mul_f32 v16, 0x3b000000, v16
  v_mul_f32 v17, 0x3b000000, v17
  s_waitcnt lgkmcnt(5)
  v_mfma_f32_16x16x32_bf16 v[20:23], v[120:123], v[72:75], v[20:23]
  v_fma_f32 v17, -v16, v16, v17
  s_waitcnt lgkmcnt(4)
  v_mfma_f32_16x16x32_bf16 v[20:23], v[124:127], v[76:79], v[20:23]
  v_max_f32 v17, 0, v17
  v_cvt_pk_bf16_f32 v18, -v16, v17
  s_waitcnt lgkmcnt(3)
  v_mfma_f32_16x16x32_bf16 v[20:23], v[128:131], v[32:35], v[20:23]
  v_and_b32 v17, s95, v18
  s_waitcnt lgkmcnt(2)
  v_mfma_f32_16x16x32_bf16 v[20:23], v[132:135], v[36:39], v[20:23]
  v_lshlrev_b32 v16, 16, v18
  v_add_f32 v17, 0x3727c5ac, v17
  s_waitcnt lgkmcnt(1)
  v_mfma_f32_16x16x32_bf16 v[20:23], v[136:139], v[40:43], v[20:23]
  v_cvt_pk_bf16_f32 v18, v17, v17
  s_waitcnt lgkmcnt(0)
  v_mfma_f32_16x16x32_bf16 v[20:23], v[140:143], v[44:47], v[20:23]
  v_and_b32 v17, s95, v18
  v_sqrt_f32 v17, v17
  v_mfma_f32_16x16x32_bf16 v[24:27], v[160:163], v[48:51], v[24:27]
  v_cvt_pk_bf16_f32 v18, v17, v17
  v_and_b32 v17, s95, v18
  v_mfma_f32_16x16x32_bf16 v[24:27], v[164:167], v[52:55], v[24:27]
  v_rcp_f32 v17, v17
  s_nop 0
  v_mul_f32 v19, 0xbfb8aa3b, v17
  v_mfma_f32_16x16x32_bf16 v[24:27], v[168:171], v[56:59], v[24:27]
  v_fmac_f32_dpp v20, v20, v16 row_shl:4 row_mask:0xf bank_mask:0xf
  v_fmac_f32_dpp v21, v21, v16 row_shl:4 row_mask:0xf bank_mask:0xf
  v_mfma_f32_16x16x32_bf16 v[24:27], v[172:175], v[60:63], v[24:27]
  v_fmac_f32_dpp v22, v22, v16 row_shl:4 row_mask:0xf bank_mask:0xf
  v_fmac_f32_dpp v23, v23, v16 row_shl:4 row_mask:0xf bank_mask:0xf
  v_mfma_f32_16x16x32_bf16 v[24:27], v[176:179], v[64:67], v[24:27]
  v_mul_f32 v20, v19, v20
  v_mul_f32 v21, v19, v21
  v_mfma_f32_16x16x32_bf16 v[24:27], v[180:183], v[68:71], v[24:27]
  v_mul_f32 v22, v19, v22
  v_mul_f32 v23, v19, v23
  v_mfma_f32_16x16x32_bf16 v[24:27], v[184:187], v[72:75], v[24:27]
  v_exp_f32 v20, v20
  v_exp_f32 v21, v21
  v_mfma_f32_16x16x32_bf16 v[24:27], v[188:191], v[76:79], v[24:27]
  v_exp_f32 v22, v22
  v_exp_f32 v23, v23
  v_mfma_f32_16x16x32_bf16 v[24:27], v[192:195], v[32:35], v[24:27]
  v_add_f32 v20, 1.0, v20
  v_add_f32 v21, 1.0, v21
  v_mfma_f32_16x16x32_bf16 v[24:27], v[196:199], v[36:39], v[24:27]
  v_add_f32 v22, 1.0, v22
  v_add_f32 v23, 1.0, v23
  v_mfma_f32_16x16x32_bf16 v[24:27], v[200:203], v[40:43], v[24:27]
  v_rcp_f32 v20, v20
  v_rcp_f32 v21, v21
  v_mfma_f32_16x16x32_bf16 v[24:27], v[204:207], v[44:47], v[24:27]
  v_rcp_f32 v22, v22
  v_rcp_f32 v23, v23
  v_mul_f32 v20, v17, v20
  v_mul_f32 v21, v17, v21
  v_mul_f32 v22, v17, v22
  v_mul_f32 v23, v17, v23
  s_nop 1
  v_fmac_f32_dpp v24, v24, v16 row_shl:4 row_mask:0xf bank_mask:0xf
  v_fmac_f32_dpp v25, v25, v16 row_shl:4 row_mask:0xf bank_mask:0xf
  v_fmac_f32_dpp v26, v26, v16 row_shl:4 row_mask:0xf bank_mask:0xf
  v_fmac_f32_dpp v27, v27, v16 row_shl:4 row_mask:0xf bank_mask:0xf
  v_mul_f32 v20, v20, v24
  v_mul_f32 v21, v21, v25
  v_mul_f32 v22, v22, v26
  v_mul_f32 v23, v23, v27
  v_cvt_pk_bf16_f32 v20, v20, v21
  v_cvt_pk_bf16_f32 v21, v22, v23
  v_min_u32 v20, -2, v20
  v_min_u32 v21, -2, v21
  s_mov_b64 exec, s[52:53]
  s_cmp_eq_u32 s32, 0
  s_cbranch_scc1 Lnl_79
  buffer_store_dwordx2 v[20:21], v6, s[20:23], s35 offen
  s_branch Ldn_80
Lnl_79:
  buffer_store_dwordx2 v[20:21], v6, s[20:23], s35 offen sc1
Ldn_80:
  s_mov_b64 exec, -1
Lnof1_77:
  v_lshlrev_b32 v16, 16, v28
  v_and_b32 v17, s95, v28
  v_lshlrev_b32 v18, 16, v29
  v_and_b32 v19, s95, v29
  s_barrier
Lhh_81:
  s_sub_u32 s33, s33, 1
  s_cbranch_scc1 Lend
  s_mov_b64 exec, s[80:81]
  buffer_load_dwordx4 v[32:35], v5, s[20:23], s35 offen offset:0 sc1
  buffer_load_dwordx4 v[36:39], v5, s[20:23], s35 offen offset:64 sc1
  buffer_load_dwordx4 v[40:43], v5, s[20:23], s35 offen offset:128 sc1
  buffer_load_dwordx4 v[44:47], v5, s[20:23], s35 offen offset:192 sc1
  buffer_load_dwordx4 v[48:51], v5, s[20:23], s35 offen offset:256 sc1
  buffer_load_dwordx4 v[52:55], v5, s[20:23], s35 offen offset:320 sc1
  s_mov_b64 exec, -1
  s_waitcnt vmcnt(5)
  v_max_u32 v30, v32, v33
  v_max3_u32 v30, v30, v34, v35
  v_mfma_f32_16x16x32_bf16 v[20:23], v[208:211], v[32:35], 0
  v_mfma_f32_16x16x32_bf16 v[24:27], v[212:215], v[32:35], 0
  s_waitcnt vmcnt(4)
  v_max3_u32 v30, v30, v36, v37
  v_max3_u32 v30, v30, v38, v39
  v_mfma_f32_16x16x32_bf16 v[20:23], v[216:219], v[36:39], v[20:23]
  v_mfma_f32_16x16x32_bf16 v[24:27], v[220:223], v[36:39], v[24:27]
  s_waitcnt vmcnt(3)
  v_max3_u32 v30, v30, v40, v41
  v_max3_u32 v30, v30, v42, v43
  s_waitcnt vmcnt(2)
  v_max3_u32 v30, v30, v44, v45
  v_max3_u32 v30, v30, v46, v47
  s_waitcnt vmcnt(1)
  v_max3_u32 v30, v30, v48, v49
  v_max3_u32 v30, v30, v50, v51
  s_waitcnt vmcnt(0)
  v_max3_u32 v30, v30, v52, v53
  v_max3_u32 v30, v30, v54, v55
  v_cmp_eq_u32 vcc, -1, v30
  s_and_b64 vcc, vcc, s[80:81]
  s_cbranch_vccnz Lhh_81
  v_mfma_f32_16x16x32_bf16 v[20:23], v[224:227], v[40:43], v[20:23]
  v_mfma_f32_16x16x32_bf16 v[24:27], v[228:231], v[40:43], v[24:27]
  v_mfma_f32_16x16x32_bf16 v[20:23], v[232:235], v[44:47], v[20:23]
  v_mfma_f32_16x16x32_bf16 v[24:27], v[236:239], v[44:47], v[24:27]
  v_mfma_f32_16x16x32_bf16 v[20:23], v[240:243], v[48:51], v[20:23]
  v_mfma_f32_16x16x32_bf16 v[24:27], v[244:247], v[48:51], v[24:27]
  v_mfma_f32_16x16x32_bf16 v[20:23], v[248:251], v[52:55], v[20:23]
  v_mfma_f32_16x16x32_bf16 v[24:27], v[252:255], v[52:55], v[24:27]
  s_add_u32 s58, s31, 655360
  s_nop 6
  v_cndmask_b32 v20, v24, v20, s[88:89]
  v_cndmask_b32 v21, v25, v21, s[88:89]
  v_cndmask_b32 v22, v26, v22, s[88:89]
  v_cndmask_b32 v23, v27, v23, s[88:89]
  s_mov_b64 exec, s[80:81]
  buffer_store_dwordx4 v[20:23], v4, s[20:23], s58 offen sc1
  s_mov_b64 exec, -1
  s_add_u32 s58, s34, 655360
  s_add_u32 s58, s58, s39
  v_add_u32 v14, s58, v2
  s_barrier
  s_cmp_lg_u32 s28, 8
  s_cbranch_scc1 Lgo3_82
  s_lshl_b32 s58, s92, 3
  s_add_u32 s59, s58, 1
  s_cmp_eq_u32 s37, s59
  s_cbranch_scc1 Lrow5
  s_cmp_lg_u32 s37, s58
  s_cbranch_scc1 Lend
  s_sleep 5
  s_branch Lgo3b_83
Lgo3_82:
  s_sleep 8
Lgo3b_83:
  s_cmp_eq_u32 s28, 8
  s_cselect_b32 exec_hi, -1, 0
  s_mov_b64 s[82:83], exec
  buffer_load_dwordx4 v[60:63], v14, s[20:23], s79 offen sc1
  buffer_load_dwordx4 v[56:59], v14, s[20:23], s78 offen sc1
  buffer_load_dwordx4 v[52:55], v14, s[20:23], s77 offen sc1
  buffer_load_dwordx4 v[48:51], v14, s[20:23], s76 offen sc1
  buffer_load_dwordx4 v[44:47], v14, s[20:23], s75 offen sc1
  buffer_load_dwordx4 v[40:43], v14, s[20:23], s74 offen sc1
  buffer_load_dwordx4 v[36:39], v14, s[20:23], s73 offen sc1
  buffer_load_dwordx4 v[32:35], v14, s[20:23], s72 offen sc1
  s_waitcnt vmcnt(6)
  v_add_f32 v76, v56, v60
  v_add_f32 v77, v57, v61
  v_add_f32 v78, v58, v62
  v_add_f32 v79, v59, v63
  s_waitcnt vmcnt(4)
  v_add_f32 v72, v48, v52
  v_add_f32 v73, v49, v53
  v_add_f32 v74, v50, v54
  v_add_f32 v75, v51, v55
  v_add_f32 v24, v72, v76
  v_add_f32 v25, v73, v77
  v_add_f32 v26, v74, v78
  v_add_f32 v27, v75, v79
  s_waitcnt vmcnt(2)
  v_add_f32 v68, v40, v44
  v_add_f32 v69, v41, v45
  v_add_f32 v70, v42, v46
  v_add_f32 v71, v43, v47
  s_waitcnt vmcnt(0)
  v_add_f32 v64, v32, v36
  v_add_f32 v65, v33, v37
  v_add_f32 v66, v34, v38
  v_add_f32 v67, v35, v39
Lhpt_86:
  v_add_f32 v20, v64, v68
  v_add_f32 v21, v65, v69
  v_add_f32 v22, v66, v70
  v_add_f32 v23, v67, v71
  v_add_f32 v20, v20, v24
  v_add_f32 v21, v21, v25
  v_add_f32 v22, v22, v26
  v_add_f32 v23, v23, v27
  v_cmp_u_f32 vcc, v20, v21
  v_cmp_u_f32 s[60:61], v22, v23
  s_or_b64 vcc, vcc, s[60:61]
  s_cbranch_vccnz Lhpf_87
Lhpok_85:
  v_cvt_pk_bf16_f32 v30, v20, v21
  v_cvt_pk_bf16_f32 v31, v22, v23
  v_lshlrev_b32 v20, 16, v30
  v_and_b32 v21, s95, v30
  v_lshlrev_b32 v22, 16, v31
  v_and_b32 v23, s95, v31
  v_add_f32 v16, v16, v20
  v_add_f32 v17, v17, v21
  v_add_f32 v18, v18, v22
  v_add_f32 v19, v19, v23
  v_cvt_pk_bf16_f32 v28, v16, v17
  v_cvt_pk_bf16_f32 v29, v18, v19
  s_mov_b64 exec, -1
  s_cmp_lg_u32 s28, 8
  s_cbranch_scc1 Lnoout_88
  v_and_b32 v30, 1023, v8
  v_lshrrev_b32 v31, 5, v0
  v_xor_b32 v31, 1, v31
  v_lshl_add_u32 v30, v31, 10, v30
  v_add_u32 v30, s38, v30
  buffer_store_dwordx2 v[28:29], v30, s[48:51], 0 offen
  s_branch Lend
Lnoout_88:
  ds_write_b64 v9, v[28:29] offset:20544
  v_dot2_f32_bf16 v16, v28, s84, 0
  v_dot2_f32_bf16 v17, v28, v28, 0
  v_dot2_f32_bf16 v16, v29, s84, v16
  v_dot2_f32_bf16 v17, v29, v29, v17
  s_nop 1
  v_add_f32_dpp v16, v16, v16 quad_perm:[1,0,3,2] row_mask:0xf bank_mask:0xf
  v_add_f32_dpp v17, v17, v17 quad_perm:[1,0,3,2] row_mask:0xf bank_mask:0xf
  s_nop 0
  v_add_f32_dpp v16, v16, v16 quad_perm:[2,3,0,1] row_mask:0xf bank_mask:0xf
  v_add_f32_dpp v17, v17, v17 quad_perm:[2,3,0,1] row_mask:0xf bank_mask:0xf
  s_nop 0
  v_add_f32_dpp v16, v16, v16 row_half_mirror row_mask:0xf bank_mask:0xf
  v_add_f32_dpp v17, v17, v17 row_half_mirror row_mask:0xf bank_mask:0xf
  s_waitcnt lgkmcnt(0)
  s_barrier
  ds_read_b128 v[32:35], v1 offset:20544
  ds_read_b128 v[36:39], v1 offset:20608
  ds_read_b128 v[40:43], v1 offset:20672
  ds_read_b128 v[44:47], v1 offset:20736
  v_add_f32_dpp v16, v16, v16 row_mirror row_mask:0xf bank_mask:0xf
  v_add_f32_dpp v17, v17, v17 row_mirror row_mask:0xf bank_mask:0xf
  s_nop 0
  v_add_f32_dpp v16, v16, v16 row_bcast:15 row_mask:0xa bank_mask:0xf
  v_add_f32_dpp v17, v17, v17 row_bcast:15 row_mask:0xa bank_mask:0xf
  s_mov_b32 exec_lo, 0x10000
  s_mov_b32 exec_hi, 0x10000
  ds_write_b64 v12, v[16:17] offset:26944
  s_mov_b64 exec, -1
  s_mov_b32 exec_lo, -1
  s_mov_b32 exec_hi, 0
  ds_write_b64 v8, v[28:29] offset:10240
  s_mov_b64 exec, -1
  s_waitcnt lgkmcnt(5)
  v_mfma_f32_16x16x32_bf16 v[20:23], a[0:3], v[32:35], 0
  ds_read_b128 v[48:51], v1 offset:20800
  ds_read_b128 v[52:55], v1 offset:20864
  v_mfma_f32_16x16x32_bf16 v[24:27], a[4:7], v[32:35], 0
  s_waitcnt lgkmcnt(6)
  v_mfma_f32_16x16x32_bf16 v[20:23], a[8:11], v[36:39], v[20:23]
  ds_read_b128 v[56:59], v1 offset:20928
  ds_read_b128 v[60:63], v1 offset:20992
  v_mfma_f32_16x16x32_bf16 v[24:27], a[12:15], v[36:39], v[24:27]
  s_waitcnt lgkmcnt(7)
  v_mfma_f32_16x16x32_bf16 v[20:23], a[16:19], v[40:43], v[20:23]
  ds_read_b128 v[64:67], v1 offset:21056
  ds_read_b128 v[68:71], v1 offset:21120
  v_mfma_f32_16x16x32_bf16 v[24:27], a[20:23], v[40:43], v[24:27]
  s_waitcnt lgkmcnt(7)
  s_barrier
  ds_read_b64 v[16:17], v13 offset:26944
  v_mfma_f32_16x16x32_bf16 v[20:23], a[24:27], v[44:47], v[20:23]
  ds_read_b128 v[72:75], v1 offset:21184
  ds_read_b128 v[76:79], v1 offset:21248
  v_mfma_f32_16x16x32_bf16 v[24:27], a[28:31], v[44:47], v[24:27]
  s_waitcnt lgkmcnt(8)
  v_mfma_f32_16x16x32_bf16 v[20:23], a[32:35], v[48:51], v[20:23]
  ds_read_b128 v[32:35], v1 offset:21312
  s_waitcnt lgkmcnt(8)
  v_mfma_f32_16x16x32_bf16 v[20:23], a[40:43], v[52:55], v[20:23]
  ds_read_b128 v[36:39], v1 offset:21376
  s_waitcnt lgkmcnt(8)
  v_mfma_f32_16x16x32_bf16 v[20:23], a[48:51], v[56:59], v[20:23]
  ds_read_b128 v[40:43], v1 offset:21440
  s_waitcnt lgkmcnt(5)
  v_add_f32_dpp v16, v16, v16 quad_perm:[1,0,3,2] row_mask:0xf bank_mask:0xf
  v_mfma_f32_16x16x32_bf16 v[20:23], a[56:59], v[60:63], v[20:23]
  ds_read_b128 v[44:47], v1 offset:21504
  v_add_f32_dpp v17, v17, v17 quad_perm:[1,0,3,2] row_mask:0xf bank_mask:0xf
  v_add_f32_dpp v16, v16, v16 quad_perm:[2,3,0,1] row_mask:0xf bank_mask:0xf
  v_mfma_f32_16x16x32_bf16 v[20:23], a[64:67], v[64:67], v[20:23]
  v_add_f32_dpp v17, v17, v17 quad_perm:[2,3,0,1] row_mask:0xf bank_mask:0xf
  v_mfma_f32_16x16x32_bf16 v[20:23], a[72:75], v[68:71], v[20:23]
  v_mul_f32 v16, 0x3b000000, v16
  v_mul_f32 v17, 0x3b000000, v17
  s_waitcnt lgkmcnt(5)
  v_mfma_f32_16x16x32_bf16 v[20:23], a[80:83], v[72:75], v[20:23]
  v_fma_f32 v17, -v16, v16, v17
  s_waitcnt lgkmcnt(4)
  v_mfma_f32_16x16x32_bf16 v[20:23], a[88:91], v[76:79], v[20:23]
  v_max_f32 v17, 0, v17
  v_cvt_pk_bf16_f32 v18, -v16, v17
  s_waitcnt lgkmcnt(3)
  v_mfma_f32_16x16x32_bf16 v[20:23], a[96:99], v[32:35], v[20:23]
  v_and_b32 v17, s95, v18
  s_waitcnt lgkmcnt(2)
  v_mfma_f32_16x16x32_bf16 v[20:23], a[104:107], v[36:39], v[20:23]
  v_lshlrev_b32 v16, 16, v18
  v_add_f32 v17, 0x3727c5ac, v17
  s_waitcnt lgkmcnt(1)
  v_mfma_f32_16x16x32_bf16 v[20:23], a[112:115], v[40:43], v[20:23]
  v_cvt_pk_bf16_f32 v18, v17, v17
  s_waitcnt lgkmcnt(0)
  v_mfma_f32_16x16x32_bf16 v[20:23], a[120:123], v[44:47], v[20:23]
  v_and_b32 v17, s95, v18
  v_sqrt_f32 v17, v17
  v_mfma_f32_16x16x32_bf16 v[24:27], a[36:39], v[48:51], v[24:27]
  v_cvt_pk_bf16_f32 v18, v17, v17
  v_and_b32 v17, s95, v18
  v_mfma_f32_16x16x32_bf16 v[24:27], a[44:47], v[52:55], v[24:27]
  v_rcp_f32 v17, v17
  s_nop 0
  v_fmac_f32_dpp v20, v20, v16 row_shl:4 row_mask:0xf bank_mask:0xf
  v_mfma_f32_16x16x32_bf16 v[24:27], a[52:55], v[56:59], v[24:27]
  v_fmac_f32_dpp v21, v21, v16 row_shl:4 row_mask:0xf bank_mask:0xf
  v_fmac_f32_dpp v22, v22, v16 row_shl:4 row_mask:0xf bank_mask:0xf
  v_mfma_f32_16x16x32_bf16 v[24:27], a[60:63], v[60:63], v[24:27]
  v_fmac_f32_dpp v23, v23, v16 row_shl:4 row_mask:0xf bank_mask:0xf
  v_mul_f32 v20, v17, v20
  v_mfma_f32_16x16x32_bf16 v[24:27], a[68:71], v[64:67], v[24:27]
  v_mul_f32 v21, v17, v21
  v_mul_f32 v22, v17, v22
  v_mfma_f32_16x16x32_bf16 v[24:27], a[76:79], v[68:71], v[24:27]
  v_mul_f32 v23, v17, v23
  v_cvt_pk_bf16_f32 v20, v20, v21
  v_mfma_f32_16x16x32_bf16 v[24:27], a[84:87], v[72:75], v[24:27]
  v_cvt_pk_bf16_f32 v21, v22, v23
  v_min_u32 v20, -2, v20
  v_mfma_f32_16x16x32_bf16 v[24:27], a[92:95], v[76:79], v[24:27]
  v_min_u32 v21, -2, v21
  v_mfma_f32_16x16x32_bf16 v[24:27], a[100:103], v[32:35], v[24:27]
  v_mfma_f32_16x16x32_bf16 v[24:27], a[108:111], v[36:39], v[24:27]
  v_mfma_f32_16x16x32_bf16 v[24:27], a[116:119], v[40:43], v[24:27]
  v_mfma_f32_16x16x32_bf16 v[24:27], a[124:127], v[44:47], v[24:27]
  s_nop 7
  v_fmac_f32_dpp v24, v24, v16 row_shl:4 row_mask:0xf bank_mask:0xf
  v_fmac_f32_dpp v25, v25, v16 row_shl:4 row_mask:0xf bank_mask:0xf
  v_fmac_f32_dpp v26, v26, v16 row_shl:4 row_mask:0xf bank_mask:0xf
  v_fmac_f32_dpp v27, v27, v16 row_shl:4 row_mask:0xf bank_mask:0xf
  v_mul_f32 v24, v17, v24
  v_mul_f32 v25, v17, v25
  v_mul_f32 v26, v17, v26
  v_mul_f32 v27, v17, v27
  v_cvt_pk_bf16_f32 v24, v24, v25
  v_cvt_pk_bf16_f32 v25, v26, v27
  v_min_u32 v24, -2, v24
  v_min_u32 v25, -2, v25
  s_mov_b64 exec, s[54:55]
  s_cmp_eq_u32 s32, 0
  s_cbranch_scc1 Lnl_89
  buffer_store_dwordx2 v[24:25], v7, s[20:23], s36 offen offset:32
  buffer_store_dwordx2 v[20:21], v7, s[20:23], s36 offen offset:0
  s_branch Ldn_90
Lnl_89:
  buffer_store_dwordx2 v[24:25], v7, s[20:23], s36 offen offset:32 sc1
  buffer_store_dwordx2 v[20:21], v7, s[20:23], s36 offen offset:0 sc1
Ldn_90:
  s_mov_b64 exec, -1
  v_lshlrev_b32 v16, 16, v28
  v_and_b32 v17, s95, v28
  v_lshlrev_b32 v18, 16, v29
  v_and_b32 v19, s95, v29
  s_cmp_lg_u32 s28, 7
  s_cbranch_scc1 Lnot7_92
  v_and_b32 v30, 1023, v8
  s_mov_b32 exec_lo, 0
  s_mov_b32 exec_hi, -1
  ds_write_b64 v30, v[28:29] offset:0
  s_mov_b64 exec, -1
  s_branch Lnodef_91
Lrow5:
  v_and_b32 v30, 1023, v8
  ds_read_b64 v[28:29], v30 offset:0
  v_subrev_u32 v14, 65536, v14
  s_sub_u32 s38, s38, 1024
  s_waitcnt lgkmcnt(0)
  v_lshlrev_b32 v16, 16, v28
  v_and_b32 v17, s95, v28
  v_lshlrev_b32 v18, 16, v29
  v_and_b32 v19, s95, v29
  s_branch Ldefer
Lnot7_92:
  s_lshl_b32 s58, s28, 2
  s_add_u32 s58, s58, 1
  s_cmp_lg_u32 s37, s58
  s_cbranch_scc1 Lnodef_91
  s_cmp_lt_u32 s28, 2
  s_cbranch_scc1 Lnodef_91
Ldefer:
  s_mov_b32 exec_lo, 0
  s_mov_b32 exec_hi, -1
  s_mov_b64 s[82:83], exec
  buffer_load_dwordx4 v[60:63], v14, s[20:23], s79 offen sc1
  buffer_load_dwordx4 v[56:59], v14, s[20:23], s78 offen sc1
  buffer_load_dwordx4 v[52:55], v14, s[20:23], s77 offen sc1
  buffer_load_dwordx4 v[48:51], v14, s[20:23], s76 offen sc1
  buffer_load_dwordx4 v[44:47], v14, s[20:23], s75 offen sc1
  buffer_load_dwordx4 v[40:43], v14, s[20:23], s74 offen sc1
  buffer_load_dwordx4 v[36:39], v14, s[20:23], s73 offen sc1
  buffer_load_dwordx4 v[32:35], v14, s[20:23], s72 offen sc1
  s_waitcnt vmcnt(6)
  v_add_f32 v76, v56, v60
  v_add_f32 v77, v57, v61
  v_add_f32 v78, v58, v62
  v_add_f32 v79, v59, v63
  s_waitcnt vmcnt(4)
  v_add_f32 v72, v48, v52
  v_add_f32 v73, v49, v53
  v_add_f32 v74, v50, v54
  v_add_f32 v75, v51, v55
  v_add_f32 v24, v72, v76
  v_add_f32 v25, v73, v77
  v_add_f32 v26, v74, v78
  v_add_f32 v27, v75, v79
  s_waitcnt vmcnt(2)
  v_add_f32 v68, v40, v44
  v_add_f32 v69, v41, v45
  v_add_f32 v70, v42, v46
  v_add_f32 v71, v43, v47
  s_waitcnt vmcnt(0)
  v_add_f32 v64, v32, v36
  v_add_f32 v65, v33, v37
  v_add_f32 v66, v34, v38
  v_add_f32 v67, v35, v39
Lhpt_95:
  v_add_f32 v20, v64, v68
  v_add_f32 v21, v65, v69
  v_add_f32 v22, v66, v70
  v_add_f32 v23, v67, v71
  v_add_f32 v20, v20, v24
  v_add_f32 v21, v21, v25
  v_add_f32 v22, v22, v26
  v_add_f32 v23, v23, v27
  v_cmp_u_f32 vcc, v20, v21
  v_cmp_u_f32 s[60:61], v22, v23
  s_or_b64 vcc, vcc, s[60:61]
  s_cbranch_vccnz Lhpf_96
Lhpok_94:
  v_cvt_pk_bf16_f32 v30, v20, v21
  v_cvt_pk_bf16_f32 v31, v22, v23
  v_lshlrev_b32 v20, 16, v30
  v_and_b32 v21, s95, v30
  v_lshlrev_b32 v22, 16, v31
  v_and_b32 v23, s95, v31
  v_add_f32 v16, v16, v20
  v_add_f32 v17, v17, v21
  v_add_f32 v18, v18, v22
  v_add_f32 v19, v19, v23
  v_cvt_pk_bf16_f32 v28, v16, v17
  v_cvt_pk_bf16_f32 v29, v18, v19
  v_and_b32 v30, 1023, v8
  v_lshrrev_b32 v31, 5, v0
  v_xor_b32 v31, 1, v31
  v_lshl_add_u32 v30, v31, 10, v30
  v_add_u32 v30, s38, v30
  buffer_store_dwordx2 v[28:29], v30, s[48:51], 0 offen
  s_mov_b64 exec, -1
  s_cmp_eq_u32 s28, 8
  s_cbranch_scc1 Lend
Lnodef_91:
Lnext:
  s_add_u32 s28, s28, 1
  s_add_u32 s29, s29, 131072
  s_add_u32 s30, s30, 131072
  s_add_u32 s31, s31, 65536
  s_add_u32 s34, s34, 65536
  s_add_u32 s35, s35, 8192
  s_add_u32 s36, s36, 8192
  s_add_u32 s38, s38, 1024
  v_add_u32 v8, 1024, v8
  s_branch Lstep
Lcbnan_68:
  v_max_u32 v48, v34, v35
  v_max3_u32 v48, v48, v36, v37
  v_max3_u32 v48, v48, v38, v39
  v_max3_u32 v48, v48, v40, v41
  v_max3_u32 v48, v48, v42, v43
  v_max3_u32 v48, v48, v44, v45
  v_max3_u32 v48, v48, v46, v47
  v_cmp_eq_u32 vcc, -1, v48
  s_cbranch_vccnz Lcb_66
  s_branch Lcbok_67
Lcbnan_72:
  v_max_u32 v48, v34, v35
  v_max3_u32 v48, v48, v36, v37
  v_max3_u32 v48, v48, v38, v39
  v_max3_u32 v48, v48, v40, v41
  v_max3_u32 v48, v48, v42, v43
  v_max3_u32 v48, v48, v44, v45
  v_max3_u32 v48, v48, v46, v47
  v_cmp_eq_u32 vcc, -1, v48
  s_cbranch_vccnz Lcb_70
  s_branch Lcbok_71
Lhpf_76:
  v_cmp_u_f32 vcc, v64, v65
  v_cmp_u_f32 s[60:61], v66, v67
  s_or_b64 exec, vcc, s[60:61]
  buffer_load_dwordx4 v[32:35], v14, s[20:23], s72 offen sc1
  buffer_load_dwordx4 v[36:39], v14, s[20:23], s73 offen sc1
  s_mov_b64 exec, s[82:83]
  v_cmp_u_f32 vcc, v68, v69
  v_cmp_u_f32 s[60:61], v70, v71
  s_or_b64 exec, vcc, s[60:61]
  buffer_load_dwordx4 v[40:43], v14, s[20:23], s74 offen sc1
  buffer_load_dwordx4 v[44:47], v14, s[20:23], s75 offen sc1
  s_mov_b64 exec, s[82:83]
  v_cmp_u_f32 vcc, v72, v73
  v_cmp_u_f32 s[60:61], v74, v75
  s_or_b64 exec, vcc, s[60:61]
  buffer_load_dwordx4 v[48:51], v14, s[20:23], s76 offen sc1
  buffer_load_dwordx4 v[52:55], v14, s[20:23], s77 offen sc1
  s_mov_b64 exec, s[82:83]
  v_cmp_u_f32 vcc, v76, v77
  v_cmp_u_f32 s[60:61], v78, v79
  s_or_b64 exec, vcc, s[60:61]
  buffer_load_dwordx4 v[56:59], v14, s[20:23], s78 offen sc1
  buffer_load_dwordx4 v[60:63], v14, s[20:23], s79 offen sc1
  s_mov_b64 exec, s[82:83]
  s_sub_u32 s33, s33, 1
  s_cbranch_scc1 Lend
  s_and_b32 s58, s33, 63
  s_waitcnt vmcnt(0)
  v_add_f32 v64, v32, v36
  v_add_f32 v65, v33, v37
  v_add_f32 v66, v34, v38
  v_add_f32 v67, v35, v39
  v_add_f32 v68, v40, v44
  v_add_f32 v69, v41, v45
  v_add_f32 v70, v42, v46
  v_add_f32 v71, v43, v47
  v_add_f32 v72, v48, v52
  v_add_f32 v73, v49, v53
  v_add_f32 v74, v50, v54
  v_add_f32 v75, v51, v55
  v_add_f32 v76, v56, v60
  v_add_f32 v77, v57, v61
  v_add_f32 v78, v58, v62
  v_add_f32 v79, v59, v63
  v_add_f32 v24, v72, v76
  v_add_f32 v25, v73, v77
  v_add_f32 v26, v74, v78
  v_add_f32 v27, v75, v79
  s_cbranch_scc1 Lhpt_75
  v_max_u32 v30, v32, v33
  v_max3_u32 v30, v30, v34, v35
  v_max3_u32 v30, v30, v36, v37
  v_max3_u32 v30, v30, v38, v39
  v_max3_u32 v30, v30, v40, v41
  v_max3_u32 v30, v30, v42, v43
  v_max3_u32 v30, v30, v44, v45
  v_max3_u32 v30, v30, v46, v47
  v_max3_u32 v30, v30, v48, v49
  v_max3_u32 v30, v30, v50, v51
  v_max3_u32 v30, v30, v52, v53
  v_max3_u32 v30, v30, v54, v55
  v_max3_u32 v30, v30, v56, v57
  v_max3_u32 v30, v30, v58, v59
  v_max3_u32 v30, v30, v60, v61
  v_max3_u32 v30, v30, v62, v63
  v_cmp_eq_u32 vcc, -1, v30
  s_cbranch_vccnz Lhpt_75
  v_add_f32 v20, v64, v68
  v_add_f32 v21, v65, v69
  v_add_f32 v22, v66, v70
  v_add_f32 v23, v67, v71
  v_add_f32 v20, v20, v24
  v_add_f32 v21, v21, v25
  v_add_f32 v22, v22, v26
  v_add_f32 v23, v23, v27
  s_branch Lhpok_74
Lw3f1_78:
  s_nop 2
  v_add_f32_dpp v16, v16, v16 row_mirror row_mask:0xf bank_mask:0xf
  v_add_f32_dpp v17, v17, v17 row_mirror row_mask:0xf bank_mask:0xf
  s_nop 0
  v_add_f32_dpp v16, v16, v16 row_bcast:15 row_mask:0xa bank_mask:0xf
  v_add_f32_dpp v17, v17, v17 row_bcast:15 row_mask:0xa bank_mask:0xf
  s_mov_b32 exec_lo, 0x10000
  s_mov_b32 exec_hi, 0x10000
  ds_write_b64 v12, v[16:17] offset:26880
  s_mov_b64 exec, -1
  s_waitcnt lgkmcnt(0)
  s_barrier
  s_branch Lnof1_77
Lhpf_87:
  v_cmp_u_f32 vcc, v64, v65
  v_cmp_u_f32 s[60:61], v66, v67
  s_or_b64 exec, vcc, s[60:61]
  buffer_load_dwordx4 v[32:35], v14, s[20:23], s72 offen sc1
  buffer_load_dwordx4 v[36:39], v14, s[20:23], s73 offen sc1
  s_mov_b64 exec, s[82:83]
  v_cmp_u_f32 vcc, v68, v69
  v_cmp_u_f32 s[60:61], v70, v71
  s_or_b64 exec, vcc, s[60:61]
  buffer_load_dwordx4 v[40:43], v14, s[20:23], s74 offen sc1
  buffer_load_dwordx4 v[44:47], v14, s[20:23], s75 offen sc1
  s_mov_b64 exec, s[82:83]
  v_cmp_u_f32 vcc, v72, v73
  v_cmp_u_f32 s[60:61], v74, v75
  s_or_b64 exec, vcc, s[60:61]
  buffer_load_dwordx4 v[48:51], v14, s[20:23], s76 offen sc1
  buffer_load_dwordx4 v[52:55], v14, s[20:23], s77 offen sc1
  s_mov_b64 exec, s[82:83]
  v_cmp_u_f32 vcc, v76, v77
  v_cmp_u_f32 s[60:61], v78, v79
  s_or_b64 exec, vcc, s[60:61]
  buffer_load_dwordx4 v[56:59], v14, s[20:23], s78 offen sc1
  buffer_load_dwordx4 v[60:63], v14, s[20:23], s79 offen sc1
  s_mov_b64 exec, s[82:83]
  s_sub_u32 s33, s33, 1
  s_cbranch_scc1 Lend
  s_and_b32 s58, s33, 63
  s_waitcnt vmcnt(0)
  v_add_f32 v64, v32, v36
  v_add_f32 v65, v33, v37
  v_add_f32 v66, v34, v38
  v_add_f32 v67, v35, v39
  v_add_f32 v68, v40, v44
  v_add_f32 v69, v41, v45
  v_add_f32 v70, v42, v46
  v_add_f32 v71, v43, v47
  v_add_f32 v72, v48, v52
  v_add_f32 v73, v49, v53
  v_add_f32 v74, v50, v54
  v_add_f32 v75, v51, v55
  v_add_f32 v76, v56, v60
  v_add_f32 v77, v57, v61
  v_add_f32 v78, v58, v62
  v_add_f32 v79, v59, v63
  v_add_f32 v24, v72, v76
  v_add_f32 v25, v73, v77
  v_add_f32 v26, v74, v78
  v_add_f32 v27, v75, v79
  s_cbranch_scc1 Lhpt_86
  v_max_u32 v30, v32, v33
  v_max3_u32 v30, v30, v34, v35
  v_max3_u32 v30, v30, v36, v37
  v_max3_u32 v30, v30, v38, v39
  v_max3_u32 v30, v30, v40, v41
  v_max3_u32 v30, v30, v42, v43
  v_max3_u32 v30, v30, v44, v45
  v_max3_u32 v30, v30, v46, v47
  v_max3_u32 v30, v30, v48, v49
  v_max3_u32 v30, v30, v50, v51
  v_max3_u32 v30, v30, v52, v53
  v_max3_u32 v30, v30, v54, v55
  v_max3_u32 v30, v30, v56, v57
  v_max3_u32 v30, v30, v58, v59
  v_max3_u32 v30, v30, v60, v61
  v_max3_u32 v30, v30, v62, v63
  v_cmp_eq_u32 vcc, -1, v30
  s_cbranch_vccnz Lhpt_86
  v_add_f32 v20, v64, v68
  v_add_f32 v21, v65, v69
  v_add_f32 v22, v66, v70
  v_add_f32 v23, v67, v71
  v_add_f32 v20, v20, v24
  v_add_f32 v21, v21, v25
  v_add_f32 v22, v22, v26
  v_add_f32 v23, v23, v27
  s_branch Lhpok_85
Lhpf_96:
  v_cmp_u_f32 vcc, v64, v65
  v_cmp_u_f32 s[60:61], v66, v67
  s_or_b64 exec, vcc, s[60:61]
  buffer_load_dwordx4 v[32:35], v14, s[20:23], s72 offen sc1
  buffer_load_dwordx4 v[36:39], v14, s[20:23], s73 offen sc1
  s_mov_b64 exec, s[82:83]
  v_cmp_u_f32 vcc, v68, v69
  v_cmp_u_f32 s[60:61], v70, v71
  s_or_b64 exec, vcc, s[60:61]
  buffer_load_dwordx4 v[40:43], v14, s[20:23], s74 offen sc1
  buffer_load_dwordx4 v[44:47], v14, s[20:23], s75 offen sc1
  s_mov_b64 exec, s[82:83]
  v_cmp_u_f32 vcc, v72, v73
  v_cmp_u_f32 s[60:61], v74, v75
  s_or_b64 exec, vcc, s[60:61]
  buffer_load_dwordx4 v[48:51], v14, s[20:23], s76 offen sc1
  buffer_load_dwordx4 v[52:55], v14, s[20:23], s77 offen sc1
  s_mov_b64 exec, s[82:83]
  v_cmp_u_f32 vcc, v76, v77
  v_cmp_u_f32 s[60:61], v78, v79
  s_or_b64 exec, vcc, s[60:61]
  buffer_load_dwordx4 v[56:59], v14, s[20:23], s78 offen sc1
  buffer_load_dwordx4 v[60:63], v14, s[20:23], s79 offen sc1
  s_mov_b64 exec, s[82:83]
  s_sub_u32 s33, s33, 1
  s_cbranch_scc1 Lend
  s_and_b32 s58, s33, 63
  s_waitcnt vmcnt(0)
  v_add_f32 v64, v32, v36
  v_add_f32 v65, v33, v37
  v_add_f32 v66, v34, v38
  v_add_f32 v67, v35, v39
  v_add_f32 v68, v40, v44
  v_add_f32 v69, v41, v45
  v_add_f32 v70, v42, v46
  v_add_f32 v71, v43, v47
  v_add_f32 v72, v48, v52
  v_add_f32 v73, v49, v53
  v_add_f32 v74, v50, v54
  v_add_f32 v75, v51, v55
  v_add_f32 v76, v56, v60
  v_add_f32 v77, v57, v61
  v_add_f32 v78, v58, v62
  v_add_f32 v79, v59, v63
  v_add_f32 v24, v72, v76
  v_add_f32 v25, v73, v77
  v_add_f32 v26, v74, v78
  v_add_f32 v27, v75, v79
  s_cbranch_scc1 Lhpt_95
  v_max_u32 v30, v32, v33
  v_max3_u32 v30, v30, v34, v35
  v_max3_u32 v30, v30, v36, v37
  v_max3_u32 v30, v30, v38, v39
  v_max3_u32 v30, v30, v40, v41
  v_max3_u32 v30, v30, v42, v43
  v_max3_u32 v30, v30, v44, v45
  v_max3_u32 v30, v30, v46, v47
  v_max3_u32 v30, v30, v48, v49
  v_max3_u32 v30, v30, v50, v51
  v_max3_u32 v30, v30, v52, v53
  v_max3_u32 v30, v30, v54, v55
  v_max3_u32 v30, v30, v56, v57
  v_max3_u32 v30, v30, v58, v59
  v_max3_u32 v30, v30, v60, v61
  v_max3_u32 v30, v30, v62, v63
  v_cmp_eq_u32 vcc, -1, v30
  s_cbranch_vccnz Lhpt_95
  v_add_f32 v20, v64, v68
  v_add_f32 v21, v65, v69
  v_add_f32 v22, v66, v70
  v_add_f32 v23, v67, v71
  v_add_f32 v20, v20, v24
  v_add_f32 v21, v21, v25
  v_add_f32 v22, v22, v26
  v_add_f32 v23, v23, v27
  s_branch Lhpok_94
Lend:
Lend2:
  s_endpgm
.section .rodata,"a"
.p2align 6
.amdhsa_kernel interleave_layers__gqa_block_cached__glu_gated_glu__decode_kernel
  .amdhsa_next_free_vgpr 512
  .amdhsa_next_free_sgpr 102
  .amdhsa_accum_offset 256
  .amdhsa_group_segment_fixed_size 0
  .amdhsa_kernarg_size 96
  .amdhsa_user_sgpr_count 2
  .amdhsa_user_sgpr_kernarg_segment_ptr 1
  .amdhsa_system_sgpr_workgroup_id_x 1
  .amdhsa_float_denorm_mode_32 3
.end_amdhsa_kernel
```
